```python
import torch

def _softmax(x, axis=-1):
    return torch.softmax(x, dim=axis)
def _gelu(x):
    return torch.nn.functional.gelu(x, approximate="tanh")
def _silu(x):
    return torch.nn.functional.silu(x)
def _sigmoid(x):
    return torch.sigmoid(x)
def _layernorm(x, axis=-1, eps=1e-5):
    m = x.mean(dim=axis, keepdim=True)
    v = x.var(dim=axis, keepdim=True, unbiased=False)
    return (x - m) / torch.sqrt(v + eps)
def _scatter_add(tgt, idx, src, axis=0):
    return tgt.clone().index_add_(axis, idx, src)
def _segment_sum(src, seg, n):
    out = torch.zeros((n,) + src.shape[1:], dtype=src.dtype)
    return out.index_add_(0, seg, src)
def _pad(x, pw):
    flat = tuple(v for pair in reversed(pw) for v in pair)
    return torch.nn.functional.pad(x, flat)

kernel_name = 'standalone__gqa_softmax__near_ridge'

def setup_inputs():

    _w = (lambda a: (lambda t: t.to(torch.bfloat16) if t.is_floating_point() else t)(torch.as_tensor(a)))
    B, Hq, Hkv, Sq, Sk, D = 8, 32, 32, 736, 512, 128
    return {
        "q": _w((lambda *s: torch.randn(*s, dtype=torch.bfloat16) * 0.8)(B, Hq, Sq, D)),
        "k": _w((lambda *s: torch.randn(*s, dtype=torch.bfloat16) * 0.8)(B, Hkv, Sk, D)),
        "v": _w((lambda *s: torch.randn(*s, dtype=torch.bfloat16) * 0.05)(B, Hkv, Sk, D)),
    }

def reference(q, k, v):
    B, Hq, Sq, D = q.shape
    Hkv = k.shape[1]
    rep = Hq // Hkv
    k = (lambda x, n, axis: torch.repeat_interleave(x, n, dim=axis))(k, rep, axis=1)
    v = (lambda x, n, axis: torch.repeat_interleave(x, n, dim=axis))(v, rep, axis=1)
    scale = D ** -0.5
    scores = torch.einsum("bhqd,bhkd->bhqk", q, k) * scale
    p = _softmax(scores, axis=-1)
    return torch.einsum("bhqk,bhkd->bhqd", p, v)
```

```asm
; @launch grid=(256,1,1) block=(256,1,1) lds=163840
.amdgcn_target "amdgcn-amd-amdhsa--gfx950"
.text
.globl standalone__gqa_softmax__near_ridge_kernel
.p2align 8
.type standalone__gqa_softmax__near_ridge_kernel,@function
standalone__gqa_softmax__near_ridge_kernel:
s_cmp_ge_u32 s2, 256
s_cbranch_scc1 L_end
s_load_dwordx4 s[4:7], s[0:1], 0
s_load_dwordx4 s[12:15], s[0:1], 16
v_lshrrev_b32 v202, 6, v0
v_and_b32 v0, 63, v0
v_readfirstlane_b32 s20, v202
v_and_b32 v200, 15, v0
v_lshrrev_b32 v201, 4, v0
v_lshlrev_b32 v5, 8, v200
v_lshl_add_u32 v5, v201, 4, v5
v_lshrrev_b32 v202, 2, v200
v_lshlrev_b32 v3, 8, v202
v_lshl_add_u32 v3, v201, 6, v3
v_and_b32 v203, 3, v0
v_lshl_add_u32 v3, v203, 4, v3
s_and_b32 s32, s20, 1
s_lshl_b32 s32, s32, 5
v_xor_b32 v232, s32, v3
v_xor_b32 v4, 32, v3
s_and_b32 s32, s2, 7
s_lshl_b32 s32, s32, 5
s_lshr_b32 s33, s2, 4
s_lshl_b32 s33, s33, 1
s_add_u32 s32, s32, s33
s_lshl_b32 s100, s32, 17
s_add_u32 s3, s100, 262144
s_lshl_b32 s22, s20, 11
s_add_u32 s21, s100, s22
s_mul_i32 s34, s20, 2064
s_add_u32 s34, s34, 32768
s_add_u32 s35, s34, 33024
s_mov_b32 s23, s34
s_mul_i32 s27, s32, 188416
s_bfe_u32 s33, s2, 0x10003
s_mul_i32 s33, s33, 94208
s_add_u32 s27, s27, s33
s_mul_i32 s33, s20, 24576
s_add_u32 s27, s27, s33
s_add_u32 s46, s33, 65792
s_waitcnt lgkmcnt(0)
s_mov_b32 s8, s6
s_mov_b32 s9, s7
s_mov_b32 s10, s3
s_mov_b32 s11, 0x20000
s_mov_b32 s16, s14
s_mov_b32 s17, s15
s_mov_b32 s18, 48234496
s_mov_b32 s19, 0x20000
s_mov_b32 s6, 48234496
s_mov_b32 s7, 0x20000
s_mov_b32 s14, s3
s_mov_b32 s15, 0x20000
s_getpc_b64 s[44:45]
L_pc:
s_lshr_b32 s33, s2, 3
s_lshl_b32 s33, s33, 2
s_add_u32 s33, s33, s20
s_mul_i32 s33, s33, 768
v_min_u32 v242, 5, v0
v_lshl_add_u32 v242, v242, 7, s33
v_min_u32 v242, L_fin-L_pc, v242
v_mov_b32 v243, s45
v_add_co_u32 v242, vcc, s44, v242
s_nop 1
v_addc_co_u32 v243, vcc, 0, v243, vcc
global_load_dword v240, v[242:243], off
s_mov_b32 m0, s22
s_nop 0
buffer_load_dwordx4 v232, s[8:11], s21 offen nt lds
buffer_load_dwordx4 v232, s[8:11], s21 offen offset:1024 nt lds
s_mov_b32 m0, s23
s_nop 0
buffer_load_dwordx4 v3, s[12:15], s21 offen nt lds
s_add_u32 m0, s23, 8
s_nop 0
buffer_load_dwordx4 v3, s[12:15], s21 offen offset:1024 nt lds
s_add_u32 s22, s22, 8192
s_and_b32 s22, s22, 0x7fff
s_add_u32 s21, s21, 8192
s_add_u32 s23, s23, 8256
s_cmp_eq_u32 s23, s35
s_cselect_b32 s23, s34, s23
s_mov_b32 m0, s22
s_nop 0
buffer_load_dwordx4 v232, s[8:11], s21 offen nt lds
buffer_load_dwordx4 v232, s[8:11], s21 offen offset:1024 nt lds
s_mov_b32 m0, s23
s_nop 0
buffer_load_dwordx4 v3, s[12:15], s21 offen nt lds
s_add_u32 m0, s23, 8
s_nop 0
buffer_load_dwordx4 v3, s[12:15], s21 offen offset:1024 nt lds
s_add_u32 s22, s22, 8192
s_and_b32 s22, s22, 0x7fff
s_add_u32 s21, s21, 8192
s_add_u32 s23, s23, 8256
s_cmp_eq_u32 s23, s35
s_cselect_b32 s23, s34, s23
s_add_u32 m0, s46, 0
s_add_u32 s32, s27, 0
buffer_load_dwordx4 v3, s[4:7], s32 offen offset:0 nt lds
buffer_load_dwordx4 v3, s[4:7], s32 offen offset:1024 nt lds
buffer_load_dwordx4 v4, s[4:7], s32 offen offset:2048 nt lds
buffer_load_dwordx4 v4, s[4:7], s32 offen offset:3072 nt lds
v_lshlrev_b32 v1, 10, v202
v_and_b32 v202, 3, v200
v_lshl_add_u32 v1, v202, 6, v1
v_lshl_add_u32 v8, v201, 4, v1
v_add_u32 v8, s46, v8
v_lshrrev_b32 v203, 3, v200
v_lshlrev_b32 v203, 1, v203
v_xor_b32 v203, v203, v201
v_lshl_add_u32 v1, v203, 4, v1
v_add_u32 v8, s46, v1
v_mul_u32_u24 v2, 1032, v201
v_lshl_add_u32 v2, v200, 4, v2
v_add_u32 v2, 32768, v2
v_mov_b32 v202, v200
v_and_b32 v203, 7, v202
v_xor_b32 v203, v203, v201
v_lshlrev_b32 v203, 4, v203
v_lshl_add_u32 v203, v202, 8, v203
v_add_u32 v233, s46, v203
v_xor_b32 v203, 64, v203
v_add_u32 v234, s46, v203
v_xor_b32 v203, v200, v201
v_lshlrev_b32 v203, 4, v203
v_lshl_add_u32 v203, v201, 8, v203
v_add_u32 v235, s46, v203
v_xor_b32 v203, 64, v203
v_add_u32 v236, s46, v203
v_lshlrev_b32 v237, 4, v0
v_mov_b32 v7, 1.0
v_mov_b32 v9, 0
v_mov_b32 v228, 0
v_mov_b32 v229, 0
v_mov_b32 v230, 0
v_mov_b32 v231, 0
s_add_u32 s25, s27, 188416
s_mov_b32 s26, s46
s_mov_b32 s37, 1024
s_mov_b32 s36, 6
s_mov_b32 s38, 0x3e0293ee
s_mov_b32 s39, 0x3e0293ee
s_mov_b32 s31, 0xffff0000
s_mov_b32 s29, 0
s_mov_b32 s30, 16512
s_mov_b32 s47, 0x2b800000
s_mov_b32 s24, 0
s_mov_b32 s91, 0
s_mov_b32 s3, s27
s_mov_b64 exec, 0
s_cmp_eq_u32 s20, 0
s_cbranch_scc1 L_padhead0
s_cmp_eq_u32 s20, 1
s_cbranch_scc1 L_padhead1
s_cmp_eq_u32 s20, 2
s_cbranch_scc1 L_padhead2
s_branch L_padhead3
L_padret:
s_mov_b64 exec, -1
s_cmp_eq_u32 s20, 3
s_cbranch_scc1 L_varB
s_branch L_varA
.p2align 12
L_varA:
s_mov_b32 s101, 6
s_waitcnt vmcnt(8)
s_add_u32 m0, s46, 4096
s_add_u32 s32, s27, 4096
buffer_load_dwordx4 v3, s[4:7], s32 offen offset:0 nt lds
buffer_load_dwordx4 v3, s[4:7], s32 offen offset:1024 nt lds
buffer_load_dwordx4 v4, s[4:7], s32 offen offset:2048 nt lds
buffer_load_dwordx4 v4, s[4:7], s32 offen offset:3072 nt lds
s_waitcnt vmcnt(8)
s_barrier
ds_read_b128 a[192:195], v1 offset:0
ds_read_b128 a[196:199], v1 offset:256
ds_read_b128 a[200:203], v1 offset:512
ds_read_b128 a[204:207], v1 offset:768
ds_read_b128 a[208:211], v1 offset:4096
ds_read_b128 a[212:215], v1 offset:4352
ds_read_b128 a[216:219], v1 offset:4608
ds_read_b128 a[220:223], v1 offset:4864
s_waitcnt vmcnt(4)
ds_read_b128 v[16:19], v8 offset:0
ds_read_b128 v[20:23], v8 offset:256
ds_read_b128 v[24:27], v8 offset:512
ds_read_b128 v[28:31], v8 offset:768
ds_read_b128 a[224:227], v1 offset:8192
ds_read_b128 a[228:231], v1 offset:8448
ds_read_b128 a[232:235], v1 offset:8704
ds_read_b128 a[236:239], v1 offset:8960
ds_read_b128 a[240:243], v1 offset:12288
ds_read_b128 a[244:247], v1 offset:12544
ds_read_b128 a[248:251], v1 offset:12800
ds_read_b128 a[252:255], v1 offset:13056
s_add_u32 m0, s46, 8192
s_add_u32 s32, s27, 8192
buffer_load_dwordx4 v3, s[4:7], s32 offen offset:0 nt lds
buffer_load_dwordx4 v3, s[4:7], s32 offen offset:1024 nt lds
buffer_load_dwordx4 v4, s[4:7], s32 offen offset:2048 nt lds
buffer_load_dwordx4 v4, s[4:7], s32 offen offset:3072 nt lds
s_waitcnt lgkmcnt(8)
v_lshlrev_b32 v220, 16, v16
v_and_b32 v221, s31, v16
v_lshlrev_b32 v222, 16, v17
v_and_b32 v223, s31, v17
ds_read_b64_tr_b16 a[128:129], v2 offset:0
v_pk_mul_f32 v[220:221], v[220:221], s[38:39]
v_pk_mul_f32 v[222:223], v[222:223], s[38:39]
v_cvt_pk_bf16_f32 v16, v220, v221
v_cvt_pk_bf16_f32 v17, v222, v223
ds_read_b64_tr_b16 a[130:131], v2 offset:4128
v_lshlrev_b32 v224, 16, v18
v_and_b32 v225, s31, v18
v_lshlrev_b32 v226, 16, v19
v_and_b32 v227, s31, v19
ds_read_b64_tr_b16 a[132:133], v2 offset:8
v_pk_mul_f32 v[224:225], v[224:225], s[38:39]
v_pk_mul_f32 v[226:227], v[226:227], s[38:39]
v_cvt_pk_bf16_f32 v18, v224, v225
v_cvt_pk_bf16_f32 v19, v226, v227
ds_read_b64_tr_b16 a[134:135], v2 offset:4136
v_lshlrev_b32 v220, 16, v20
v_and_b32 v221, s31, v20
v_lshlrev_b32 v222, 16, v21
v_and_b32 v223, s31, v21
ds_read_b64_tr_b16 a[136:137], v2 offset:256
v_pk_mul_f32 v[220:221], v[220:221], s[38:39]
v_pk_mul_f32 v[222:223], v[222:223], s[38:39]
v_cvt_pk_bf16_f32 v20, v220, v221
v_cvt_pk_bf16_f32 v21, v222, v223
ds_read_b64_tr_b16 a[138:139], v2 offset:4384
v_lshlrev_b32 v224, 16, v22
v_and_b32 v225, s31, v22
v_lshlrev_b32 v226, 16, v23
v_and_b32 v227, s31, v23
ds_read_b64_tr_b16 a[140:141], v2 offset:264
v_pk_mul_f32 v[224:225], v[224:225], s[38:39]
v_pk_mul_f32 v[226:227], v[226:227], s[38:39]
v_cvt_pk_bf16_f32 v22, v224, v225
v_cvt_pk_bf16_f32 v23, v226, v227
ds_read_b64_tr_b16 a[142:143], v2 offset:4392
v_lshlrev_b32 v220, 16, v24
v_and_b32 v221, s31, v24
v_lshlrev_b32 v222, 16, v25
v_and_b32 v223, s31, v25
ds_read_b64_tr_b16 a[144:145], v2 offset:512
v_pk_mul_f32 v[220:221], v[220:221], s[38:39]
v_pk_mul_f32 v[222:223], v[222:223], s[38:39]
v_cvt_pk_bf16_f32 v24, v220, v221
v_cvt_pk_bf16_f32 v25, v222, v223
ds_read_b64_tr_b16 a[146:147], v2 offset:4640
v_lshlrev_b32 v224, 16, v26
v_and_b32 v225, s31, v26
v_lshlrev_b32 v226, 16, v27
v_and_b32 v227, s31, v27
ds_read_b64_tr_b16 a[148:149], v2 offset:520
v_pk_mul_f32 v[224:225], v[224:225], s[38:39]
v_pk_mul_f32 v[226:227], v[226:227], s[38:39]
v_cvt_pk_bf16_f32 v26, v224, v225
v_cvt_pk_bf16_f32 v27, v226, v227
ds_read_b64_tr_b16 a[150:151], v2 offset:4648
v_lshlrev_b32 v220, 16, v28
v_and_b32 v221, s31, v28
v_lshlrev_b32 v222, 16, v29
v_and_b32 v223, s31, v29
ds_read_b64_tr_b16 a[152:153], v2 offset:768
v_pk_mul_f32 v[220:221], v[220:221], s[38:39]
v_pk_mul_f32 v[222:223], v[222:223], s[38:39]
v_cvt_pk_bf16_f32 v28, v220, v221
v_cvt_pk_bf16_f32 v29, v222, v223
ds_read_b64_tr_b16 a[154:155], v2 offset:4896
v_lshlrev_b32 v224, 16, v30
v_and_b32 v225, s31, v30
v_lshlrev_b32 v226, 16, v31
v_and_b32 v227, s31, v31
ds_read_b64_tr_b16 a[156:157], v2 offset:776
v_pk_mul_f32 v[224:225], v[224:225], s[38:39]
v_pk_mul_f32 v[226:227], v[226:227], s[38:39]
v_cvt_pk_bf16_f32 v30, v224, v225
v_cvt_pk_bf16_f32 v31, v226, v227
ds_read_b64_tr_b16 a[158:159], v2 offset:4904
v_mov_b32 v10, 0
s_waitcnt lgkmcnt(14)
v_mfma_f32_16x16x32_bf16 v[176:179], a[192:195], v[16:19], -4.0
ds_read_b64_tr_b16 a[160:161], v2 offset:8256
ds_read_b64_tr_b16 a[162:163], v2 offset:12384
v_mfma_f32_16x16x32_bf16 v[176:179], a[196:199], v[20:23], v[176:179]
ds_read_b64_tr_b16 a[164:165], v2 offset:8264
ds_read_b64_tr_b16 a[166:167], v2 offset:12392
v_mfma_f32_16x16x32_bf16 v[176:179], a[200:203], v[24:27], v[176:179]
ds_read_b64_tr_b16 a[168:169], v2 offset:8512
ds_read_b64_tr_b16 a[170:171], v2 offset:12640
v_mfma_f32_16x16x32_bf16 v[176:179], a[204:207], v[28:31], v[176:179]
ds_read_b64_tr_b16 a[172:173], v2 offset:8520
ds_read_b64_tr_b16 a[174:175], v2 offset:12648
v_mfma_f32_16x16x32_bf16 v[180:183], a[208:211], v[16:19], -4.0
ds_read_b64_tr_b16 a[176:177], v2 offset:8768
ds_read_b64_tr_b16 a[178:179], v2 offset:12896
v_mfma_f32_16x16x32_bf16 v[180:183], a[212:215], v[20:23], v[180:183]
ds_read_b64_tr_b16 a[180:181], v2 offset:8776
ds_read_b64_tr_b16 a[182:183], v2 offset:12904
v_mfma_f32_16x16x32_bf16 v[180:183], a[216:219], v[24:27], v[180:183]
ds_read_b64_tr_b16 a[184:185], v2 offset:9024
ds_read_b64_tr_b16 a[186:187], v2 offset:13152
v_mfma_f32_16x16x32_bf16 v[180:183], a[220:223], v[28:31], v[180:183]
ds_read_b64_tr_b16 a[188:189], v2 offset:9032
ds_read_b64_tr_b16 a[190:191], v2 offset:13160
v_exp_f32 v176, v176
v_exp_f32 v177, v177
v_exp_f32 v178, v178
v_exp_f32 v179, v179
s_nop 1
v_exp_f32 v180, v180
v_add_f32 v6, v176, v177
v_cvt_pk_bf16_f32 v192, v176, v177
v_add_f32 v6, v6, v178
v_cvt_pk_bf16_f32 v193, v178, v179
v_add_f32 v6, v6, v179
s_waitcnt lgkmcnt(0)
v_mfma_f32_16x16x32_bf16 v[184:187], a[224:227], v[16:19], -4.0
v_add_f32 v10, v10, v180
v_add_f32 v10, v10, v6
v_mfma_f32_16x16x32_bf16 v[184:187], a[228:231], v[20:23], v[184:187]
v_exp_f32 v181, v181
v_mfma_f32_16x16x32_bf16 v[184:187], a[232:235], v[24:27], v[184:187]
v_cvt_pk_bf16_f32 v194, v180, v181
v_add_f32 v10, v10, v181
v_mfma_f32_16x16x32_bf16 v[184:187], a[236:239], v[28:31], v[184:187]
v_exp_f32 v182, v182
v_mfma_f32_16x16x32_bf16 v[188:191], a[240:243], v[16:19], -4.0
v_add_f32 v10, v10, v182
v_mfma_f32_16x16x32_bf16 v[188:191], a[244:247], v[20:23], v[188:191]
v_exp_f32 v183, v183
v_mfma_f32_16x16x32_bf16 v[188:191], a[248:251], v[24:27], v[188:191]
v_cvt_pk_bf16_f32 v195, v182, v183
v_add_f32 v10, v10, v183
v_mfma_f32_16x16x32_bf16 v[188:191], a[252:255], v[28:31], v[188:191]
v_exp_f32 v184, v184
v_mfma_f32_16x16x32_bf16 a[0:3], a[128:131], v[192:195], 0
v_add_f32 v10, v10, v184
v_mfma_f32_16x16x32_bf16 a[4:7], a[132:135], v[192:195], 0
v_exp_f32 v185, v185
v_mfma_f32_16x16x32_bf16 a[8:11], a[136:139], v[192:195], 0
v_cvt_pk_bf16_f32 v196, v184, v185
v_add_f32 v10, v10, v185
v_mfma_f32_16x16x32_bf16 a[12:15], a[140:143], v[192:195], 0
v_exp_f32 v186, v186
v_mfma_f32_16x16x32_bf16 a[16:19], a[144:147], v[192:195], 0
v_add_f32 v10, v10, v186
v_mfma_f32_16x16x32_bf16 a[20:23], a[148:151], v[192:195], 0
v_exp_f32 v187, v187
v_mfma_f32_16x16x32_bf16 a[24:27], a[152:155], v[192:195], 0
v_cvt_pk_bf16_f32 v197, v186, v187
v_add_f32 v10, v10, v187
v_mfma_f32_16x16x32_bf16 a[28:31], a[156:159], v[192:195], 0
v_exp_f32 v188, v188
s_barrier
s_waitcnt vmcnt(4)
ds_read_b128 v[32:35], v8 offset:4096
ds_read_b128 v[36:39], v8 offset:4352
ds_read_b128 v[40:43], v8 offset:4608
ds_read_b128 v[44:47], v8 offset:4864
s_add_u32 m0, s46, 12288
s_add_u32 s32, s27, 12288
buffer_load_dwordx4 v3, s[4:7], s32 offen offset:0 nt lds
buffer_load_dwordx4 v3, s[4:7], s32 offen offset:1024 nt lds
buffer_load_dwordx4 v4, s[4:7], s32 offen offset:2048 nt lds
buffer_load_dwordx4 v4, s[4:7], s32 offen offset:3072 nt lds
s_waitcnt lgkmcnt(0)
v_lshlrev_b32 v220, 16, v32
v_and_b32 v221, s31, v32
v_lshlrev_b32 v222, 16, v33
v_and_b32 v223, s31, v33
v_pk_mul_f32 v[220:221], v[220:221], s[38:39]
v_pk_mul_f32 v[222:223], v[222:223], s[38:39]
v_cvt_pk_bf16_f32 v32, v220, v221
v_cvt_pk_bf16_f32 v33, v222, v223
v_lshlrev_b32 v224, 16, v34
v_and_b32 v225, s31, v34
v_lshlrev_b32 v226, 16, v35
v_and_b32 v227, s31, v35
v_pk_mul_f32 v[224:225], v[224:225], s[38:39]
v_pk_mul_f32 v[226:227], v[226:227], s[38:39]
v_cvt_pk_bf16_f32 v34, v224, v225
v_cvt_pk_bf16_f32 v35, v226, v227
v_lshlrev_b32 v220, 16, v36
v_and_b32 v221, s31, v36
v_lshlrev_b32 v222, 16, v37
v_and_b32 v223, s31, v37
v_pk_mul_f32 v[220:221], v[220:221], s[38:39]
v_pk_mul_f32 v[222:223], v[222:223], s[38:39]
v_cvt_pk_bf16_f32 v36, v220, v221
v_cvt_pk_bf16_f32 v37, v222, v223
v_lshlrev_b32 v224, 16, v38
v_and_b32 v225, s31, v38
v_lshlrev_b32 v226, 16, v39
v_and_b32 v227, s31, v39
v_pk_mul_f32 v[224:225], v[224:225], s[38:39]
v_pk_mul_f32 v[226:227], v[226:227], s[38:39]
v_cvt_pk_bf16_f32 v38, v224, v225
v_cvt_pk_bf16_f32 v39, v226, v227
v_lshlrev_b32 v220, 16, v40
v_and_b32 v221, s31, v40
v_lshlrev_b32 v222, 16, v41
v_and_b32 v223, s31, v41
v_pk_mul_f32 v[220:221], v[220:221], s[38:39]
v_pk_mul_f32 v[222:223], v[222:223], s[38:39]
v_cvt_pk_bf16_f32 v40, v220, v221
v_cvt_pk_bf16_f32 v41, v222, v223
v_lshlrev_b32 v224, 16, v42
v_and_b32 v225, s31, v42
v_lshlrev_b32 v226, 16, v43
v_and_b32 v227, s31, v43
v_pk_mul_f32 v[224:225], v[224:225], s[38:39]
v_pk_mul_f32 v[226:227], v[226:227], s[38:39]
v_cvt_pk_bf16_f32 v42, v224, v225
v_cvt_pk_bf16_f32 v43, v226, v227
v_lshlrev_b32 v220, 16, v44
v_and_b32 v221, s31, v44
v_lshlrev_b32 v222, 16, v45
v_and_b32 v223, s31, v45
v_pk_mul_f32 v[220:221], v[220:221], s[38:39]
v_pk_mul_f32 v[222:223], v[222:223], s[38:39]
v_cvt_pk_bf16_f32 v44, v220, v221
v_cvt_pk_bf16_f32 v45, v222, v223
v_lshlrev_b32 v224, 16, v46
v_and_b32 v225, s31, v46
v_lshlrev_b32 v226, 16, v47
v_and_b32 v227, s31, v47
v_pk_mul_f32 v[224:225], v[224:225], s[38:39]
v_pk_mul_f32 v[226:227], v[226:227], s[38:39]
v_cvt_pk_bf16_f32 v46, v224, v225
v_cvt_pk_bf16_f32 v47, v226, v227
v_mov_b32 v11, 0
s_nop 0
v_mfma_f32_16x16x32_bf16 v[176:179], a[192:195], v[32:35], -4.0
v_add_f32 v10, v10, v188
v_mfma_f32_16x16x32_bf16 v[176:179], a[196:199], v[36:39], v[176:179]
v_exp_f32 v189, v189
v_mfma_f32_16x16x32_bf16 v[176:179], a[200:203], v[40:43], v[176:179]
v_cvt_pk_bf16_f32 v198, v188, v189
v_add_f32 v10, v10, v189
v_mfma_f32_16x16x32_bf16 v[176:179], a[204:207], v[44:47], v[176:179]
v_exp_f32 v190, v190
v_mfma_f32_16x16x32_bf16 v[180:183], a[208:211], v[32:35], -4.0
v_add_f32 v10, v10, v190
v_mfma_f32_16x16x32_bf16 v[180:183], a[212:215], v[36:39], v[180:183]
v_exp_f32 v191, v191
v_mfma_f32_16x16x32_bf16 v[180:183], a[216:219], v[40:43], v[180:183]
v_cvt_pk_bf16_f32 v199, v190, v191
v_add_f32 v10, v10, v191
v_mfma_f32_16x16x32_bf16 v[180:183], a[220:223], v[44:47], v[180:183]
v_exp_f32 v176, v176
v_mfma_f32_16x16x32_bf16 a[0:3], a[160:163], v[196:199], a[0:3]
v_add_f32 v11, v11, v176
v_mfma_f32_16x16x32_bf16 a[4:7], a[164:167], v[196:199], a[4:7]
v_exp_f32 v177, v177
v_mfma_f32_16x16x32_bf16 a[8:11], a[168:171], v[196:199], a[8:11]
v_cvt_pk_bf16_f32 v192, v176, v177
v_add_f32 v11, v11, v177
v_mfma_f32_16x16x32_bf16 a[12:15], a[172:175], v[196:199], a[12:15]
v_exp_f32 v178, v178
v_mfma_f32_16x16x32_bf16 a[16:19], a[176:179], v[196:199], a[16:19]
v_add_f32 v11, v11, v178
v_mfma_f32_16x16x32_bf16 a[20:23], a[180:183], v[196:199], a[20:23]
v_exp_f32 v179, v179
v_mfma_f32_16x16x32_bf16 a[24:27], a[184:187], v[196:199], a[24:27]
v_cvt_pk_bf16_f32 v193, v178, v179
v_add_f32 v11, v11, v179
v_mfma_f32_16x16x32_bf16 a[28:31], a[188:191], v[196:199], a[28:31]
v_exp_f32 v180, v180
v_mfma_f32_16x16x32_bf16 v[184:187], a[224:227], v[32:35], -4.0
v_add_f32 v11, v11, v180
v_mfma_f32_16x16x32_bf16 v[184:187], a[228:231], v[36:39], v[184:187]
v_exp_f32 v181, v181
v_mfma_f32_16x16x32_bf16 v[184:187], a[232:235], v[40:43], v[184:187]
v_cvt_pk_bf16_f32 v194, v180, v181
v_add_f32 v11, v11, v181
v_mfma_f32_16x16x32_bf16 v[184:187], a[236:239], v[44:47], v[184:187]
v_exp_f32 v182, v182
v_mfma_f32_16x16x32_bf16 v[188:191], a[240:243], v[32:35], -4.0
v_add_f32 v11, v11, v182
v_mfma_f32_16x16x32_bf16 v[188:191], a[244:247], v[36:39], v[188:191]
v_exp_f32 v183, v183
v_mfma_f32_16x16x32_bf16 v[188:191], a[248:251], v[40:43], v[188:191]
v_cvt_pk_bf16_f32 v195, v182, v183
v_add_f32 v11, v11, v183
v_mfma_f32_16x16x32_bf16 v[188:191], a[252:255], v[44:47], v[188:191]
v_exp_f32 v184, v184
v_mfma_f32_16x16x32_bf16 a[32:35], a[128:131], v[192:195], 0
v_add_f32 v11, v11, v184
v_mfma_f32_16x16x32_bf16 a[36:39], a[132:135], v[192:195], 0
v_exp_f32 v185, v185
v_mfma_f32_16x16x32_bf16 a[40:43], a[136:139], v[192:195], 0
v_cvt_pk_bf16_f32 v196, v184, v185
v_add_f32 v11, v11, v185
v_mfma_f32_16x16x32_bf16 a[44:47], a[140:143], v[192:195], 0
v_exp_f32 v186, v186
v_mfma_f32_16x16x32_bf16 a[48:51], a[144:147], v[192:195], 0
v_add_f32 v11, v11, v186
v_mfma_f32_16x16x32_bf16 a[52:55], a[148:151], v[192:195], 0
v_exp_f32 v187, v187
v_mfma_f32_16x16x32_bf16 a[56:59], a[152:155], v[192:195], 0
v_cvt_pk_bf16_f32 v197, v186, v187
v_add_f32 v11, v11, v187
v_mfma_f32_16x16x32_bf16 a[60:63], a[156:159], v[192:195], 0
v_exp_f32 v188, v188
s_waitcnt vmcnt(4)
ds_read_b128 v[48:51], v8 offset:8192
ds_read_b128 v[52:55], v8 offset:8448
ds_read_b128 v[56:59], v8 offset:8704
ds_read_b128 v[60:63], v8 offset:8960
s_add_u32 m0, s46, 16384
s_add_u32 s32, s27, 16384
buffer_load_dwordx4 v3, s[4:7], s32 offen offset:0 nt lds
buffer_load_dwordx4 v3, s[4:7], s32 offen offset:1024 nt lds
buffer_load_dwordx4 v4, s[4:7], s32 offen offset:2048 nt lds
buffer_load_dwordx4 v4, s[4:7], s32 offen offset:3072 nt lds
s_waitcnt lgkmcnt(0)
v_lshlrev_b32 v220, 16, v48
v_and_b32 v221, s31, v48
v_lshlrev_b32 v222, 16, v49
v_and_b32 v223, s31, v49
v_pk_mul_f32 v[220:221], v[220:221], s[38:39]
v_pk_mul_f32 v[222:223], v[222:223], s[38:39]
v_cvt_pk_bf16_f32 v48, v220, v221
v_cvt_pk_bf16_f32 v49, v222, v223
v_lshlrev_b32 v224, 16, v50
v_and_b32 v225, s31, v50
v_lshlrev_b32 v226, 16, v51
v_and_b32 v227, s31, v51
v_pk_mul_f32 v[224:225], v[224:225], s[38:39]
v_pk_mul_f32 v[226:227], v[226:227], s[38:39]
v_cvt_pk_bf16_f32 v50, v224, v225
v_cvt_pk_bf16_f32 v51, v226, v227
v_lshlrev_b32 v220, 16, v52
v_and_b32 v221, s31, v52
v_lshlrev_b32 v222, 16, v53
v_and_b32 v223, s31, v53
v_pk_mul_f32 v[220:221], v[220:221], s[38:39]
v_pk_mul_f32 v[222:223], v[222:223], s[38:39]
v_cvt_pk_bf16_f32 v52, v220, v221
v_cvt_pk_bf16_f32 v53, v222, v223
v_lshlrev_b32 v224, 16, v54
v_and_b32 v225, s31, v54
v_lshlrev_b32 v226, 16, v55
v_and_b32 v227, s31, v55
v_pk_mul_f32 v[224:225], v[224:225], s[38:39]
v_pk_mul_f32 v[226:227], v[226:227], s[38:39]
v_cvt_pk_bf16_f32 v54, v224, v225
v_cvt_pk_bf16_f32 v55, v226, v227
v_lshlrev_b32 v220, 16, v56
v_and_b32 v221, s31, v56
v_lshlrev_b32 v222, 16, v57
v_and_b32 v223, s31, v57
v_pk_mul_f32 v[220:221], v[220:221], s[38:39]
v_pk_mul_f32 v[222:223], v[222:223], s[38:39]
v_cvt_pk_bf16_f32 v56, v220, v221
v_cvt_pk_bf16_f32 v57, v222, v223
v_lshlrev_b32 v224, 16, v58
v_and_b32 v225, s31, v58
v_lshlrev_b32 v226, 16, v59
v_and_b32 v227, s31, v59
v_pk_mul_f32 v[224:225], v[224:225], s[38:39]
v_pk_mul_f32 v[226:227], v[226:227], s[38:39]
v_cvt_pk_bf16_f32 v58, v224, v225
v_cvt_pk_bf16_f32 v59, v226, v227
v_lshlrev_b32 v220, 16, v60
v_and_b32 v221, s31, v60
v_lshlrev_b32 v222, 16, v61
v_and_b32 v223, s31, v61
v_pk_mul_f32 v[220:221], v[220:221], s[38:39]
v_pk_mul_f32 v[222:223], v[222:223], s[38:39]
v_cvt_pk_bf16_f32 v60, v220, v221
v_cvt_pk_bf16_f32 v61, v222, v223
v_lshlrev_b32 v224, 16, v62
v_and_b32 v225, s31, v62
v_lshlrev_b32 v226, 16, v63
v_and_b32 v227, s31, v63
v_pk_mul_f32 v[224:225], v[224:225], s[38:39]
v_pk_mul_f32 v[226:227], v[226:227], s[38:39]
v_cvt_pk_bf16_f32 v62, v224, v225
v_cvt_pk_bf16_f32 v63, v226, v227
v_mov_b32 v12, 0
s_nop 0
v_mfma_f32_16x16x32_bf16 v[176:179], a[192:195], v[48:51], -4.0
v_add_f32 v11, v11, v188
v_mfma_f32_16x16x32_bf16 v[176:179], a[196:199], v[52:55], v[176:179]
v_exp_f32 v189, v189
v_mfma_f32_16x16x32_bf16 v[176:179], a[200:203], v[56:59], v[176:179]
v_cvt_pk_bf16_f32 v198, v188, v189
v_add_f32 v11, v11, v189
v_mfma_f32_16x16x32_bf16 v[176:179], a[204:207], v[60:63], v[176:179]
v_exp_f32 v190, v190
v_mfma_f32_16x16x32_bf16 v[180:183], a[208:211], v[48:51], -4.0
v_add_f32 v11, v11, v190
v_mfma_f32_16x16x32_bf16 v[180:183], a[212:215], v[52:55], v[180:183]
v_exp_f32 v191, v191
v_mfma_f32_16x16x32_bf16 v[180:183], a[216:219], v[56:59], v[180:183]
v_cvt_pk_bf16_f32 v199, v190, v191
v_add_f32 v11, v11, v191
v_mfma_f32_16x16x32_bf16 v[180:183], a[220:223], v[60:63], v[180:183]
v_exp_f32 v176, v176
v_mfma_f32_16x16x32_bf16 a[32:35], a[160:163], v[196:199], a[32:35]
v_add_f32 v12, v12, v176
v_mfma_f32_16x16x32_bf16 a[36:39], a[164:167], v[196:199], a[36:39]
v_exp_f32 v177, v177
v_mfma_f32_16x16x32_bf16 a[40:43], a[168:171], v[196:199], a[40:43]
v_cvt_pk_bf16_f32 v192, v176, v177
v_add_f32 v12, v12, v177
v_mfma_f32_16x16x32_bf16 a[44:47], a[172:175], v[196:199], a[44:47]
v_exp_f32 v178, v178
v_mfma_f32_16x16x32_bf16 a[48:51], a[176:179], v[196:199], a[48:51]
v_add_f32 v12, v12, v178
v_mfma_f32_16x16x32_bf16 a[52:55], a[180:183], v[196:199], a[52:55]
v_exp_f32 v179, v179
v_mfma_f32_16x16x32_bf16 a[56:59], a[184:187], v[196:199], a[56:59]
v_cvt_pk_bf16_f32 v193, v178, v179
v_add_f32 v12, v12, v179
v_mfma_f32_16x16x32_bf16 a[60:63], a[188:191], v[196:199], a[60:63]
v_exp_f32 v180, v180
v_mfma_f32_16x16x32_bf16 v[184:187], a[224:227], v[48:51], -4.0
v_add_f32 v12, v12, v180
v_mfma_f32_16x16x32_bf16 v[184:187], a[228:231], v[52:55], v[184:187]
v_exp_f32 v181, v181
v_mfma_f32_16x16x32_bf16 v[184:187], a[232:235], v[56:59], v[184:187]
v_cvt_pk_bf16_f32 v194, v180, v181
v_add_f32 v12, v12, v181
v_mfma_f32_16x16x32_bf16 v[184:187], a[236:239], v[60:63], v[184:187]
v_exp_f32 v182, v182
v_mfma_f32_16x16x32_bf16 v[188:191], a[240:243], v[48:51], -4.0
v_add_f32 v12, v12, v182
v_mfma_f32_16x16x32_bf16 v[188:191], a[244:247], v[52:55], v[188:191]
v_exp_f32 v183, v183
v_mfma_f32_16x16x32_bf16 v[188:191], a[248:251], v[56:59], v[188:191]
v_cvt_pk_bf16_f32 v195, v182, v183
v_add_f32 v12, v12, v183
v_mfma_f32_16x16x32_bf16 v[188:191], a[252:255], v[60:63], v[188:191]
v_exp_f32 v184, v184
v_mfma_f32_16x16x32_bf16 a[64:67], a[128:131], v[192:195], 0
v_add_f32 v12, v12, v184
v_mfma_f32_16x16x32_bf16 a[68:71], a[132:135], v[192:195], 0
v_exp_f32 v185, v185
v_mfma_f32_16x16x32_bf16 a[72:75], a[136:139], v[192:195], 0
v_cvt_pk_bf16_f32 v196, v184, v185
v_add_f32 v12, v12, v185
v_mfma_f32_16x16x32_bf16 a[76:79], a[140:143], v[192:195], 0
v_exp_f32 v186, v186
v_mfma_f32_16x16x32_bf16 a[80:83], a[144:147], v[192:195], 0
v_add_f32 v12, v12, v186
v_mfma_f32_16x16x32_bf16 a[84:87], a[148:151], v[192:195], 0
v_exp_f32 v187, v187
v_mfma_f32_16x16x32_bf16 a[88:91], a[152:155], v[192:195], 0
v_cvt_pk_bf16_f32 v197, v186, v187
v_add_f32 v12, v12, v187
v_mfma_f32_16x16x32_bf16 a[92:95], a[156:159], v[192:195], 0
v_exp_f32 v188, v188
s_waitcnt vmcnt(4)
ds_read_b128 v[64:67], v8 offset:12288
ds_read_b128 v[68:71], v8 offset:12544
ds_read_b128 v[72:75], v8 offset:12800
ds_read_b128 v[76:79], v8 offset:13056
s_add_u32 m0, s46, 20480
s_add_u32 s32, s27, 20480
buffer_load_dwordx4 v3, s[4:7], s32 offen offset:0 nt lds
buffer_load_dwordx4 v3, s[4:7], s32 offen offset:1024 nt lds
buffer_load_dwordx4 v4, s[4:7], s32 offen offset:2048 nt lds
buffer_load_dwordx4 v4, s[4:7], s32 offen offset:3072 nt lds
s_waitcnt lgkmcnt(0)
v_lshlrev_b32 v220, 16, v64
v_and_b32 v221, s31, v64
v_lshlrev_b32 v222, 16, v65
v_and_b32 v223, s31, v65
v_pk_mul_f32 v[220:221], v[220:221], s[38:39]
v_pk_mul_f32 v[222:223], v[222:223], s[38:39]
v_cvt_pk_bf16_f32 v64, v220, v221
v_cvt_pk_bf16_f32 v65, v222, v223
v_lshlrev_b32 v224, 16, v66
v_and_b32 v225, s31, v66
v_lshlrev_b32 v226, 16, v67
v_and_b32 v227, s31, v67
v_pk_mul_f32 v[224:225], v[224:225], s[38:39]
v_pk_mul_f32 v[226:227], v[226:227], s[38:39]
v_cvt_pk_bf16_f32 v66, v224, v225
v_cvt_pk_bf16_f32 v67, v226, v227
v_lshlrev_b32 v220, 16, v68
v_and_b32 v221, s31, v68
v_lshlrev_b32 v222, 16, v69
v_and_b32 v223, s31, v69
v_pk_mul_f32 v[220:221], v[220:221], s[38:39]
v_pk_mul_f32 v[222:223], v[222:223], s[38:39]
v_cvt_pk_bf16_f32 v68, v220, v221
v_cvt_pk_bf16_f32 v69, v222, v223
v_lshlrev_b32 v224, 16, v70
v_and_b32 v225, s31, v70
v_lshlrev_b32 v226, 16, v71
v_and_b32 v227, s31, v71
v_pk_mul_f32 v[224:225], v[224:225], s[38:39]
v_pk_mul_f32 v[226:227], v[226:227], s[38:39]
v_cvt_pk_bf16_f32 v70, v224, v225
v_cvt_pk_bf16_f32 v71, v226, v227
v_lshlrev_b32 v220, 16, v72
v_and_b32 v221, s31, v72
v_lshlrev_b32 v222, 16, v73
v_and_b32 v223, s31, v73
v_pk_mul_f32 v[220:221], v[220:221], s[38:39]
v_pk_mul_f32 v[222:223], v[222:223], s[38:39]
v_cvt_pk_bf16_f32 v72, v220, v221
v_cvt_pk_bf16_f32 v73, v222, v223
v_lshlrev_b32 v224, 16, v74
v_and_b32 v225, s31, v74
v_lshlrev_b32 v226, 16, v75
v_and_b32 v227, s31, v75
v_pk_mul_f32 v[224:225], v[224:225], s[38:39]
v_pk_mul_f32 v[226:227], v[226:227], s[38:39]
v_cvt_pk_bf16_f32 v74, v224, v225
v_cvt_pk_bf16_f32 v75, v226, v227
v_lshlrev_b32 v220, 16, v76
v_and_b32 v221, s31, v76
v_lshlrev_b32 v222, 16, v77
v_and_b32 v223, s31, v77
v_pk_mul_f32 v[220:221], v[220:221], s[38:39]
v_pk_mul_f32 v[222:223], v[222:223], s[38:39]
v_cvt_pk_bf16_f32 v76, v220, v221
v_cvt_pk_bf16_f32 v77, v222, v223
v_lshlrev_b32 v224, 16, v78
v_and_b32 v225, s31, v78
v_lshlrev_b32 v226, 16, v79
v_and_b32 v227, s31, v79
v_pk_mul_f32 v[224:225], v[224:225], s[38:39]
v_pk_mul_f32 v[226:227], v[226:227], s[38:39]
v_cvt_pk_bf16_f32 v78, v224, v225
v_cvt_pk_bf16_f32 v79, v226, v227
v_mov_b32 v13, 0
s_nop 0
v_mfma_f32_16x16x32_bf16 v[176:179], a[192:195], v[64:67], -4.0
v_add_f32 v12, v12, v188
v_mfma_f32_16x16x32_bf16 v[176:179], a[196:199], v[68:71], v[176:179]
v_exp_f32 v189, v189
v_mfma_f32_16x16x32_bf16 v[176:179], a[200:203], v[72:75], v[176:179]
v_cvt_pk_bf16_f32 v198, v188, v189
v_add_f32 v12, v12, v189
v_mfma_f32_16x16x32_bf16 v[176:179], a[204:207], v[76:79], v[176:179]
v_exp_f32 v190, v190
v_mfma_f32_16x16x32_bf16 v[180:183], a[208:211], v[64:67], -4.0
v_add_f32 v12, v12, v190
v_mfma_f32_16x16x32_bf16 v[180:183], a[212:215], v[68:71], v[180:183]
v_exp_f32 v191, v191
v_mfma_f32_16x16x32_bf16 v[180:183], a[216:219], v[72:75], v[180:183]
v_cvt_pk_bf16_f32 v199, v190, v191
v_add_f32 v12, v12, v191
v_mfma_f32_16x16x32_bf16 v[180:183], a[220:223], v[76:79], v[180:183]
v_exp_f32 v176, v176
v_mfma_f32_16x16x32_bf16 a[64:67], a[160:163], v[196:199], a[64:67]
v_add_f32 v13, v13, v176
v_mfma_f32_16x16x32_bf16 a[68:71], a[164:167], v[196:199], a[68:71]
v_exp_f32 v177, v177
v_mfma_f32_16x16x32_bf16 a[72:75], a[168:171], v[196:199], a[72:75]
v_cvt_pk_bf16_f32 v192, v176, v177
v_add_f32 v13, v13, v177
v_mfma_f32_16x16x32_bf16 a[76:79], a[172:175], v[196:199], a[76:79]
v_exp_f32 v178, v178
v_mfma_f32_16x16x32_bf16 a[80:83], a[176:179], v[196:199], a[80:83]
v_add_f32 v13, v13, v178
v_mfma_f32_16x16x32_bf16 a[84:87], a[180:183], v[196:199], a[84:87]
v_exp_f32 v179, v179
v_mfma_f32_16x16x32_bf16 a[88:91], a[184:187], v[196:199], a[88:91]
v_cvt_pk_bf16_f32 v193, v178, v179
v_add_f32 v13, v13, v179
v_mfma_f32_16x16x32_bf16 a[92:95], a[188:191], v[196:199], a[92:95]
v_exp_f32 v180, v180
v_mfma_f32_16x16x32_bf16 v[184:187], a[224:227], v[64:67], -4.0
v_add_f32 v13, v13, v180
v_mfma_f32_16x16x32_bf16 v[184:187], a[228:231], v[68:71], v[184:187]
v_exp_f32 v181, v181
v_mfma_f32_16x16x32_bf16 v[184:187], a[232:235], v[72:75], v[184:187]
v_cvt_pk_bf16_f32 v194, v180, v181
v_add_f32 v13, v13, v181
v_mfma_f32_16x16x32_bf16 v[184:187], a[236:239], v[76:79], v[184:187]
v_exp_f32 v182, v182
v_mfma_f32_16x16x32_bf16 v[188:191], a[240:243], v[64:67], -4.0
v_add_f32 v13, v13, v182
v_mfma_f32_16x16x32_bf16 v[188:191], a[244:247], v[68:71], v[188:191]
v_exp_f32 v183, v183
v_mfma_f32_16x16x32_bf16 v[188:191], a[248:251], v[72:75], v[188:191]
v_cvt_pk_bf16_f32 v195, v182, v183
v_add_f32 v13, v13, v183
v_mfma_f32_16x16x32_bf16 v[188:191], a[252:255], v[76:79], v[188:191]
v_exp_f32 v184, v184
v_mfma_f32_16x16x32_bf16 a[96:99], a[128:131], v[192:195], 0
v_add_f32 v13, v13, v184
v_mfma_f32_16x16x32_bf16 a[100:103], a[132:135], v[192:195], 0
v_exp_f32 v185, v185
v_mfma_f32_16x16x32_bf16 a[104:107], a[136:139], v[192:195], 0
v_cvt_pk_bf16_f32 v196, v184, v185
v_add_f32 v13, v13, v185
v_mfma_f32_16x16x32_bf16 a[108:111], a[140:143], v[192:195], 0
v_exp_f32 v186, v186
v_mfma_f32_16x16x32_bf16 a[112:115], a[144:147], v[192:195], 0
v_add_f32 v13, v13, v186
v_mfma_f32_16x16x32_bf16 a[116:119], a[148:151], v[192:195], 0
v_exp_f32 v187, v187
v_mfma_f32_16x16x32_bf16 a[120:123], a[152:155], v[192:195], 0
v_cvt_pk_bf16_f32 v197, v186, v187
v_add_f32 v13, v13, v187
v_mfma_f32_16x16x32_bf16 a[124:127], a[156:159], v[192:195], 0
v_exp_f32 v188, v188
s_waitcnt vmcnt(4)
ds_read_b128 v[80:83], v8 offset:16384
ds_read_b128 v[84:87], v8 offset:16640
ds_read_b128 v[88:91], v8 offset:16896
ds_read_b128 v[92:95], v8 offset:17152
L_padhead0:
L_pad0:
s_cbranch_execz L_pad4
s_mov_b32 m0, s22
s_nop 0
buffer_load_dwordx4 v232, s[8:11], s21 offen nt lds
buffer_load_dwordx4 v232, s[8:11], s21 offen offset:1024 nt lds
s_mov_b32 m0, s23
s_nop 0
buffer_load_dwordx4 v3, s[12:15], s21 offen nt lds
s_add_u32 m0, s23, 8
s_nop 0
buffer_load_dwordx4 v3, s[12:15], s21 offen offset:1024 nt lds
s_add_u32 s22, s22, 8192
s_and_b32 s22, s22, 0x7fff
s_add_u32 s21, s21, 8192
s_add_u32 s23, s23, 8256
s_cmp_eq_u32 s23, s35
s_cselect_b32 s23, s34, s23
s_waitcnt lgkmcnt(0)
v_lshlrev_b32 v220, 16, v80
v_and_b32 v221, s31, v80
v_lshlrev_b32 v222, 16, v81
v_and_b32 v223, s31, v81
v_pk_mul_f32 v[220:221], v[220:221], s[38:39]
v_pk_mul_f32 v[222:223], v[222:223], s[38:39]
v_cvt_pk_bf16_f32 v80, v220, v221
v_cvt_pk_bf16_f32 v81, v222, v223
v_lshlrev_b32 v224, 16, v82
v_and_b32 v225, s31, v82
v_lshlrev_b32 v226, 16, v83
v_and_b32 v227, s31, v83
v_pk_mul_f32 v[224:225], v[224:225], s[38:39]
v_pk_mul_f32 v[226:227], v[226:227], s[38:39]
v_cvt_pk_bf16_f32 v82, v224, v225
v_cvt_pk_bf16_f32 v83, v226, v227
v_lshlrev_b32 v220, 16, v84
v_and_b32 v221, s31, v84
v_lshlrev_b32 v222, 16, v85
v_and_b32 v223, s31, v85
v_pk_mul_f32 v[220:221], v[220:221], s[38:39]
v_pk_mul_f32 v[222:223], v[222:223], s[38:39]
v_cvt_pk_bf16_f32 v84, v220, v221
v_cvt_pk_bf16_f32 v85, v222, v223
v_lshlrev_b32 v224, 16, v86
v_and_b32 v225, s31, v86
v_lshlrev_b32 v226, 16, v87
v_and_b32 v227, s31, v87
v_pk_mul_f32 v[224:225], v[224:225], s[38:39]
v_pk_mul_f32 v[226:227], v[226:227], s[38:39]
v_cvt_pk_bf16_f32 v86, v224, v225
v_cvt_pk_bf16_f32 v87, v226, v227
v_lshlrev_b32 v220, 16, v88
v_and_b32 v221, s31, v88
v_lshlrev_b32 v222, 16, v89
v_and_b32 v223, s31, v89
v_pk_mul_f32 v[220:221], v[220:221], s[38:39]
v_pk_mul_f32 v[222:223], v[222:223], s[38:39]
v_cvt_pk_bf16_f32 v88, v220, v221
v_cvt_pk_bf16_f32 v89, v222, v223
v_lshlrev_b32 v224, 16, v90
v_and_b32 v225, s31, v90
v_lshlrev_b32 v226, 16, v91
v_and_b32 v227, s31, v91
v_pk_mul_f32 v[224:225], v[224:225], s[38:39]
v_pk_mul_f32 v[226:227], v[226:227], s[38:39]
v_cvt_pk_bf16_f32 v90, v224, v225
v_cvt_pk_bf16_f32 v91, v226, v227
v_lshlrev_b32 v220, 16, v92
v_and_b32 v221, s31, v92
v_lshlrev_b32 v222, 16, v93
v_and_b32 v223, s31, v93
v_pk_mul_f32 v[220:221], v[220:221], s[38:39]
v_pk_mul_f32 v[222:223], v[222:223], s[38:39]
v_cvt_pk_bf16_f32 v92, v220, v221
v_cvt_pk_bf16_f32 v93, v222, v223
v_lshlrev_b32 v224, 16, v94
v_and_b32 v225, s31, v94
v_lshlrev_b32 v226, 16, v95
v_and_b32 v227, s31, v95
v_pk_mul_f32 v[224:225], v[224:225], s[38:39]
v_pk_mul_f32 v[226:227], v[226:227], s[38:39]
v_cvt_pk_bf16_f32 v94, v224, v225
v_cvt_pk_bf16_f32 v95, v226, v227
v_mov_b32 v14, 0
s_nop 0
v_mfma_f32_16x16x32_bf16 v[176:179], a[192:195], v[80:83], -4.0
v_add_f32 v13, v13, v188
v_mfma_f32_16x16x32_bf16 v[176:179], a[196:199], v[84:87], v[176:179]
v_exp_f32 v189, v189
v_mfma_f32_16x16x32_bf16 v[176:179], a[200:203], v[88:91], v[176:179]
v_cvt_pk_bf16_f32 v198, v188, v189
v_add_f32 v13, v13, v189
v_mfma_f32_16x16x32_bf16 v[176:179], a[204:207], v[92:95], v[176:179]
v_exp_f32 v190, v190
v_mfma_f32_16x16x32_bf16 v[180:183], a[208:211], v[80:83], -4.0
v_add_f32 v13, v13, v190
v_mfma_f32_16x16x32_bf16 v[180:183], a[212:215], v[84:87], v[180:183]
v_exp_f32 v191, v191
v_mfma_f32_16x16x32_bf16 v[180:183], a[216:219], v[88:91], v[180:183]
v_cvt_pk_bf16_f32 v199, v190, v191
v_add_f32 v13, v13, v191
v_mfma_f32_16x16x32_bf16 v[180:183], a[220:223], v[92:95], v[180:183]
v_exp_f32 v176, v176
v_mfma_f32_16x16x32_bf16 a[96:99], a[160:163], v[196:199], a[96:99]
v_add_f32 v14, v14, v176
v_mfma_f32_16x16x32_bf16 a[100:103], a[164:167], v[196:199], a[100:103]
v_exp_f32 v177, v177
v_mfma_f32_16x16x32_bf16 a[104:107], a[168:171], v[196:199], a[104:107]
v_cvt_pk_bf16_f32 v192, v176, v177
v_add_f32 v14, v14, v177
v_mfma_f32_16x16x32_bf16 a[108:111], a[172:175], v[196:199], a[108:111]
v_exp_f32 v178, v178
v_mfma_f32_16x16x32_bf16 a[112:115], a[176:179], v[196:199], a[112:115]
v_add_f32 v14, v14, v178
v_mfma_f32_16x16x32_bf16 a[116:119], a[180:183], v[196:199], a[116:119]
v_exp_f32 v179, v179
v_mfma_f32_16x16x32_bf16 a[120:123], a[184:187], v[196:199], a[120:123]
v_cvt_pk_bf16_f32 v193, v178, v179
v_add_f32 v14, v14, v179
v_mfma_f32_16x16x32_bf16 a[124:127], a[188:191], v[196:199], a[124:127]
v_exp_f32 v180, v180
v_mfma_f32_16x16x32_bf16 v[184:187], a[224:227], v[80:83], -4.0
v_add_f32 v14, v14, v180
v_xor_b32 v1, 0x4000, v1
v_mfma_f32_16x16x32_bf16 v[184:187], a[228:231], v[84:87], v[184:187]
v_exp_f32 v181, v181
v_mfma_f32_16x16x32_bf16 v[184:187], a[232:235], v[88:91], v[184:187]
v_cvt_pk_bf16_f32 v194, v180, v181
v_add_f32 v14, v14, v181
v_mfma_f32_16x16x32_bf16 v[184:187], a[236:239], v[92:95], v[184:187]
v_exp_f32 v182, v182
v_mfma_f32_16x16x32_bf16 v[188:191], a[240:243], v[80:83], -4.0
v_add_f32 v14, v14, v182
v_add_u32 v2, s30, v2
v_mfma_f32_16x16x32_bf16 v[188:191], a[244:247], v[84:87], v[188:191]
s_sub_u32 s30, 0, s30
v_exp_f32 v183, v183
v_mfma_f32_16x16x32_bf16 v[188:191], a[248:251], v[88:91], v[188:191]
v_cvt_pk_bf16_f32 v195, v182, v183
v_add_f32 v14, v14, v183
v_mfma_f32_16x16x32_bf16 v[188:191], a[252:255], v[92:95], v[188:191]
v_exp_f32 v184, v184
v_mfma_f32_16x16x32_bf16 v[112:115], a[128:131], v[192:195], 0
v_add_f32 v14, v14, v184
v_mfma_f32_16x16x32_bf16 v[116:119], a[132:135], v[192:195], 0
v_exp_f32 v185, v185
v_mfma_f32_16x16x32_bf16 v[120:123], a[136:139], v[192:195], 0
v_cvt_pk_bf16_f32 v196, v184, v185
v_add_f32 v14, v14, v185
v_mfma_f32_16x16x32_bf16 v[124:127], a[140:143], v[192:195], 0
v_exp_f32 v186, v186
v_mfma_f32_16x16x32_bf16 v[128:131], a[144:147], v[192:195], 0
v_add_f32 v14, v14, v186
v_mfma_f32_16x16x32_bf16 v[132:135], a[148:151], v[192:195], 0
v_exp_f32 v187, v187
v_mfma_f32_16x16x32_bf16 v[136:139], a[152:155], v[192:195], 0
v_cvt_pk_bf16_f32 v197, v186, v187
v_add_f32 v14, v14, v187
v_mfma_f32_16x16x32_bf16 v[140:143], a[156:159], v[192:195], 0
v_exp_f32 v188, v188
s_waitcnt vmcnt(4)
ds_read_b128 v[96:99], v8 offset:20480
ds_read_b128 v[100:103], v8 offset:20736
ds_read_b128 v[104:107], v8 offset:20992
ds_read_b128 v[108:111], v8 offset:21248
s_mov_b32 m0, s22
s_nop 0
buffer_load_dwordx4 v232, s[8:11], s21 offen nt lds
buffer_load_dwordx4 v232, s[8:11], s21 offen offset:1024 nt lds
s_mov_b32 m0, s23
s_nop 0
buffer_load_dwordx4 v3, s[12:15], s21 offen nt lds
s_add_u32 m0, s23, 8
s_nop 0
buffer_load_dwordx4 v3, s[12:15], s21 offen offset:1024 nt lds
s_add_u32 s22, s22, 8192
s_and_b32 s22, s22, 0x7fff
s_add_u32 s21, s21, 8192
s_add_u32 s23, s23, 8256
s_cmp_eq_u32 s23, s35
s_cselect_b32 s23, s34, s23
s_waitcnt lgkmcnt(0)
v_lshlrev_b32 v220, 16, v96
v_and_b32 v221, s31, v96
v_lshlrev_b32 v222, 16, v97
v_and_b32 v223, s31, v97
v_pk_mul_f32 v[220:221], v[220:221], s[38:39]
v_pk_mul_f32 v[222:223], v[222:223], s[38:39]
v_cvt_pk_bf16_f32 v96, v220, v221
v_cvt_pk_bf16_f32 v97, v222, v223
v_lshlrev_b32 v224, 16, v98
v_and_b32 v225, s31, v98
v_lshlrev_b32 v226, 16, v99
v_and_b32 v227, s31, v99
v_pk_mul_f32 v[224:225], v[224:225], s[38:39]
v_pk_mul_f32 v[226:227], v[226:227], s[38:39]
v_cvt_pk_bf16_f32 v98, v224, v225
v_cvt_pk_bf16_f32 v99, v226, v227
v_lshlrev_b32 v220, 16, v100
v_and_b32 v221, s31, v100
v_lshlrev_b32 v222, 16, v101
v_and_b32 v223, s31, v101
v_pk_mul_f32 v[220:221], v[220:221], s[38:39]
v_pk_mul_f32 v[222:223], v[222:223], s[38:39]
v_cvt_pk_bf16_f32 v100, v220, v221
v_cvt_pk_bf16_f32 v101, v222, v223
v_lshlrev_b32 v224, 16, v102
v_and_b32 v225, s31, v102
v_lshlrev_b32 v226, 16, v103
v_and_b32 v227, s31, v103
v_pk_mul_f32 v[224:225], v[224:225], s[38:39]
v_pk_mul_f32 v[226:227], v[226:227], s[38:39]
v_cvt_pk_bf16_f32 v102, v224, v225
v_cvt_pk_bf16_f32 v103, v226, v227
v_lshlrev_b32 v220, 16, v104
v_and_b32 v221, s31, v104
v_lshlrev_b32 v222, 16, v105
v_and_b32 v223, s31, v105
v_pk_mul_f32 v[220:221], v[220:221], s[38:39]
v_pk_mul_f32 v[222:223], v[222:223], s[38:39]
v_cvt_pk_bf16_f32 v104, v220, v221
v_cvt_pk_bf16_f32 v105, v222, v223
v_lshlrev_b32 v224, 16, v106
v_and_b32 v225, s31, v106
v_lshlrev_b32 v226, 16, v107
v_and_b32 v227, s31, v107
v_pk_mul_f32 v[224:225], v[224:225], s[38:39]
v_pk_mul_f32 v[226:227], v[226:227], s[38:39]
v_cvt_pk_bf16_f32 v106, v224, v225
v_cvt_pk_bf16_f32 v107, v226, v227
v_lshlrev_b32 v220, 16, v108
v_and_b32 v221, s31, v108
v_lshlrev_b32 v222, 16, v109
v_and_b32 v223, s31, v109
v_pk_mul_f32 v[220:221], v[220:221], s[38:39]
v_pk_mul_f32 v[222:223], v[222:223], s[38:39]
v_cvt_pk_bf16_f32 v108, v220, v221
v_cvt_pk_bf16_f32 v109, v222, v223
v_lshlrev_b32 v224, 16, v110
v_and_b32 v225, s31, v110
v_lshlrev_b32 v226, 16, v111
v_and_b32 v227, s31, v111
v_pk_mul_f32 v[224:225], v[224:225], s[38:39]
v_pk_mul_f32 v[226:227], v[226:227], s[38:39]
v_cvt_pk_bf16_f32 v110, v224, v225
v_cvt_pk_bf16_f32 v111, v226, v227
v_mov_b32 v15, 0
s_nop 0
v_mfma_f32_16x16x32_bf16 v[176:179], a[192:195], v[96:99], -4.0
v_add_f32 v14, v14, v188
v_mfma_f32_16x16x32_bf16 v[176:179], a[196:199], v[100:103], v[176:179]
v_exp_f32 v189, v189
v_mfma_f32_16x16x32_bf16 v[176:179], a[200:203], v[104:107], v[176:179]
v_cvt_pk_bf16_f32 v198, v188, v189
v_add_f32 v14, v14, v189
v_mfma_f32_16x16x32_bf16 v[176:179], a[204:207], v[108:111], v[176:179]
v_exp_f32 v190, v190
v_mfma_f32_16x16x32_bf16 v[180:183], a[208:211], v[96:99], -4.0
v_add_f32 v14, v14, v190
v_mfma_f32_16x16x32_bf16 v[180:183], a[212:215], v[100:103], v[180:183]
v_exp_f32 v191, v191
v_mfma_f32_16x16x32_bf16 v[180:183], a[216:219], v[104:107], v[180:183]
s_waitcnt vmcnt(4) lgkmcnt(0)
v_cvt_pk_bf16_f32 v199, v190, v191
v_add_f32 v14, v14, v191
v_mfma_f32_16x16x32_bf16 v[180:183], a[220:223], v[108:111], v[180:183]
s_barrier
v_exp_f32 v176, v176
v_mfma_f32_16x16x32_bf16 v[112:115], a[160:163], v[196:199], v[112:115]
ds_read_b128 a[192:195], v1 offset:0
v_add_f32 v15, v15, v176
v_mfma_f32_16x16x32_bf16 v[116:119], a[164:167], v[196:199], v[116:119]
v_exp_f32 v177, v177
v_mfma_f32_16x16x32_bf16 v[120:123], a[168:171], v[196:199], v[120:123]
v_cvt_pk_bf16_f32 v192, v176, v177
v_add_f32 v15, v15, v177
v_mfma_f32_16x16x32_bf16 v[124:127], a[172:175], v[196:199], v[124:127]
ds_read_b128 a[196:199], v1 offset:256
v_exp_f32 v178, v178
v_mfma_f32_16x16x32_bf16 v[128:131], a[176:179], v[196:199], v[128:131]
ds_read_b128 a[200:203], v1 offset:512
v_add_f32 v15, v15, v178
v_mfma_f32_16x16x32_bf16 v[132:135], a[180:183], v[196:199], v[132:135]
v_exp_f32 v179, v179
v_mfma_f32_16x16x32_bf16 v[136:139], a[184:187], v[196:199], v[136:139]
v_cvt_pk_bf16_f32 v193, v178, v179
v_add_f32 v15, v15, v179
v_mfma_f32_16x16x32_bf16 v[140:143], a[188:191], v[196:199], v[140:143]
v_exp_f32 v180, v180
v_mfma_f32_16x16x32_bf16 v[184:187], a[224:227], v[96:99], -4.0
ds_read_b128 a[204:207], v1 offset:768
v_add_f32 v15, v15, v180
v_mfma_f32_16x16x32_bf16 v[184:187], a[228:231], v[100:103], v[184:187]
v_exp_f32 v181, v181
v_mfma_f32_16x16x32_bf16 v[184:187], a[232:235], v[104:107], v[184:187]
ds_read_b128 a[208:211], v1 offset:4096
v_cvt_pk_bf16_f32 v194, v180, v181
v_add_f32 v15, v15, v181
v_mfma_f32_16x16x32_bf16 v[184:187], a[236:239], v[108:111], v[184:187]
v_exp_f32 v182, v182
v_mfma_f32_16x16x32_bf16 v[188:191], a[240:243], v[96:99], -4.0
ds_read_b128 a[212:215], v1 offset:4352
v_add_f32 v15, v15, v182
v_mfma_f32_16x16x32_bf16 v[188:191], a[244:247], v[100:103], v[188:191]
v_exp_f32 v183, v183
v_mfma_f32_16x16x32_bf16 v[188:191], a[248:251], v[104:107], v[188:191]
v_cvt_pk_bf16_f32 v195, v182, v183
v_add_f32 v15, v15, v183
v_mfma_f32_16x16x32_bf16 v[188:191], a[252:255], v[108:111], v[188:191]
v_exp_f32 v184, v184
v_mfma_f32_16x16x32_bf16 v[144:147], a[128:131], v[192:195], 0
ds_read_b128 a[216:219], v1 offset:4608
v_add_f32 v15, v15, v184
v_mfma_f32_16x16x32_bf16 v[148:151], a[132:135], v[192:195], 0
ds_read_b128 a[220:223], v1 offset:4864
v_exp_f32 v185, v185
v_mfma_f32_16x16x32_bf16 v[152:155], a[136:139], v[192:195], 0
v_cvt_pk_bf16_f32 v196, v184, v185
v_add_f32 v15, v15, v185
v_mfma_f32_16x16x32_bf16 v[156:159], a[140:143], v[192:195], 0
v_exp_f32 v186, v186
v_mfma_f32_16x16x32_bf16 v[160:163], a[144:147], v[192:195], 0
v_add_f32 v15, v15, v186
v_mfma_f32_16x16x32_bf16 v[164:167], a[148:151], v[192:195], 0
v_exp_f32 v187, v187
v_mfma_f32_16x16x32_bf16 v[168:171], a[152:155], v[192:195], 0
v_cvt_pk_bf16_f32 v197, v186, v187
v_add_f32 v15, v15, v187
v_mfma_f32_16x16x32_bf16 v[172:175], a[156:159], v[192:195], 0
s_waitcnt lgkmcnt(0)
v_exp_f32 v188, v188
v_mfma_f32_16x16x32_bf16 v[176:179], a[192:195], v[16:19], -4.0
ds_read_b64_tr_b16 a[128:129], v2 offset:0
v_add_f32 v15, v15, v188
v_mfma_f32_16x16x32_bf16 v[176:179], a[196:199], v[20:23], v[176:179]
ds_read_b64_tr_b16 a[130:131], v2 offset:4128
v_exp_f32 v189, v189
v_mfma_f32_16x16x32_bf16 v[176:179], a[200:203], v[24:27], v[176:179]
ds_read_b64_tr_b16 a[132:133], v2 offset:8
v_cvt_pk_bf16_f32 v198, v188, v189
v_add_f32 v15, v15, v189
v_mfma_f32_16x16x32_bf16 v[176:179], a[204:207], v[28:31], v[176:179]
ds_read_b64_tr_b16 a[134:135], v2 offset:4136
v_exp_f32 v190, v190
v_mfma_f32_16x16x32_bf16 v[180:183], a[208:211], v[16:19], -4.0
ds_read_b64_tr_b16 a[136:137], v2 offset:256
v_add_f32 v15, v15, v190
v_mfma_f32_16x16x32_bf16 v[180:183], a[212:215], v[20:23], v[180:183]
ds_read_b64_tr_b16 a[138:139], v2 offset:4384
v_exp_f32 v191, v191
v_mfma_f32_16x16x32_bf16 v[180:183], a[216:219], v[24:27], v[180:183]
ds_read_b64_tr_b16 a[140:141], v2 offset:264
v_cvt_pk_bf16_f32 v199, v190, v191
v_add_f32 v15, v15, v191
v_mfma_f32_16x16x32_bf16 v[180:183], a[220:223], v[28:31], v[180:183]
ds_read_b64_tr_b16 a[142:143], v2 offset:4392
v_exp_f32 v176, v176
v_mfma_f32_16x16x32_bf16 v[144:147], a[160:163], v[196:199], v[144:147]
ds_read_b64_tr_b16 a[144:145], v2 offset:512
v_mov_b32 v6, v176
v_mfma_f32_16x16x32_bf16 v[148:151], a[164:167], v[196:199], v[148:151]
ds_read_b64_tr_b16 a[146:147], v2 offset:4640
v_exp_f32 v177, v177
v_mfma_f32_16x16x32_bf16 v[152:155], a[168:171], v[196:199], v[152:155]
ds_read_b64_tr_b16 a[148:149], v2 offset:520
v_cvt_pk_bf16_f32 v192, v176, v177
v_add_f32 v6, v6, v177
v_mfma_f32_16x16x32_bf16 v[156:159], a[172:175], v[196:199], v[156:159]
ds_read_b64_tr_b16 a[150:151], v2 offset:4648
v_exp_f32 v178, v178
v_mfma_f32_16x16x32_bf16 v[160:163], a[176:179], v[196:199], v[160:163]
ds_read_b64_tr_b16 a[152:153], v2 offset:768
v_add_f32 v6, v6, v178
v_mfma_f32_16x16x32_bf16 v[164:167], a[180:183], v[196:199], v[164:167]
ds_read_b64_tr_b16 a[154:155], v2 offset:4896
v_exp_f32 v179, v179
v_mfma_f32_16x16x32_bf16 v[168:171], a[184:187], v[196:199], v[168:171]
ds_read_b64_tr_b16 a[156:157], v2 offset:776
v_cvt_pk_bf16_f32 v193, v178, v179
v_add_f32 v6, v6, v179
v_mfma_f32_16x16x32_bf16 v[172:175], a[188:191], v[196:199], v[172:175]
ds_read_b64_tr_b16 a[158:159], v2 offset:4904
v_exp_f32 v180, v180
s_waitcnt vmcnt(0)
s_mov_b32 s28, 0
.p2align 6
L_loopA:
v_mfma_f32_16x16x32_bf16 v[184:187], a[192:195], v[32:35], -4.0
v_add_f32 v10, v10, v180
v_add_f32 v10, v10, v6
v_mfma_f32_16x16x32_bf16 v[184:187], a[196:199], v[36:39], v[184:187]
v_exp_f32 v181, v181
v_mfma_f32_16x16x32_bf16 v[184:187], a[200:203], v[40:43], v[184:187]
v_cvt_pk_bf16_f32 v194, v180, v181
v_add_f32 v10, v10, v181
v_mfma_f32_16x16x32_bf16 v[184:187], a[204:207], v[44:47], v[184:187]
v_exp_f32 v182, v182
v_mfma_f32_16x16x32_bf16 v[188:191], a[208:211], v[32:35], -4.0
v_add_f32 v10, v10, v182
v_mfma_f32_16x16x32_bf16 v[188:191], a[212:215], v[36:39], v[188:191]
v_exp_f32 v183, v183
v_mfma_f32_16x16x32_bf16 v[188:191], a[216:219], v[40:43], v[188:191]
s_waitcnt lgkmcnt(0)
v_cvt_pk_bf16_f32 v195, v182, v183
v_add_f32 v10, v10, v183
v_mfma_f32_16x16x32_bf16 v[188:191], a[220:223], v[44:47], v[188:191]
s_barrier
v_exp_f32 v184, v184
v_mfma_f32_16x16x32_bf16 a[0:3], a[128:131], v[192:195], a[0:3]
ds_read_b128 a[224:227], v1 offset:8192
v_add_f32 v11, v11, v184
v_mfma_f32_16x16x32_bf16 a[4:7], a[132:135], v[192:195], a[4:7]
s_mov_b32 m0, s26
v_exp_f32 v185, v185
v_mfma_f32_16x16x32_bf16 a[8:11], a[136:139], v[192:195], a[8:11]
buffer_load_dwordx4 v3, s[4:7], s25 offen nt lds
v_cvt_pk_bf16_f32 v196, v184, v185
v_add_f32 v11, v11, v185
v_mfma_f32_16x16x32_bf16 a[12:15], a[140:143], v[192:195], a[12:15]
s_add_u32 s26, s26, s37
v_exp_f32 v186, v186
v_mfma_f32_16x16x32_bf16 a[16:19], a[144:147], v[192:195], a[16:19]
ds_read_b128 a[228:231], v1 offset:8448
v_add_f32 v11, v11, v186
v_mfma_f32_16x16x32_bf16 a[20:23], a[148:151], v[192:195], a[20:23]
s_add_u32 s25, s25, 1024
v_exp_f32 v187, v187
v_mfma_f32_16x16x32_bf16 a[24:27], a[152:155], v[192:195], a[24:27]
s_mov_b32 m0, s26
v_cvt_pk_bf16_f32 v197, v186, v187
v_add_f32 v11, v11, v187
v_mfma_f32_16x16x32_bf16 a[28:31], a[156:159], v[192:195], a[28:31]
v_exp_f32 v188, v188
v_mfma_f32_16x16x32_bf16 v[176:179], a[192:195], v[48:51], -4.0
ds_read_b128 a[232:235], v1 offset:8704
v_add_f32 v11, v11, v188
v_mfma_f32_16x16x32_bf16 v[176:179], a[196:199], v[52:55], v[176:179]
buffer_load_dwordx4 v3, s[4:7], s25 offen nt lds
v_exp_f32 v189, v189
v_mfma_f32_16x16x32_bf16 v[176:179], a[200:203], v[56:59], v[176:179]
s_add_u32 s26, s26, s37
v_cvt_pk_bf16_f32 v198, v188, v189
v_add_f32 v11, v11, v189
v_mfma_f32_16x16x32_bf16 v[176:179], a[204:207], v[60:63], v[176:179]
s_add_u32 s25, s25, 1024
v_exp_f32 v190, v190
v_mfma_f32_16x16x32_bf16 v[180:183], a[208:211], v[48:51], -4.0
ds_read_b128 a[236:239], v1 offset:8960
v_add_f32 v11, v11, v190
v_mfma_f32_16x16x32_bf16 v[180:183], a[212:215], v[52:55], v[180:183]
v_exp_f32 v191, v191
v_mfma_f32_16x16x32_bf16 v[180:183], a[216:219], v[56:59], v[180:183]
v_cvt_pk_bf16_f32 v199, v190, v191
v_add_f32 v11, v11, v191
v_mfma_f32_16x16x32_bf16 v[180:183], a[220:223], v[60:63], v[180:183]
v_exp_f32 v176, v176
v_mfma_f32_16x16x32_bf16 a[32:35], a[128:131], v[196:199], a[32:35]
ds_read_b128 a[240:243], v1 offset:12288
v_add_f32 v12, v12, v176
v_mfma_f32_16x16x32_bf16 a[36:39], a[132:135], v[196:199], a[36:39]
v_exp_f32 v177, v177
v_mfma_f32_16x16x32_bf16 a[40:43], a[136:139], v[196:199], a[40:43]
v_cvt_pk_bf16_f32 v192, v176, v177
v_add_f32 v12, v12, v177
v_mfma_f32_16x16x32_bf16 a[44:47], a[140:143], v[196:199], a[44:47]
v_exp_f32 v178, v178
v_mfma_f32_16x16x32_bf16 a[48:51], a[144:147], v[196:199], a[48:51]
ds_read_b128 a[244:247], v1 offset:12544
v_add_f32 v12, v12, v178
v_mfma_f32_16x16x32_bf16 a[52:55], a[148:151], v[196:199], a[52:55]
ds_read_b128 a[248:251], v1 offset:12800
v_exp_f32 v179, v179
v_mfma_f32_16x16x32_bf16 a[56:59], a[152:155], v[196:199], a[56:59]
v_cvt_pk_bf16_f32 v193, v178, v179
v_add_f32 v12, v12, v179
v_mfma_f32_16x16x32_bf16 a[60:63], a[156:159], v[196:199], a[60:63]
v_exp_f32 v180, v180
v_mfma_f32_16x16x32_bf16 v[184:187], a[192:195], v[64:67], -4.0
ds_read_b128 a[252:255], v1 offset:13056
v_add_f32 v12, v12, v180
v_mfma_f32_16x16x32_bf16 v[184:187], a[196:199], v[68:71], v[184:187]
v_exp_f32 v181, v181
v_mfma_f32_16x16x32_bf16 v[184:187], a[200:203], v[72:75], v[184:187]
v_cvt_pk_bf16_f32 v194, v180, v181
v_add_f32 v12, v12, v181
v_mfma_f32_16x16x32_bf16 v[184:187], a[204:207], v[76:79], v[184:187]
v_exp_f32 v182, v182
v_mfma_f32_16x16x32_bf16 v[188:191], a[208:211], v[64:67], -4.0
ds_read_b64_tr_b16 a[160:161], v2 offset:8256
v_add_f32 v12, v12, v182
v_mfma_f32_16x16x32_bf16 v[188:191], a[212:215], v[68:71], v[188:191]
v_exp_f32 v183, v183
v_mfma_f32_16x16x32_bf16 v[188:191], a[216:219], v[72:75], v[188:191]
v_cvt_pk_bf16_f32 v195, v182, v183
v_add_f32 v12, v12, v183
v_mfma_f32_16x16x32_bf16 v[188:191], a[220:223], v[76:79], v[188:191]
v_exp_f32 v184, v184
v_mfma_f32_16x16x32_bf16 a[64:67], a[128:131], v[192:195], a[64:67]
ds_read_b64_tr_b16 a[162:163], v2 offset:12384
v_add_f32 v13, v13, v184
v_mfma_f32_16x16x32_bf16 a[68:71], a[132:135], v[192:195], a[68:71]
v_exp_f32 v185, v185
v_mfma_f32_16x16x32_bf16 a[72:75], a[136:139], v[192:195], a[72:75]
v_cvt_pk_bf16_f32 v196, v184, v185
v_add_f32 v13, v13, v185
v_mfma_f32_16x16x32_bf16 a[76:79], a[140:143], v[192:195], a[76:79]
v_exp_f32 v186, v186
v_mfma_f32_16x16x32_bf16 a[80:83], a[144:147], v[192:195], a[80:83]
ds_read_b64_tr_b16 a[164:165], v2 offset:8264
v_add_f32 v13, v13, v186
v_mfma_f32_16x16x32_bf16 a[84:87], a[148:151], v[192:195], a[84:87]
v_exp_f32 v187, v187
v_mfma_f32_16x16x32_bf16 a[88:91], a[152:155], v[192:195], a[88:91]
v_cvt_pk_bf16_f32 v197, v186, v187
v_add_f32 v13, v13, v187
v_mfma_f32_16x16x32_bf16 a[92:95], a[156:159], v[192:195], a[92:95]
v_exp_f32 v188, v188
v_mfma_f32_16x16x32_bf16 v[176:179], a[192:195], v[80:83], -4.0
ds_read_b64_tr_b16 a[166:167], v2 offset:12392
v_add_f32 v13, v13, v188
v_mfma_f32_16x16x32_bf16 v[176:179], a[196:199], v[84:87], v[176:179]
v_exp_f32 v189, v189
v_mfma_f32_16x16x32_bf16 v[176:179], a[200:203], v[88:91], v[176:179]
v_cvt_pk_bf16_f32 v198, v188, v189
v_add_f32 v13, v13, v189
v_mfma_f32_16x16x32_bf16 v[176:179], a[204:207], v[92:95], v[176:179]
v_exp_f32 v190, v190
v_mfma_f32_16x16x32_bf16 v[180:183], a[208:211], v[80:83], -4.0
ds_read_b64_tr_b16 a[168:169], v2 offset:8512
v_add_f32 v13, v13, v190
v_mfma_f32_16x16x32_bf16 v[180:183], a[212:215], v[84:87], v[180:183]
v_exp_f32 v191, v191
v_mfma_f32_16x16x32_bf16 v[180:183], a[216:219], v[88:91], v[180:183]
v_cvt_pk_bf16_f32 v199, v190, v191
v_add_f32 v13, v13, v191
v_mfma_f32_16x16x32_bf16 v[180:183], a[220:223], v[92:95], v[180:183]
v_exp_f32 v176, v176
v_mfma_f32_16x16x32_bf16 a[96:99], a[128:131], v[196:199], a[96:99]
ds_read_b64_tr_b16 a[170:171], v2 offset:12640
v_add_f32 v14, v14, v176
v_mfma_f32_16x16x32_bf16 a[100:103], a[132:135], v[196:199], a[100:103]
v_exp_f32 v177, v177
v_mfma_f32_16x16x32_bf16 a[104:107], a[136:139], v[196:199], a[104:107]
v_cvt_pk_bf16_f32 v192, v176, v177
v_add_f32 v14, v14, v177
v_mfma_f32_16x16x32_bf16 a[108:111], a[140:143], v[196:199], a[108:111]
v_exp_f32 v178, v178
v_mfma_f32_16x16x32_bf16 a[112:115], a[144:147], v[196:199], a[112:115]
ds_read_b64_tr_b16 a[172:173], v2 offset:8520
v_add_f32 v14, v14, v178
v_mfma_f32_16x16x32_bf16 a[116:119], a[148:151], v[196:199], a[116:119]
v_exp_f32 v179, v179
v_mfma_f32_16x16x32_bf16 a[120:123], a[152:155], v[196:199], a[120:123]
v_cvt_pk_bf16_f32 v193, v178, v179
v_add_f32 v14, v14, v179
v_mfma_f32_16x16x32_bf16 a[124:127], a[156:159], v[196:199], a[124:127]
v_exp_f32 v180, v180
v_mfma_f32_16x16x32_bf16 v[184:187], a[192:195], v[96:99], -4.0
ds_read_b64_tr_b16 a[174:175], v2 offset:12648
v_add_f32 v14, v14, v180
v_mfma_f32_16x16x32_bf16 v[184:187], a[196:199], v[100:103], v[184:187]
v_exp_f32 v181, v181
v_mfma_f32_16x16x32_bf16 v[184:187], a[200:203], v[104:107], v[184:187]
v_cvt_pk_bf16_f32 v194, v180, v181
v_add_f32 v14, v14, v181
v_mfma_f32_16x16x32_bf16 v[184:187], a[204:207], v[108:111], v[184:187]
v_exp_f32 v182, v182
v_mfma_f32_16x16x32_bf16 v[188:191], a[208:211], v[96:99], -4.0
ds_read_b64_tr_b16 a[176:177], v2 offset:8768
v_add_f32 v14, v14, v182
v_mfma_f32_16x16x32_bf16 v[188:191], a[212:215], v[100:103], v[188:191]
v_exp_f32 v183, v183
v_mfma_f32_16x16x32_bf16 v[188:191], a[216:219], v[104:107], v[188:191]
ds_read_b64_tr_b16 a[178:179], v2 offset:12896
v_cvt_pk_bf16_f32 v195, v182, v183
v_add_f32 v14, v14, v183
v_mfma_f32_16x16x32_bf16 v[188:191], a[220:223], v[108:111], v[188:191]
v_exp_f32 v184, v184
v_mfma_f32_16x16x32_bf16 v[112:115], a[128:131], v[192:195], v[112:115]
ds_read_b64_tr_b16 a[180:181], v2 offset:8776
v_add_f32 v15, v15, v184
v_mfma_f32_16x16x32_bf16 v[116:119], a[132:135], v[192:195], v[116:119]
v_exp_f32 v185, v185
v_mfma_f32_16x16x32_bf16 v[120:123], a[136:139], v[192:195], v[120:123]
v_cvt_pk_bf16_f32 v196, v184, v185
v_add_f32 v15, v15, v185
v_mfma_f32_16x16x32_bf16 v[124:127], a[140:143], v[192:195], v[124:127]
v_exp_f32 v186, v186
v_mfma_f32_16x16x32_bf16 v[128:131], a[144:147], v[192:195], v[128:131]
ds_read_b64_tr_b16 a[182:183], v2 offset:12904
v_add_f32 v15, v15, v186
v_mfma_f32_16x16x32_bf16 v[132:135], a[148:151], v[192:195], v[132:135]
v_exp_f32 v187, v187
v_mfma_f32_16x16x32_bf16 v[136:139], a[152:155], v[192:195], v[136:139]
v_cvt_pk_bf16_f32 v197, v186, v187
v_add_f32 v15, v15, v187
v_mfma_f32_16x16x32_bf16 v[140:143], a[156:159], v[192:195], v[140:143]
s_waitcnt lgkmcnt(8)
v_exp_f32 v188, v188
v_mfma_f32_16x16x32_bf16 v[176:179], a[224:227], v[16:19], -4.0
ds_read_b64_tr_b16 a[184:185], v2 offset:9024
v_add_f32 v15, v15, v188
v_mfma_f32_16x16x32_bf16 v[176:179], a[228:231], v[20:23], v[176:179]
v_exp_f32 v189, v189
v_mfma_f32_16x16x32_bf16 v[176:179], a[232:235], v[24:27], v[176:179]
v_cvt_pk_bf16_f32 v198, v188, v189
v_add_f32 v15, v15, v189
v_mfma_f32_16x16x32_bf16 v[176:179], a[236:239], v[28:31], v[176:179]
v_exp_f32 v190, v190
v_mfma_f32_16x16x32_bf16 v[180:183], a[240:243], v[16:19], -4.0
ds_read_b64_tr_b16 a[186:187], v2 offset:13152
v_add_f32 v15, v15, v190
v_mfma_f32_16x16x32_bf16 v[180:183], a[244:247], v[20:23], v[180:183]
v_exp_f32 v191, v191
v_mfma_f32_16x16x32_bf16 v[180:183], a[248:251], v[24:27], v[180:183]
v_cvt_pk_bf16_f32 v199, v190, v191
v_add_f32 v15, v15, v191
v_mfma_f32_16x16x32_bf16 v[180:183], a[252:255], v[28:31], v[180:183]
v_exp_f32 v176, v176
v_mfma_f32_16x16x32_bf16 v[144:147], a[128:131], v[196:199], v[144:147]
ds_read_b64_tr_b16 a[188:189], v2 offset:9032
v_add_f32 v10, v10, v176
v_mfma_f32_16x16x32_bf16 v[148:151], a[132:135], v[196:199], v[148:151]
v_exp_f32 v177, v177
v_mfma_f32_16x16x32_bf16 v[152:155], a[136:139], v[196:199], v[152:155]
v_cvt_pk_bf16_f32 v192, v176, v177
v_add_f32 v10, v10, v177
v_mfma_f32_16x16x32_bf16 v[156:159], a[140:143], v[196:199], v[156:159]
v_exp_f32 v178, v178
v_mfma_f32_16x16x32_bf16 v[160:163], a[144:147], v[196:199], v[160:163]
ds_read_b64_tr_b16 a[190:191], v2 offset:13160
v_add_f32 v10, v10, v178
v_mfma_f32_16x16x32_bf16 v[164:167], a[148:151], v[196:199], v[164:167]
v_exp_f32 v179, v179
v_mfma_f32_16x16x32_bf16 v[168:171], a[152:155], v[196:199], v[168:171]
v_cvt_pk_bf16_f32 v193, v178, v179
v_add_f32 v10, v10, v179
v_mfma_f32_16x16x32_bf16 v[172:175], a[156:159], v[196:199], v[172:175]
v_exp_f32 v180, v180
v_mfma_f32_16x16x32_bf16 v[184:187], a[224:227], v[32:35], -4.0
v_add_f32 v10, v10, v180
v_xor_b32 v1, 0x4000, v1
v_mfma_f32_16x16x32_bf16 v[184:187], a[228:231], v[36:39], v[184:187]
v_exp_f32 v181, v181
v_mfma_f32_16x16x32_bf16 v[184:187], a[232:235], v[40:43], v[184:187]
v_cvt_pk_bf16_f32 v194, v180, v181
v_add_f32 v10, v10, v181
v_mfma_f32_16x16x32_bf16 v[184:187], a[236:239], v[44:47], v[184:187]
v_exp_f32 v182, v182
v_mfma_f32_16x16x32_bf16 v[188:191], a[240:243], v[32:35], -4.0
L_padhead1:
L_pad1:
s_cbranch_execz L_pad5
v_add_f32 v10, v10, v182
v_add_u32 v2, s30, v2
v_mfma_f32_16x16x32_bf16 v[188:191], a[244:247], v[36:39], v[188:191]
s_sub_u32 s30, 0, s30
v_exp_f32 v183, v183
v_mfma_f32_16x16x32_bf16 v[188:191], a[248:251], v[40:43], v[188:191]
s_waitcnt lgkmcnt(0)
v_cvt_pk_bf16_f32 v195, v182, v183
v_add_f32 v10, v10, v183
v_mfma_f32_16x16x32_bf16 v[188:191], a[252:255], v[44:47], v[188:191]
s_barrier
v_exp_f32 v184, v184
v_mfma_f32_16x16x32_bf16 a[0:3], a[160:163], v[192:195], a[0:3]
ds_read_b128 a[192:195], v1 offset:0
v_add_f32 v11, v11, v184
v_mfma_f32_16x16x32_bf16 a[4:7], a[164:167], v[192:195], a[4:7]
s_mov_b32 m0, s26
v_exp_f32 v185, v185
v_mfma_f32_16x16x32_bf16 a[8:11], a[168:171], v[192:195], a[8:11]
buffer_load_dwordx4 v4, s[4:7], s25 offen nt lds
v_cvt_pk_bf16_f32 v196, v184, v185
v_add_f32 v11, v11, v185
v_mfma_f32_16x16x32_bf16 a[12:15], a[172:175], v[192:195], a[12:15]
s_add_u32 s26, s26, s37
v_exp_f32 v186, v186
v_mfma_f32_16x16x32_bf16 a[16:19], a[176:179], v[192:195], a[16:19]
ds_read_b128 a[196:199], v1 offset:256
v_add_f32 v11, v11, v186
v_mfma_f32_16x16x32_bf16 a[20:23], a[180:183], v[192:195], a[20:23]
s_add_u32 s25, s25, 1024
v_exp_f32 v187, v187
v_mfma_f32_16x16x32_bf16 a[24:27], a[184:187], v[192:195], a[24:27]
s_mov_b32 m0, s26
v_cvt_pk_bf16_f32 v197, v186, v187
v_add_f32 v11, v11, v187
v_mfma_f32_16x16x32_bf16 a[28:31], a[188:191], v[192:195], a[28:31]
v_exp_f32 v188, v188
v_mfma_f32_16x16x32_bf16 v[176:179], a[224:227], v[48:51], -4.0
ds_read_b128 a[200:203], v1 offset:512
v_add_f32 v11, v11, v188
v_mfma_f32_16x16x32_bf16 v[176:179], a[228:231], v[52:55], v[176:179]
buffer_load_dwordx4 v4, s[4:7], s25 offen nt lds
v_exp_f32 v189, v189
v_mfma_f32_16x16x32_bf16 v[176:179], a[232:235], v[56:59], v[176:179]
s_add_u32 s26, s26, s37
v_cvt_pk_bf16_f32 v198, v188, v189
v_add_f32 v11, v11, v189
v_mfma_f32_16x16x32_bf16 v[176:179], a[236:239], v[60:63], v[176:179]
s_add_u32 s25, s25, 1024
v_exp_f32 v190, v190
v_mfma_f32_16x16x32_bf16 v[180:183], a[240:243], v[48:51], -4.0
ds_read_b128 a[204:207], v1 offset:768
v_add_f32 v11, v11, v190
v_mfma_f32_16x16x32_bf16 v[180:183], a[244:247], v[52:55], v[180:183]
v_exp_f32 v191, v191
v_mfma_f32_16x16x32_bf16 v[180:183], a[248:251], v[56:59], v[180:183]
v_cvt_pk_bf16_f32 v199, v190, v191
v_add_f32 v11, v11, v191
v_mfma_f32_16x16x32_bf16 v[180:183], a[252:255], v[60:63], v[180:183]
v_exp_f32 v176, v176
v_mfma_f32_16x16x32_bf16 a[32:35], a[160:163], v[196:199], a[32:35]
ds_read_b128 a[208:211], v1 offset:4096
v_add_f32 v12, v12, v176
v_mfma_f32_16x16x32_bf16 a[36:39], a[164:167], v[196:199], a[36:39]
v_exp_f32 v177, v177
v_mfma_f32_16x16x32_bf16 a[40:43], a[168:171], v[196:199], a[40:43]
v_cvt_pk_bf16_f32 v192, v176, v177
v_add_f32 v12, v12, v177
v_mfma_f32_16x16x32_bf16 a[44:47], a[172:175], v[196:199], a[44:47]
v_exp_f32 v178, v178
v_mfma_f32_16x16x32_bf16 a[48:51], a[176:179], v[196:199], a[48:51]
ds_read_b128 a[212:215], v1 offset:4352
v_add_f32 v12, v12, v178
v_mfma_f32_16x16x32_bf16 a[52:55], a[180:183], v[196:199], a[52:55]
ds_read_b128 a[216:219], v1 offset:4608
v_exp_f32 v179, v179
v_mfma_f32_16x16x32_bf16 a[56:59], a[184:187], v[196:199], a[56:59]
v_cvt_pk_bf16_f32 v193, v178, v179
v_add_f32 v12, v12, v179
v_mfma_f32_16x16x32_bf16 a[60:63], a[188:191], v[196:199], a[60:63]
v_exp_f32 v180, v180
v_mfma_f32_16x16x32_bf16 v[184:187], a[224:227], v[64:67], -4.0
ds_read_b128 a[220:223], v1 offset:4864
v_add_f32 v12, v12, v180
v_mfma_f32_16x16x32_bf16 v[184:187], a[228:231], v[68:71], v[184:187]
v_exp_f32 v181, v181
v_mfma_f32_16x16x32_bf16 v[184:187], a[232:235], v[72:75], v[184:187]
v_cvt_pk_bf16_f32 v194, v180, v181
v_add_f32 v12, v12, v181
v_mfma_f32_16x16x32_bf16 v[184:187], a[236:239], v[76:79], v[184:187]
v_exp_f32 v182, v182
v_mfma_f32_16x16x32_bf16 v[188:191], a[240:243], v[64:67], -4.0
ds_read_b64_tr_b16 a[128:129], v2 offset:0
v_add_f32 v12, v12, v182
v_mfma_f32_16x16x32_bf16 v[188:191], a[244:247], v[68:71], v[188:191]
v_exp_f32 v183, v183
v_mfma_f32_16x16x32_bf16 v[188:191], a[248:251], v[72:75], v[188:191]
v_cvt_pk_bf16_f32 v195, v182, v183
v_add_f32 v12, v12, v183
v_mfma_f32_16x16x32_bf16 v[188:191], a[252:255], v[76:79], v[188:191]
v_exp_f32 v184, v184
v_mfma_f32_16x16x32_bf16 a[64:67], a[160:163], v[192:195], a[64:67]
ds_read_b64_tr_b16 a[130:131], v2 offset:4128
v_add_f32 v13, v13, v184
v_mfma_f32_16x16x32_bf16 a[68:71], a[164:167], v[192:195], a[68:71]
v_exp_f32 v185, v185
v_mfma_f32_16x16x32_bf16 a[72:75], a[168:171], v[192:195], a[72:75]
v_cvt_pk_bf16_f32 v196, v184, v185
v_add_f32 v13, v13, v185
v_mfma_f32_16x16x32_bf16 a[76:79], a[172:175], v[192:195], a[76:79]
v_exp_f32 v186, v186
v_mfma_f32_16x16x32_bf16 a[80:83], a[176:179], v[192:195], a[80:83]
ds_read_b64_tr_b16 a[132:133], v2 offset:8
v_add_f32 v13, v13, v186
v_mfma_f32_16x16x32_bf16 a[84:87], a[180:183], v[192:195], a[84:87]
v_exp_f32 v187, v187
v_mfma_f32_16x16x32_bf16 a[88:91], a[184:187], v[192:195], a[88:91]
v_cvt_pk_bf16_f32 v197, v186, v187
v_add_f32 v13, v13, v187
v_mfma_f32_16x16x32_bf16 a[92:95], a[188:191], v[192:195], a[92:95]
v_exp_f32 v188, v188
v_mfma_f32_16x16x32_bf16 v[176:179], a[224:227], v[80:83], -4.0
ds_read_b64_tr_b16 a[134:135], v2 offset:4136
v_add_f32 v13, v13, v188
v_mfma_f32_16x16x32_bf16 v[176:179], a[228:231], v[84:87], v[176:179]
v_exp_f32 v189, v189
v_mfma_f32_16x16x32_bf16 v[176:179], a[232:235], v[88:91], v[176:179]
v_cvt_pk_bf16_f32 v198, v188, v189
v_add_f32 v13, v13, v189
v_mfma_f32_16x16x32_bf16 v[176:179], a[236:239], v[92:95], v[176:179]
v_exp_f32 v190, v190
v_mfma_f32_16x16x32_bf16 v[180:183], a[240:243], v[80:83], -4.0
ds_read_b64_tr_b16 a[136:137], v2 offset:256
v_add_f32 v13, v13, v190
v_mfma_f32_16x16x32_bf16 v[180:183], a[244:247], v[84:87], v[180:183]
v_exp_f32 v191, v191
v_mfma_f32_16x16x32_bf16 v[180:183], a[248:251], v[88:91], v[180:183]
v_cvt_pk_bf16_f32 v199, v190, v191
v_add_f32 v13, v13, v191
v_mfma_f32_16x16x32_bf16 v[180:183], a[252:255], v[92:95], v[180:183]
v_exp_f32 v176, v176
v_mfma_f32_16x16x32_bf16 a[96:99], a[160:163], v[196:199], a[96:99]
ds_read_b64_tr_b16 a[138:139], v2 offset:4384
v_add_f32 v14, v14, v176
v_mfma_f32_16x16x32_bf16 a[100:103], a[164:167], v[196:199], a[100:103]
v_exp_f32 v177, v177
v_mfma_f32_16x16x32_bf16 a[104:107], a[168:171], v[196:199], a[104:107]
v_cvt_pk_bf16_f32 v192, v176, v177
v_add_f32 v14, v14, v177
v_mfma_f32_16x16x32_bf16 a[108:111], a[172:175], v[196:199], a[108:111]
v_exp_f32 v178, v178
v_mfma_f32_16x16x32_bf16 a[112:115], a[176:179], v[196:199], a[112:115]
ds_read_b64_tr_b16 a[140:141], v2 offset:264
v_add_f32 v14, v14, v178
v_mfma_f32_16x16x32_bf16 a[116:119], a[180:183], v[196:199], a[116:119]
v_exp_f32 v179, v179
v_mfma_f32_16x16x32_bf16 a[120:123], a[184:187], v[196:199], a[120:123]
v_cvt_pk_bf16_f32 v193, v178, v179
v_add_f32 v14, v14, v179
v_mfma_f32_16x16x32_bf16 a[124:127], a[188:191], v[196:199], a[124:127]
v_exp_f32 v180, v180
v_mfma_f32_16x16x32_bf16 v[184:187], a[224:227], v[96:99], -4.0
ds_read_b64_tr_b16 a[142:143], v2 offset:4392
v_add_f32 v14, v14, v180
v_mfma_f32_16x16x32_bf16 v[184:187], a[228:231], v[100:103], v[184:187]
v_exp_f32 v181, v181
v_mfma_f32_16x16x32_bf16 v[184:187], a[232:235], v[104:107], v[184:187]
v_cvt_pk_bf16_f32 v194, v180, v181
v_add_f32 v14, v14, v181
v_mfma_f32_16x16x32_bf16 v[184:187], a[236:239], v[108:111], v[184:187]
v_exp_f32 v182, v182
v_mfma_f32_16x16x32_bf16 v[188:191], a[240:243], v[96:99], -4.0
ds_read_b64_tr_b16 a[144:145], v2 offset:512
v_add_f32 v14, v14, v182
v_mfma_f32_16x16x32_bf16 v[188:191], a[244:247], v[100:103], v[188:191]
v_exp_f32 v183, v183
v_mfma_f32_16x16x32_bf16 v[188:191], a[248:251], v[104:107], v[188:191]
ds_read_b64_tr_b16 a[146:147], v2 offset:4640
v_cvt_pk_bf16_f32 v195, v182, v183
v_add_f32 v14, v14, v183
v_mfma_f32_16x16x32_bf16 v[188:191], a[252:255], v[108:111], v[188:191]
v_exp_f32 v184, v184
v_mfma_f32_16x16x32_bf16 v[112:115], a[160:163], v[192:195], v[112:115]
ds_read_b64_tr_b16 a[148:149], v2 offset:520
v_add_f32 v15, v15, v184
v_mfma_f32_16x16x32_bf16 v[116:119], a[164:167], v[192:195], v[116:119]
v_exp_f32 v185, v185
v_mfma_f32_16x16x32_bf16 v[120:123], a[168:171], v[192:195], v[120:123]
v_cvt_pk_bf16_f32 v196, v184, v185
v_add_f32 v15, v15, v185
v_mfma_f32_16x16x32_bf16 v[124:127], a[172:175], v[192:195], v[124:127]
v_exp_f32 v186, v186
v_mfma_f32_16x16x32_bf16 v[128:131], a[176:179], v[192:195], v[128:131]
ds_read_b64_tr_b16 a[150:151], v2 offset:4648
v_add_f32 v15, v15, v186
v_mfma_f32_16x16x32_bf16 v[132:135], a[180:183], v[192:195], v[132:135]
v_exp_f32 v187, v187
v_mfma_f32_16x16x32_bf16 v[136:139], a[184:187], v[192:195], v[136:139]
v_cvt_pk_bf16_f32 v197, v186, v187
v_add_f32 v15, v15, v187
v_mfma_f32_16x16x32_bf16 v[140:143], a[188:191], v[192:195], v[140:143]
s_waitcnt lgkmcnt(8)
v_exp_f32 v188, v188
v_mfma_f32_16x16x32_bf16 v[176:179], a[192:195], v[16:19], -4.0
ds_read_b64_tr_b16 a[152:153], v2 offset:768
v_add_f32 v15, v15, v188
v_mfma_f32_16x16x32_bf16 v[176:179], a[196:199], v[20:23], v[176:179]
v_exp_f32 v189, v189
v_mfma_f32_16x16x32_bf16 v[176:179], a[200:203], v[24:27], v[176:179]
v_cvt_pk_bf16_f32 v198, v188, v189
v_add_f32 v15, v15, v189
v_mfma_f32_16x16x32_bf16 v[176:179], a[204:207], v[28:31], v[176:179]
v_exp_f32 v190, v190
v_mfma_f32_16x16x32_bf16 v[180:183], a[208:211], v[16:19], -4.0
ds_read_b64_tr_b16 a[154:155], v2 offset:4896
v_add_f32 v15, v15, v190
v_mfma_f32_16x16x32_bf16 v[180:183], a[212:215], v[20:23], v[180:183]
v_exp_f32 v191, v191
v_mfma_f32_16x16x32_bf16 v[180:183], a[216:219], v[24:27], v[180:183]
v_cvt_pk_bf16_f32 v199, v190, v191
v_add_f32 v15, v15, v191
v_mfma_f32_16x16x32_bf16 v[180:183], a[220:223], v[28:31], v[180:183]
v_exp_f32 v176, v176
v_mfma_f32_16x16x32_bf16 v[144:147], a[160:163], v[196:199], v[144:147]
ds_read_b64_tr_b16 a[156:157], v2 offset:776
v_mov_b32 v6, v176
v_mfma_f32_16x16x32_bf16 v[148:151], a[164:167], v[196:199], v[148:151]
v_exp_f32 v177, v177
v_mfma_f32_16x16x32_bf16 v[152:155], a[168:171], v[196:199], v[152:155]
v_cvt_pk_bf16_f32 v192, v176, v177
v_add_f32 v6, v6, v177
v_mfma_f32_16x16x32_bf16 v[156:159], a[172:175], v[196:199], v[156:159]
v_exp_f32 v178, v178
v_mfma_f32_16x16x32_bf16 v[160:163], a[176:179], v[196:199], v[160:163]
ds_read_b64_tr_b16 a[158:159], v2 offset:4904
v_add_f32 v6, v6, v178
v_exp_f32 v180, v180
v_mfma_f32_16x16x32_bf16 v[164:167], a[180:183], v[196:199], v[164:167]
s_add_u32 s28, s28, 1
v_exp_f32 v179, v179
v_mfma_f32_16x16x32_bf16 v[168:171], a[184:187], v[196:199], v[168:171]
s_cmp_lt_u32 s28, s36
v_cvt_pk_bf16_f32 v193, v178, v179
v_add_f32 v6, v6, v179
v_mfma_f32_16x16x32_bf16 v[172:175], a[188:191], v[196:199], v[172:175]
s_cbranch_scc1 L_loopA
L_endA:
v_mfma_f32_16x16x32_bf16 v[184:187], a[192:195], v[32:35], -4.0
v_add_f32 v10, v10, v180
v_add_f32 v10, v10, v6
v_mfma_f32_16x16x32_bf16 v[184:187], a[196:199], v[36:39], v[184:187]
v_exp_f32 v181, v181
v_mfma_f32_16x16x32_bf16 v[184:187], a[200:203], v[40:43], v[184:187]
v_cvt_pk_bf16_f32 v194, v180, v181
v_add_f32 v10, v10, v181
v_mfma_f32_16x16x32_bf16 v[184:187], a[204:207], v[44:47], v[184:187]
v_exp_f32 v182, v182
v_mfma_f32_16x16x32_bf16 v[188:191], a[208:211], v[32:35], -4.0
v_add_f32 v10, v10, v182
v_mfma_f32_16x16x32_bf16 v[188:191], a[212:215], v[36:39], v[188:191]
v_exp_f32 v183, v183
v_mfma_f32_16x16x32_bf16 v[188:191], a[216:219], v[40:43], v[188:191]
s_waitcnt lgkmcnt(0)
v_cvt_pk_bf16_f32 v195, v182, v183
v_add_f32 v10, v10, v183
v_mfma_f32_16x16x32_bf16 v[188:191], a[220:223], v[44:47], v[188:191]
s_barrier
v_exp_f32 v184, v184
v_mfma_f32_16x16x32_bf16 a[0:3], a[128:131], v[192:195], a[0:3]
ds_read_b128 a[224:227], v1 offset:8192
v_add_f32 v11, v11, v184
v_mfma_f32_16x16x32_bf16 a[4:7], a[132:135], v[192:195], a[4:7]
v_exp_f32 v185, v185
v_mfma_f32_16x16x32_bf16 a[8:11], a[136:139], v[192:195], a[8:11]
v_cvt_pk_bf16_f32 v196, v184, v185
v_add_f32 v11, v11, v185
v_mfma_f32_16x16x32_bf16 a[12:15], a[140:143], v[192:195], a[12:15]
v_exp_f32 v186, v186
v_mfma_f32_16x16x32_bf16 a[16:19], a[144:147], v[192:195], a[16:19]
ds_read_b128 a[228:231], v1 offset:8448
v_add_f32 v11, v11, v186
v_mfma_f32_16x16x32_bf16 a[20:23], a[148:151], v[192:195], a[20:23]
v_exp_f32 v187, v187
v_mfma_f32_16x16x32_bf16 a[24:27], a[152:155], v[192:195], a[24:27]
v_cvt_pk_bf16_f32 v197, v186, v187
v_add_f32 v11, v11, v187
v_mfma_f32_16x16x32_bf16 a[28:31], a[156:159], v[192:195], a[28:31]
v_exp_f32 v188, v188
v_mfma_f32_16x16x32_bf16 v[176:179], a[192:195], v[48:51], -4.0
ds_read_b128 a[232:235], v1 offset:8704
v_add_f32 v11, v11, v188
v_mfma_f32_16x16x32_bf16 v[176:179], a[196:199], v[52:55], v[176:179]
v_exp_f32 v189, v189
v_mfma_f32_16x16x32_bf16 v[176:179], a[200:203], v[56:59], v[176:179]
v_cvt_pk_bf16_f32 v198, v188, v189
v_add_f32 v11, v11, v189
v_mfma_f32_16x16x32_bf16 v[176:179], a[204:207], v[60:63], v[176:179]
v_exp_f32 v190, v190
v_mfma_f32_16x16x32_bf16 v[180:183], a[208:211], v[48:51], -4.0
ds_read_b128 a[236:239], v1 offset:8960
v_add_f32 v11, v11, v190
v_mfma_f32_16x16x32_bf16 v[180:183], a[212:215], v[52:55], v[180:183]
v_exp_f32 v191, v191
v_mfma_f32_16x16x32_bf16 v[180:183], a[216:219], v[56:59], v[180:183]
v_cvt_pk_bf16_f32 v199, v190, v191
v_add_f32 v11, v11, v191
v_mfma_f32_16x16x32_bf16 v[180:183], a[220:223], v[60:63], v[180:183]
v_exp_f32 v176, v176
v_mfma_f32_16x16x32_bf16 a[32:35], a[128:131], v[196:199], a[32:35]
ds_read_b128 a[240:243], v1 offset:12288
v_add_f32 v12, v12, v176
v_mfma_f32_16x16x32_bf16 a[36:39], a[132:135], v[196:199], a[36:39]
v_exp_f32 v177, v177
v_mfma_f32_16x16x32_bf16 a[40:43], a[136:139], v[196:199], a[40:43]
v_cvt_pk_bf16_f32 v192, v176, v177
v_add_f32 v12, v12, v177
v_mfma_f32_16x16x32_bf16 a[44:47], a[140:143], v[196:199], a[44:47]
v_exp_f32 v178, v178
v_mfma_f32_16x16x32_bf16 a[48:51], a[144:147], v[196:199], a[48:51]
ds_read_b128 a[244:247], v1 offset:12544
v_add_f32 v12, v12, v178
v_mfma_f32_16x16x32_bf16 a[52:55], a[148:151], v[196:199], a[52:55]
ds_read_b128 a[248:251], v1 offset:12800
v_exp_f32 v179, v179
v_mfma_f32_16x16x32_bf16 a[56:59], a[152:155], v[196:199], a[56:59]
v_cvt_pk_bf16_f32 v193, v178, v179
v_add_f32 v12, v12, v179
v_mfma_f32_16x16x32_bf16 a[60:63], a[156:159], v[196:199], a[60:63]
v_exp_f32 v180, v180
v_mfma_f32_16x16x32_bf16 v[184:187], a[192:195], v[64:67], -4.0
ds_read_b128 a[252:255], v1 offset:13056
v_add_f32 v12, v12, v180
v_mfma_f32_16x16x32_bf16 v[184:187], a[196:199], v[68:71], v[184:187]
v_exp_f32 v181, v181
v_mfma_f32_16x16x32_bf16 v[184:187], a[200:203], v[72:75], v[184:187]
v_cvt_pk_bf16_f32 v194, v180, v181
v_add_f32 v12, v12, v181
v_mfma_f32_16x16x32_bf16 v[184:187], a[204:207], v[76:79], v[184:187]
v_exp_f32 v182, v182
v_mfma_f32_16x16x32_bf16 v[188:191], a[208:211], v[64:67], -4.0
ds_read_b64_tr_b16 a[160:161], v2 offset:8256
v_add_f32 v12, v12, v182
v_mfma_f32_16x16x32_bf16 v[188:191], a[212:215], v[68:71], v[188:191]
v_exp_f32 v183, v183
v_mfma_f32_16x16x32_bf16 v[188:191], a[216:219], v[72:75], v[188:191]
v_cvt_pk_bf16_f32 v195, v182, v183
v_add_f32 v12, v12, v183
v_mfma_f32_16x16x32_bf16 v[188:191], a[220:223], v[76:79], v[188:191]
v_exp_f32 v184, v184
v_mfma_f32_16x16x32_bf16 a[64:67], a[128:131], v[192:195], a[64:67]
ds_read_b64_tr_b16 a[162:163], v2 offset:12384
v_add_f32 v13, v13, v184
v_mfma_f32_16x16x32_bf16 a[68:71], a[132:135], v[192:195], a[68:71]
v_exp_f32 v185, v185
v_mfma_f32_16x16x32_bf16 a[72:75], a[136:139], v[192:195], a[72:75]
v_cvt_pk_bf16_f32 v196, v184, v185
v_add_f32 v13, v13, v185
v_mfma_f32_16x16x32_bf16 a[76:79], a[140:143], v[192:195], a[76:79]
v_exp_f32 v186, v186
v_mfma_f32_16x16x32_bf16 a[80:83], a[144:147], v[192:195], a[80:83]
ds_read_b64_tr_b16 a[164:165], v2 offset:8264
v_add_f32 v13, v13, v186
v_mfma_f32_16x16x32_bf16 a[84:87], a[148:151], v[192:195], a[84:87]
v_exp_f32 v187, v187
v_mfma_f32_16x16x32_bf16 a[88:91], a[152:155], v[192:195], a[88:91]
v_cvt_pk_bf16_f32 v197, v186, v187
v_add_f32 v13, v13, v187
v_mfma_f32_16x16x32_bf16 a[92:95], a[156:159], v[192:195], a[92:95]
v_exp_f32 v188, v188
v_mfma_f32_16x16x32_bf16 v[176:179], a[192:195], v[80:83], -4.0
ds_read_b64_tr_b16 a[166:167], v2 offset:12392
v_add_f32 v13, v13, v188
v_mfma_f32_16x16x32_bf16 v[176:179], a[196:199], v[84:87], v[176:179]
v_exp_f32 v189, v189
v_mfma_f32_16x16x32_bf16 v[176:179], a[200:203], v[88:91], v[176:179]
v_cvt_pk_bf16_f32 v198, v188, v189
v_add_f32 v13, v13, v189
v_mfma_f32_16x16x32_bf16 v[176:179], a[204:207], v[92:95], v[176:179]
v_exp_f32 v190, v190
v_mfma_f32_16x16x32_bf16 v[180:183], a[208:211], v[80:83], -4.0
ds_read_b64_tr_b16 a[168:169], v2 offset:8512
v_add_f32 v13, v13, v190
v_mfma_f32_16x16x32_bf16 v[180:183], a[212:215], v[84:87], v[180:183]
v_exp_f32 v191, v191
v_mfma_f32_16x16x32_bf16 v[180:183], a[216:219], v[88:91], v[180:183]
v_cvt_pk_bf16_f32 v199, v190, v191
v_add_f32 v13, v13, v191
v_mfma_f32_16x16x32_bf16 v[180:183], a[220:223], v[92:95], v[180:183]
v_exp_f32 v176, v176
v_mfma_f32_16x16x32_bf16 a[96:99], a[128:131], v[196:199], a[96:99]
ds_read_b64_tr_b16 a[170:171], v2 offset:12640
v_add_f32 v14, v14, v176
v_mfma_f32_16x16x32_bf16 a[100:103], a[132:135], v[196:199], a[100:103]
v_exp_f32 v177, v177
v_mfma_f32_16x16x32_bf16 a[104:107], a[136:139], v[196:199], a[104:107]
v_cvt_pk_bf16_f32 v192, v176, v177
v_add_f32 v14, v14, v177
v_mfma_f32_16x16x32_bf16 a[108:111], a[140:143], v[196:199], a[108:111]
v_exp_f32 v178, v178
v_mfma_f32_16x16x32_bf16 a[112:115], a[144:147], v[196:199], a[112:115]
ds_read_b64_tr_b16 a[172:173], v2 offset:8520
v_add_f32 v14, v14, v178
v_mfma_f32_16x16x32_bf16 a[116:119], a[148:151], v[196:199], a[116:119]
v_exp_f32 v179, v179
v_mfma_f32_16x16x32_bf16 a[120:123], a[152:155], v[196:199], a[120:123]
v_cvt_pk_bf16_f32 v193, v178, v179
v_add_f32 v14, v14, v179
v_mfma_f32_16x16x32_bf16 a[124:127], a[156:159], v[196:199], a[124:127]
v_exp_f32 v180, v180
v_mfma_f32_16x16x32_bf16 v[184:187], a[192:195], v[96:99], -4.0
ds_read_b64_tr_b16 a[174:175], v2 offset:12648
v_add_f32 v14, v14, v180
v_mfma_f32_16x16x32_bf16 v[184:187], a[196:199], v[100:103], v[184:187]
v_exp_f32 v181, v181
v_mfma_f32_16x16x32_bf16 v[184:187], a[200:203], v[104:107], v[184:187]
v_cvt_pk_bf16_f32 v194, v180, v181
v_add_f32 v14, v14, v181
v_mfma_f32_16x16x32_bf16 v[184:187], a[204:207], v[108:111], v[184:187]
v_exp_f32 v182, v182
v_mfma_f32_16x16x32_bf16 v[188:191], a[208:211], v[96:99], -4.0
ds_read_b64_tr_b16 a[176:177], v2 offset:8768
v_add_f32 v14, v14, v182
v_mfma_f32_16x16x32_bf16 v[188:191], a[212:215], v[100:103], v[188:191]
v_exp_f32 v183, v183
v_mfma_f32_16x16x32_bf16 v[188:191], a[216:219], v[104:107], v[188:191]
ds_read_b64_tr_b16 a[178:179], v2 offset:12896
v_cvt_pk_bf16_f32 v195, v182, v183
v_add_f32 v14, v14, v183
v_mfma_f32_16x16x32_bf16 v[188:191], a[220:223], v[108:111], v[188:191]
v_exp_f32 v184, v184
v_mfma_f32_16x16x32_bf16 v[112:115], a[128:131], v[192:195], v[112:115]
ds_read_b64_tr_b16 a[180:181], v2 offset:8776
v_add_f32 v15, v15, v184
v_mfma_f32_16x16x32_bf16 v[116:119], a[132:135], v[192:195], v[116:119]
v_exp_f32 v185, v185
v_mfma_f32_16x16x32_bf16 v[120:123], a[136:139], v[192:195], v[120:123]
v_cvt_pk_bf16_f32 v196, v184, v185
v_add_f32 v15, v15, v185
v_mfma_f32_16x16x32_bf16 v[124:127], a[140:143], v[192:195], v[124:127]
v_exp_f32 v186, v186
v_mfma_f32_16x16x32_bf16 v[128:131], a[144:147], v[192:195], v[128:131]
ds_read_b64_tr_b16 a[182:183], v2 offset:12904
v_add_f32 v15, v15, v186
v_mfma_f32_16x16x32_bf16 v[132:135], a[148:151], v[192:195], v[132:135]
v_exp_f32 v187, v187
v_mfma_f32_16x16x32_bf16 v[136:139], a[152:155], v[192:195], v[136:139]
v_cvt_pk_bf16_f32 v197, v186, v187
v_add_f32 v15, v15, v187
v_mfma_f32_16x16x32_bf16 v[140:143], a[156:159], v[192:195], v[140:143]
s_waitcnt lgkmcnt(8)
v_exp_f32 v188, v188
v_mfma_f32_16x16x32_bf16 v[176:179], a[224:227], v[16:19], -4.0
ds_read_b64_tr_b16 a[184:185], v2 offset:9024
v_add_f32 v15, v15, v188
v_mfma_f32_16x16x32_bf16 v[176:179], a[228:231], v[20:23], v[176:179]
v_exp_f32 v189, v189
v_mfma_f32_16x16x32_bf16 v[176:179], a[232:235], v[24:27], v[176:179]
v_cvt_pk_bf16_f32 v198, v188, v189
v_add_f32 v15, v15, v189
v_mfma_f32_16x16x32_bf16 v[176:179], a[236:239], v[28:31], v[176:179]
v_exp_f32 v190, v190
v_mfma_f32_16x16x32_bf16 v[180:183], a[240:243], v[16:19], -4.0
ds_read_b64_tr_b16 a[186:187], v2 offset:13152
v_add_f32 v15, v15, v190
v_mfma_f32_16x16x32_bf16 v[180:183], a[244:247], v[20:23], v[180:183]
v_exp_f32 v191, v191
v_mfma_f32_16x16x32_bf16 v[180:183], a[248:251], v[24:27], v[180:183]
v_cvt_pk_bf16_f32 v199, v190, v191
v_add_f32 v15, v15, v191
v_mfma_f32_16x16x32_bf16 v[180:183], a[252:255], v[28:31], v[180:183]
v_exp_f32 v176, v176
v_mfma_f32_16x16x32_bf16 v[144:147], a[128:131], v[196:199], v[144:147]
ds_read_b64_tr_b16 a[188:189], v2 offset:9032
v_add_f32 v10, v10, v176
v_mfma_f32_16x16x32_bf16 v[148:151], a[132:135], v[196:199], v[148:151]
v_exp_f32 v177, v177
v_mfma_f32_16x16x32_bf16 v[152:155], a[136:139], v[196:199], v[152:155]
v_cvt_pk_bf16_f32 v192, v176, v177
v_add_f32 v10, v10, v177
v_mfma_f32_16x16x32_bf16 v[156:159], a[140:143], v[196:199], v[156:159]
v_exp_f32 v178, v178
v_mfma_f32_16x16x32_bf16 v[160:163], a[144:147], v[196:199], v[160:163]
ds_read_b64_tr_b16 a[190:191], v2 offset:13160
v_add_f32 v10, v10, v178
v_mfma_f32_16x16x32_bf16 v[164:167], a[148:151], v[196:199], v[164:167]
v_exp_f32 v179, v179
v_mfma_f32_16x16x32_bf16 v[168:171], a[152:155], v[196:199], v[168:171]
v_cvt_pk_bf16_f32 v193, v178, v179
v_add_f32 v10, v10, v179
v_mfma_f32_16x16x32_bf16 v[172:175], a[156:159], v[196:199], v[172:175]
v_exp_f32 v180, v180
v_mfma_f32_16x16x32_bf16 v[184:187], a[224:227], v[32:35], -4.0
v_add_f32 v10, v10, v180
v_xor_b32 v1, 0x4000, v1
v_mfma_f32_16x16x32_bf16 v[184:187], a[228:231], v[36:39], v[184:187]
v_exp_f32 v181, v181
v_mfma_f32_16x16x32_bf16 v[184:187], a[232:235], v[40:43], v[184:187]
v_cvt_pk_bf16_f32 v194, v180, v181
v_add_f32 v10, v10, v181
v_mfma_f32_16x16x32_bf16 v[184:187], a[236:239], v[44:47], v[184:187]
v_exp_f32 v182, v182
v_mfma_f32_16x16x32_bf16 v[188:191], a[240:243], v[32:35], -4.0
v_add_f32 v10, v10, v182
v_add_u32 v2, s30, v2
v_mfma_f32_16x16x32_bf16 v[188:191], a[244:247], v[36:39], v[188:191]
s_sub_u32 s30, 0, s30
v_exp_f32 v183, v183
v_mfma_f32_16x16x32_bf16 v[188:191], a[248:251], v[40:43], v[188:191]
s_waitcnt lgkmcnt(0)
v_cvt_pk_bf16_f32 v195, v182, v183
v_add_f32 v10, v10, v183
v_mfma_f32_16x16x32_bf16 v[188:191], a[252:255], v[44:47], v[188:191]
s_barrier
v_exp_f32 v184, v184
v_mfma_f32_16x16x32_bf16 a[0:3], a[160:163], v[192:195], a[0:3]
ds_read_b128 a[192:195], v1 offset:0
v_add_f32 v11, v11, v184
v_mfma_f32_16x16x32_bf16 a[4:7], a[164:167], v[192:195], a[4:7]
v_exp_f32 v185, v185
v_mfma_f32_16x16x32_bf16 a[8:11], a[168:171], v[192:195], a[8:11]
v_cvt_pk_bf16_f32 v196, v184, v185
v_add_f32 v11, v11, v185
v_mfma_f32_16x16x32_bf16 a[12:15], a[172:175], v[192:195], a[12:15]
v_exp_f32 v186, v186
v_mfma_f32_16x16x32_bf16 a[16:19], a[176:179], v[192:195], a[16:19]
ds_read_b128 a[196:199], v1 offset:256
v_add_f32 v11, v11, v186
v_mfma_f32_16x16x32_bf16 a[20:23], a[180:183], v[192:195], a[20:23]
v_exp_f32 v187, v187
v_mfma_f32_16x16x32_bf16 a[24:27], a[184:187], v[192:195], a[24:27]
v_cvt_pk_bf16_f32 v197, v186, v187
v_add_f32 v11, v11, v187
v_mfma_f32_16x16x32_bf16 a[28:31], a[188:191], v[192:195], a[28:31]
v_exp_f32 v188, v188
v_mfma_f32_16x16x4_f32 v[200:203], v7, v10, 0
s_waitcnt vmcnt(20)
ds_read_b128 v[16:19], v8 offset:0
ds_read_b128 v[20:23], v8 offset:256
ds_read_b128 v[24:27], v8 offset:512
ds_read_b128 v[28:31], v8 offset:768
v_accvgpr_read_b32 v204, a0
v_accvgpr_read_b32 v205, a1
v_accvgpr_read_b32 v206, a2
v_accvgpr_read_b32 v207, a3
v_accvgpr_read_b32 v208, a4
v_accvgpr_read_b32 v209, a5
v_accvgpr_read_b32 v210, a6
v_accvgpr_read_b32 v211, a7
v_rcp_f32 v200, v200
v_subrev_u32 v202, s47, v201
v_max_u32 v9, v9, v202
v_accvgpr_read_b32 v212, a8
v_accvgpr_read_b32 v213, a9
v_accvgpr_read_b32 v214, a10
v_accvgpr_read_b32 v215, a11
v_accvgpr_read_b32 v216, a12
v_accvgpr_read_b32 v217, a13
v_accvgpr_read_b32 v218, a14
v_accvgpr_read_b32 v219, a15
v_pk_mul_f32 v[204:205], v[204:205], v[200:201] op_sel_hi:[1,0]
v_pk_mul_f32 v[206:207], v[206:207], v[200:201] op_sel_hi:[1,0]
v_pk_mul_f32 v[208:209], v[208:209], v[200:201] op_sel_hi:[1,0]
v_pk_mul_f32 v[210:211], v[210:211], v[200:201] op_sel_hi:[1,0]
v_cvt_pk_bf16_f32 v220, v204, v205
v_cvt_pk_bf16_f32 v221, v206, v207
v_cvt_pk_bf16_f32 v222, v208, v209
v_cvt_pk_bf16_f32 v223, v210, v211
ds_write_b128 v233, v[220:223] offset:0
v_accvgpr_read_b32 v204, a16
v_accvgpr_read_b32 v205, a17
v_accvgpr_read_b32 v206, a18
v_accvgpr_read_b32 v207, a19
v_accvgpr_read_b32 v208, a20
v_accvgpr_read_b32 v209, a21
v_accvgpr_read_b32 v210, a22
v_accvgpr_read_b32 v211, a23
v_pk_mul_f32 v[212:213], v[212:213], v[200:201] op_sel_hi:[1,0]
v_pk_mul_f32 v[214:215], v[214:215], v[200:201] op_sel_hi:[1,0]
v_pk_mul_f32 v[216:217], v[216:217], v[200:201] op_sel_hi:[1,0]
v_pk_mul_f32 v[218:219], v[218:219], v[200:201] op_sel_hi:[1,0]
v_mfma_f32_32x32x16_bf16 a[0:15], v[228:231], v[228:231], 0
v_cvt_pk_bf16_f32 v224, v212, v213
v_cvt_pk_bf16_f32 v225, v214, v215
v_cvt_pk_bf16_f32 v226, v216, v217
v_cvt_pk_bf16_f32 v227, v218, v219
ds_write_b128 v234, v[224:227] offset:0
v_accvgpr_read_b32 v212, a24
v_accvgpr_read_b32 v213, a25
v_accvgpr_read_b32 v214, a26
v_accvgpr_read_b32 v215, a27
v_accvgpr_read_b32 v216, a28
v_accvgpr_read_b32 v217, a29
v_accvgpr_read_b32 v218, a30
v_accvgpr_read_b32 v219, a31
v_pk_mul_f32 v[204:205], v[204:205], v[200:201] op_sel_hi:[1,0]
v_pk_mul_f32 v[206:207], v[206:207], v[200:201] op_sel_hi:[1,0]
v_pk_mul_f32 v[208:209], v[208:209], v[200:201] op_sel_hi:[1,0]
v_pk_mul_f32 v[210:211], v[210:211], v[200:201] op_sel_hi:[1,0]
v_cvt_pk_bf16_f32 v220, v204, v205
v_cvt_pk_bf16_f32 v221, v206, v207
v_cvt_pk_bf16_f32 v222, v208, v209
v_cvt_pk_bf16_f32 v223, v210, v211
ds_write_b128 v233, v[220:223] offset:128
v_pk_mul_f32 v[212:213], v[212:213], v[200:201] op_sel_hi:[1,0]
v_pk_mul_f32 v[214:215], v[214:215], v[200:201] op_sel_hi:[1,0]
v_pk_mul_f32 v[216:217], v[216:217], v[200:201] op_sel_hi:[1,0]
v_pk_mul_f32 v[218:219], v[218:219], v[200:201] op_sel_hi:[1,0]
v_mfma_f32_32x32x16_bf16 a[16:31], v[228:231], v[228:231], 0
v_cvt_pk_bf16_f32 v224, v212, v213
v_cvt_pk_bf16_f32 v225, v214, v215
v_cvt_pk_bf16_f32 v226, v216, v217
v_cvt_pk_bf16_f32 v227, v218, v219
ds_write_b128 v234, v[224:227] offset:128
s_waitcnt lgkmcnt(4)
v_lshlrev_b32 v220, 16, v16
v_and_b32 v221, s31, v16
v_lshlrev_b32 v222, 16, v17
v_and_b32 v223, s31, v17
v_pk_mul_f32 v[220:221], v[220:221], s[38:39]
v_pk_mul_f32 v[222:223], v[222:223], s[38:39]
v_cvt_pk_bf16_f32 v16, v220, v221
v_cvt_pk_bf16_f32 v17, v222, v223
v_lshlrev_b32 v224, 16, v18
v_and_b32 v225, s31, v18
v_lshlrev_b32 v226, 16, v19
v_and_b32 v227, s31, v19
v_pk_mul_f32 v[224:225], v[224:225], s[38:39]
v_pk_mul_f32 v[226:227], v[226:227], s[38:39]
v_cvt_pk_bf16_f32 v18, v224, v225
v_cvt_pk_bf16_f32 v19, v226, v227
L_padhead2:
L_pad2:
s_cbranch_execz L_pad6
v_lshlrev_b32 v220, 16, v20
v_and_b32 v221, s31, v20
v_lshlrev_b32 v222, 16, v21
v_and_b32 v223, s31, v21
v_pk_mul_f32 v[220:221], v[220:221], s[38:39]
v_pk_mul_f32 v[222:223], v[222:223], s[38:39]
v_cvt_pk_bf16_f32 v20, v220, v221
v_cvt_pk_bf16_f32 v21, v222, v223
v_lshlrev_b32 v224, 16, v22
v_and_b32 v225, s31, v22
v_lshlrev_b32 v226, 16, v23
v_and_b32 v227, s31, v23
v_pk_mul_f32 v[224:225], v[224:225], s[38:39]
v_pk_mul_f32 v[226:227], v[226:227], s[38:39]
v_cvt_pk_bf16_f32 v22, v224, v225
v_cvt_pk_bf16_f32 v23, v226, v227
v_lshlrev_b32 v220, 16, v24
v_and_b32 v221, s31, v24
v_lshlrev_b32 v222, 16, v25
v_and_b32 v223, s31, v25
v_pk_mul_f32 v[220:221], v[220:221], s[38:39]
v_pk_mul_f32 v[222:223], v[222:223], s[38:39]
v_cvt_pk_bf16_f32 v24, v220, v221
v_cvt_pk_bf16_f32 v25, v222, v223
v_lshlrev_b32 v224, 16, v26
v_and_b32 v225, s31, v26
v_lshlrev_b32 v226, 16, v27
v_and_b32 v227, s31, v27
v_pk_mul_f32 v[224:225], v[224:225], s[38:39]
v_pk_mul_f32 v[226:227], v[226:227], s[38:39]
v_cvt_pk_bf16_f32 v26, v224, v225
v_cvt_pk_bf16_f32 v27, v226, v227
v_lshlrev_b32 v220, 16, v28
v_and_b32 v221, s31, v28
v_lshlrev_b32 v222, 16, v29
v_and_b32 v223, s31, v29
v_pk_mul_f32 v[220:221], v[220:221], s[38:39]
v_pk_mul_f32 v[222:223], v[222:223], s[38:39]
v_cvt_pk_bf16_f32 v28, v220, v221
v_cvt_pk_bf16_f32 v29, v222, v223
v_lshlrev_b32 v224, 16, v30
v_and_b32 v225, s31, v30
v_lshlrev_b32 v226, 16, v31
v_and_b32 v227, s31, v31
v_pk_mul_f32 v[224:225], v[224:225], s[38:39]
v_pk_mul_f32 v[226:227], v[226:227], s[38:39]
v_cvt_pk_bf16_f32 v30, v224, v225
v_cvt_pk_bf16_f32 v31, v226, v227
v_mov_b32 v10, 0
v_mfma_f32_16x16x32_bf16 v[176:179], a[224:227], v[48:51], -4.0
ds_read_b128 a[200:203], v1 offset:512
v_add_f32 v11, v11, v188
v_mfma_f32_16x16x32_bf16 v[176:179], a[228:231], v[52:55], v[176:179]
v_exp_f32 v189, v189
v_mfma_f32_16x16x32_bf16 v[176:179], a[232:235], v[56:59], v[176:179]
v_cvt_pk_bf16_f32 v198, v188, v189
v_add_f32 v11, v11, v189
v_mfma_f32_16x16x32_bf16 v[176:179], a[236:239], v[60:63], v[176:179]
v_exp_f32 v190, v190
v_mfma_f32_16x16x32_bf16 v[180:183], a[240:243], v[48:51], -4.0
ds_read_b128 a[204:207], v1 offset:768
v_add_f32 v11, v11, v190
v_mfma_f32_16x16x32_bf16 v[180:183], a[244:247], v[52:55], v[180:183]
v_exp_f32 v191, v191
v_mfma_f32_16x16x32_bf16 v[180:183], a[248:251], v[56:59], v[180:183]
v_cvt_pk_bf16_f32 v199, v190, v191
v_add_f32 v11, v11, v191
v_mfma_f32_16x16x32_bf16 v[180:183], a[252:255], v[60:63], v[180:183]
v_exp_f32 v176, v176
v_mfma_f32_16x16x32_bf16 a[32:35], a[160:163], v[196:199], a[32:35]
ds_read_b128 a[208:211], v1 offset:4096
v_add_f32 v12, v12, v176
v_mfma_f32_16x16x32_bf16 a[36:39], a[164:167], v[196:199], a[36:39]
v_exp_f32 v177, v177
v_mfma_f32_16x16x32_bf16 a[40:43], a[168:171], v[196:199], a[40:43]
v_cvt_pk_bf16_f32 v192, v176, v177
v_add_f32 v12, v12, v177
v_mfma_f32_16x16x32_bf16 a[44:47], a[172:175], v[196:199], a[44:47]
v_exp_f32 v178, v178
v_mfma_f32_16x16x32_bf16 a[48:51], a[176:179], v[196:199], a[48:51]
ds_read_b128 a[212:215], v1 offset:4352
v_add_f32 v12, v12, v178
v_mfma_f32_16x16x32_bf16 a[52:55], a[180:183], v[196:199], a[52:55]
ds_read_b128 a[216:219], v1 offset:4608
v_exp_f32 v179, v179
v_mfma_f32_16x16x32_bf16 a[56:59], a[184:187], v[196:199], a[56:59]
v_cvt_pk_bf16_f32 v193, v178, v179
v_add_f32 v12, v12, v179
v_mfma_f32_16x16x32_bf16 a[60:63], a[188:191], v[196:199], a[60:63]
v_exp_f32 v180, v180
v_mfma_f32_16x16x4_f32 v[200:203], v7, v11, 0
s_waitcnt vmcnt(16)
ds_read_b128 v[32:35], v8 offset:4096
ds_read_b128 v[36:39], v8 offset:4352
ds_read_b128 v[40:43], v8 offset:4608
ds_read_b128 v[44:47], v8 offset:4864
v_accvgpr_read_b32 v204, a32
v_accvgpr_read_b32 v205, a33
v_accvgpr_read_b32 v206, a34
v_accvgpr_read_b32 v207, a35
v_accvgpr_read_b32 v208, a36
v_accvgpr_read_b32 v209, a37
v_accvgpr_read_b32 v210, a38
v_accvgpr_read_b32 v211, a39
v_rcp_f32 v200, v200
v_subrev_u32 v202, s47, v201
v_max_u32 v9, v9, v202
v_accvgpr_read_b32 v212, a40
v_accvgpr_read_b32 v213, a41
v_accvgpr_read_b32 v214, a42
v_accvgpr_read_b32 v215, a43
v_accvgpr_read_b32 v216, a44
v_accvgpr_read_b32 v217, a45
v_accvgpr_read_b32 v218, a46
v_accvgpr_read_b32 v219, a47
v_pk_mul_f32 v[204:205], v[204:205], v[200:201] op_sel_hi:[1,0]
v_pk_mul_f32 v[206:207], v[206:207], v[200:201] op_sel_hi:[1,0]
v_pk_mul_f32 v[208:209], v[208:209], v[200:201] op_sel_hi:[1,0]
v_pk_mul_f32 v[210:211], v[210:211], v[200:201] op_sel_hi:[1,0]
v_cvt_pk_bf16_f32 v220, v204, v205
v_cvt_pk_bf16_f32 v221, v206, v207
v_cvt_pk_bf16_f32 v222, v208, v209
v_cvt_pk_bf16_f32 v223, v210, v211
ds_write_b128 v233, v[220:223] offset:4096
v_accvgpr_read_b32 v204, a48
v_accvgpr_read_b32 v205, a49
v_accvgpr_read_b32 v206, a50
v_accvgpr_read_b32 v207, a51
v_accvgpr_read_b32 v208, a52
v_accvgpr_read_b32 v209, a53
v_accvgpr_read_b32 v210, a54
v_accvgpr_read_b32 v211, a55
v_pk_mul_f32 v[212:213], v[212:213], v[200:201] op_sel_hi:[1,0]
v_pk_mul_f32 v[214:215], v[214:215], v[200:201] op_sel_hi:[1,0]
v_pk_mul_f32 v[216:217], v[216:217], v[200:201] op_sel_hi:[1,0]
v_pk_mul_f32 v[218:219], v[218:219], v[200:201] op_sel_hi:[1,0]
v_mfma_f32_32x32x16_bf16 a[32:47], v[228:231], v[228:231], 0
v_cvt_pk_bf16_f32 v224, v212, v213
v_cvt_pk_bf16_f32 v225, v214, v215
v_cvt_pk_bf16_f32 v226, v216, v217
v_cvt_pk_bf16_f32 v227, v218, v219
ds_write_b128 v234, v[224:227] offset:4096
v_accvgpr_read_b32 v212, a56
v_accvgpr_read_b32 v213, a57
v_accvgpr_read_b32 v214, a58
v_accvgpr_read_b32 v215, a59
v_accvgpr_read_b32 v216, a60
v_accvgpr_read_b32 v217, a61
v_accvgpr_read_b32 v218, a62
v_accvgpr_read_b32 v219, a63
v_pk_mul_f32 v[204:205], v[204:205], v[200:201] op_sel_hi:[1,0]
v_pk_mul_f32 v[206:207], v[206:207], v[200:201] op_sel_hi:[1,0]
v_pk_mul_f32 v[208:209], v[208:209], v[200:201] op_sel_hi:[1,0]
v_pk_mul_f32 v[210:211], v[210:211], v[200:201] op_sel_hi:[1,0]
v_cvt_pk_bf16_f32 v220, v204, v205
v_cvt_pk_bf16_f32 v221, v206, v207
v_cvt_pk_bf16_f32 v222, v208, v209
v_cvt_pk_bf16_f32 v223, v210, v211
ds_write_b128 v233, v[220:223] offset:4224
v_pk_mul_f32 v[212:213], v[212:213], v[200:201] op_sel_hi:[1,0]
v_pk_mul_f32 v[214:215], v[214:215], v[200:201] op_sel_hi:[1,0]
v_pk_mul_f32 v[216:217], v[216:217], v[200:201] op_sel_hi:[1,0]
v_pk_mul_f32 v[218:219], v[218:219], v[200:201] op_sel_hi:[1,0]
v_mfma_f32_32x32x16_bf16 a[48:63], v[228:231], v[228:231], 0
v_cvt_pk_bf16_f32 v224, v212, v213
v_cvt_pk_bf16_f32 v225, v214, v215
v_cvt_pk_bf16_f32 v226, v216, v217
v_cvt_pk_bf16_f32 v227, v218, v219
ds_write_b128 v234, v[224:227] offset:4224
s_waitcnt lgkmcnt(4)
v_lshlrev_b32 v220, 16, v32
v_and_b32 v221, s31, v32
v_lshlrev_b32 v222, 16, v33
v_and_b32 v223, s31, v33
v_pk_mul_f32 v[220:221], v[220:221], s[38:39]
v_pk_mul_f32 v[222:223], v[222:223], s[38:39]
v_cvt_pk_bf16_f32 v32, v220, v221
v_cvt_pk_bf16_f32 v33, v222, v223
v_lshlrev_b32 v224, 16, v34
v_and_b32 v225, s31, v34
v_lshlrev_b32 v226, 16, v35
v_and_b32 v227, s31, v35
v_pk_mul_f32 v[224:225], v[224:225], s[38:39]
v_pk_mul_f32 v[226:227], v[226:227], s[38:39]
v_cvt_pk_bf16_f32 v34, v224, v225
v_cvt_pk_bf16_f32 v35, v226, v227
v_lshlrev_b32 v220, 16, v36
v_and_b32 v221, s31, v36
v_lshlrev_b32 v222, 16, v37
v_and_b32 v223, s31, v37
v_pk_mul_f32 v[220:221], v[220:221], s[38:39]
v_pk_mul_f32 v[222:223], v[222:223], s[38:39]
v_cvt_pk_bf16_f32 v36, v220, v221
v_cvt_pk_bf16_f32 v37, v222, v223
v_lshlrev_b32 v224, 16, v38
v_and_b32 v225, s31, v38
v_lshlrev_b32 v226, 16, v39
v_and_b32 v227, s31, v39
v_pk_mul_f32 v[224:225], v[224:225], s[38:39]
v_pk_mul_f32 v[226:227], v[226:227], s[38:39]
v_cvt_pk_bf16_f32 v38, v224, v225
v_cvt_pk_bf16_f32 v39, v226, v227
v_lshlrev_b32 v220, 16, v40
v_and_b32 v221, s31, v40
v_lshlrev_b32 v222, 16, v41
v_and_b32 v223, s31, v41
v_pk_mul_f32 v[220:221], v[220:221], s[38:39]
v_pk_mul_f32 v[222:223], v[222:223], s[38:39]
v_cvt_pk_bf16_f32 v40, v220, v221
v_cvt_pk_bf16_f32 v41, v222, v223
v_lshlrev_b32 v224, 16, v42
v_and_b32 v225, s31, v42
v_lshlrev_b32 v226, 16, v43
v_and_b32 v227, s31, v43
v_pk_mul_f32 v[224:225], v[224:225], s[38:39]
v_pk_mul_f32 v[226:227], v[226:227], s[38:39]
v_cvt_pk_bf16_f32 v42, v224, v225
v_cvt_pk_bf16_f32 v43, v226, v227
v_lshlrev_b32 v220, 16, v44
v_and_b32 v221, s31, v44
v_lshlrev_b32 v222, 16, v45
v_and_b32 v223, s31, v45
v_pk_mul_f32 v[220:221], v[220:221], s[38:39]
v_pk_mul_f32 v[222:223], v[222:223], s[38:39]
v_cvt_pk_bf16_f32 v44, v220, v221
v_cvt_pk_bf16_f32 v45, v222, v223
v_lshlrev_b32 v224, 16, v46
v_and_b32 v225, s31, v46
v_lshlrev_b32 v226, 16, v47
v_and_b32 v227, s31, v47
v_pk_mul_f32 v[224:225], v[224:225], s[38:39]
v_pk_mul_f32 v[226:227], v[226:227], s[38:39]
v_cvt_pk_bf16_f32 v46, v224, v225
v_cvt_pk_bf16_f32 v47, v226, v227
v_mov_b32 v11, 0
v_mfma_f32_16x16x32_bf16 v[184:187], a[224:227], v[64:67], -4.0
ds_read_b128 a[220:223], v1 offset:4864
v_add_f32 v12, v12, v180
v_mfma_f32_16x16x32_bf16 v[184:187], a[228:231], v[68:71], v[184:187]
v_exp_f32 v181, v181
v_mfma_f32_16x16x32_bf16 v[184:187], a[232:235], v[72:75], v[184:187]
v_cvt_pk_bf16_f32 v194, v180, v181
v_add_f32 v12, v12, v181
v_mfma_f32_16x16x32_bf16 v[184:187], a[236:239], v[76:79], v[184:187]
v_exp_f32 v182, v182
v_mfma_f32_16x16x32_bf16 v[188:191], a[240:243], v[64:67], -4.0
ds_read_b64_tr_b16 a[128:129], v2 offset:0
v_add_f32 v12, v12, v182
v_mfma_f32_16x16x32_bf16 v[188:191], a[244:247], v[68:71], v[188:191]
v_exp_f32 v183, v183
v_mfma_f32_16x16x32_bf16 v[188:191], a[248:251], v[72:75], v[188:191]
v_cvt_pk_bf16_f32 v195, v182, v183
v_add_f32 v12, v12, v183
v_mfma_f32_16x16x32_bf16 v[188:191], a[252:255], v[76:79], v[188:191]
v_exp_f32 v184, v184
v_mfma_f32_16x16x32_bf16 a[64:67], a[160:163], v[192:195], a[64:67]
ds_read_b64_tr_b16 a[130:131], v2 offset:4128
v_add_f32 v13, v13, v184
v_mfma_f32_16x16x32_bf16 a[68:71], a[164:167], v[192:195], a[68:71]
v_exp_f32 v185, v185
v_mfma_f32_16x16x32_bf16 a[72:75], a[168:171], v[192:195], a[72:75]
v_cvt_pk_bf16_f32 v196, v184, v185
v_add_f32 v13, v13, v185
v_mfma_f32_16x16x32_bf16 a[76:79], a[172:175], v[192:195], a[76:79]
v_exp_f32 v186, v186
v_mfma_f32_16x16x32_bf16 a[80:83], a[176:179], v[192:195], a[80:83]
ds_read_b64_tr_b16 a[132:133], v2 offset:8
v_add_f32 v13, v13, v186
v_mfma_f32_16x16x32_bf16 a[84:87], a[180:183], v[192:195], a[84:87]
v_exp_f32 v187, v187
v_mfma_f32_16x16x32_bf16 a[88:91], a[184:187], v[192:195], a[88:91]
v_cvt_pk_bf16_f32 v197, v186, v187
v_add_f32 v13, v13, v187
v_mfma_f32_16x16x32_bf16 a[92:95], a[188:191], v[192:195], a[92:95]
v_exp_f32 v188, v188
v_mfma_f32_16x16x4_f32 v[200:203], v7, v12, 0
s_waitcnt vmcnt(12)
ds_read_b128 v[48:51], v8 offset:8192
ds_read_b128 v[52:55], v8 offset:8448
ds_read_b128 v[56:59], v8 offset:8704
ds_read_b128 v[60:63], v8 offset:8960
v_accvgpr_read_b32 v204, a64
v_accvgpr_read_b32 v205, a65
v_accvgpr_read_b32 v206, a66
v_accvgpr_read_b32 v207, a67
v_accvgpr_read_b32 v208, a68
v_accvgpr_read_b32 v209, a69
v_accvgpr_read_b32 v210, a70
v_accvgpr_read_b32 v211, a71
v_rcp_f32 v200, v200
v_subrev_u32 v202, s47, v201
v_max_u32 v9, v9, v202
v_accvgpr_read_b32 v212, a72
v_accvgpr_read_b32 v213, a73
v_accvgpr_read_b32 v214, a74
v_accvgpr_read_b32 v215, a75
v_accvgpr_read_b32 v216, a76
v_accvgpr_read_b32 v217, a77
v_accvgpr_read_b32 v218, a78
v_accvgpr_read_b32 v219, a79
v_pk_mul_f32 v[204:205], v[204:205], v[200:201] op_sel_hi:[1,0]
v_pk_mul_f32 v[206:207], v[206:207], v[200:201] op_sel_hi:[1,0]
v_pk_mul_f32 v[208:209], v[208:209], v[200:201] op_sel_hi:[1,0]
v_pk_mul_f32 v[210:211], v[210:211], v[200:201] op_sel_hi:[1,0]
v_cvt_pk_bf16_f32 v220, v204, v205
v_cvt_pk_bf16_f32 v221, v206, v207
v_cvt_pk_bf16_f32 v222, v208, v209
v_cvt_pk_bf16_f32 v223, v210, v211
ds_write_b128 v233, v[220:223] offset:8192
v_accvgpr_read_b32 v204, a80
v_accvgpr_read_b32 v205, a81
v_accvgpr_read_b32 v206, a82
v_accvgpr_read_b32 v207, a83
v_accvgpr_read_b32 v208, a84
v_accvgpr_read_b32 v209, a85
v_accvgpr_read_b32 v210, a86
v_accvgpr_read_b32 v211, a87
v_pk_mul_f32 v[212:213], v[212:213], v[200:201] op_sel_hi:[1,0]
v_pk_mul_f32 v[214:215], v[214:215], v[200:201] op_sel_hi:[1,0]
v_pk_mul_f32 v[216:217], v[216:217], v[200:201] op_sel_hi:[1,0]
v_pk_mul_f32 v[218:219], v[218:219], v[200:201] op_sel_hi:[1,0]
v_mfma_f32_32x32x16_bf16 a[64:79], v[228:231], v[228:231], 0
v_cvt_pk_bf16_f32 v224, v212, v213
v_cvt_pk_bf16_f32 v225, v214, v215
v_cvt_pk_bf16_f32 v226, v216, v217
v_cvt_pk_bf16_f32 v227, v218, v219
ds_write_b128 v234, v[224:227] offset:8192
v_accvgpr_read_b32 v212, a88
v_accvgpr_read_b32 v213, a89
v_accvgpr_read_b32 v214, a90
v_accvgpr_read_b32 v215, a91
v_accvgpr_read_b32 v216, a92
v_accvgpr_read_b32 v217, a93
v_accvgpr_read_b32 v218, a94
v_accvgpr_read_b32 v219, a95
v_pk_mul_f32 v[204:205], v[204:205], v[200:201] op_sel_hi:[1,0]
v_pk_mul_f32 v[206:207], v[206:207], v[200:201] op_sel_hi:[1,0]
v_pk_mul_f32 v[208:209], v[208:209], v[200:201] op_sel_hi:[1,0]
v_pk_mul_f32 v[210:211], v[210:211], v[200:201] op_sel_hi:[1,0]
v_cvt_pk_bf16_f32 v220, v204, v205
v_cvt_pk_bf16_f32 v221, v206, v207
v_cvt_pk_bf16_f32 v222, v208, v209
v_cvt_pk_bf16_f32 v223, v210, v211
ds_write_b128 v233, v[220:223] offset:8320
v_pk_mul_f32 v[212:213], v[212:213], v[200:201] op_sel_hi:[1,0]
v_pk_mul_f32 v[214:215], v[214:215], v[200:201] op_sel_hi:[1,0]
v_pk_mul_f32 v[216:217], v[216:217], v[200:201] op_sel_hi:[1,0]
v_pk_mul_f32 v[218:219], v[218:219], v[200:201] op_sel_hi:[1,0]
v_mfma_f32_32x32x16_bf16 a[80:95], v[228:231], v[228:231], 0
v_cvt_pk_bf16_f32 v224, v212, v213
v_cvt_pk_bf16_f32 v225, v214, v215
v_cvt_pk_bf16_f32 v226, v216, v217
v_cvt_pk_bf16_f32 v227, v218, v219
ds_write_b128 v234, v[224:227] offset:8320
s_waitcnt lgkmcnt(4)
v_lshlrev_b32 v220, 16, v48
v_and_b32 v221, s31, v48
v_lshlrev_b32 v222, 16, v49
v_and_b32 v223, s31, v49
v_pk_mul_f32 v[220:221], v[220:221], s[38:39]
v_pk_mul_f32 v[222:223], v[222:223], s[38:39]
v_cvt_pk_bf16_f32 v48, v220, v221
v_cvt_pk_bf16_f32 v49, v222, v223
v_lshlrev_b32 v224, 16, v50
v_and_b32 v225, s31, v50
v_lshlrev_b32 v226, 16, v51
v_and_b32 v227, s31, v51
v_pk_mul_f32 v[224:225], v[224:225], s[38:39]
v_pk_mul_f32 v[226:227], v[226:227], s[38:39]
v_cvt_pk_bf16_f32 v50, v224, v225
v_cvt_pk_bf16_f32 v51, v226, v227
v_lshlrev_b32 v220, 16, v52
v_and_b32 v221, s31, v52
v_lshlrev_b32 v222, 16, v53
v_and_b32 v223, s31, v53
v_pk_mul_f32 v[220:221], v[220:221], s[38:39]
v_pk_mul_f32 v[222:223], v[222:223], s[38:39]
v_cvt_pk_bf16_f32 v52, v220, v221
v_cvt_pk_bf16_f32 v53, v222, v223
v_lshlrev_b32 v224, 16, v54
v_and_b32 v225, s31, v54
v_lshlrev_b32 v226, 16, v55
v_and_b32 v227, s31, v55
v_pk_mul_f32 v[224:225], v[224:225], s[38:39]
v_pk_mul_f32 v[226:227], v[226:227], s[38:39]
v_cvt_pk_bf16_f32 v54, v224, v225
v_cvt_pk_bf16_f32 v55, v226, v227
v_lshlrev_b32 v220, 16, v56
v_and_b32 v221, s31, v56
v_lshlrev_b32 v222, 16, v57
v_and_b32 v223, s31, v57
v_pk_mul_f32 v[220:221], v[220:221], s[38:39]
v_pk_mul_f32 v[222:223], v[222:223], s[38:39]
v_cvt_pk_bf16_f32 v56, v220, v221
v_cvt_pk_bf16_f32 v57, v222, v223
v_lshlrev_b32 v224, 16, v58
v_and_b32 v225, s31, v58
v_lshlrev_b32 v226, 16, v59
v_and_b32 v227, s31, v59
v_pk_mul_f32 v[224:225], v[224:225], s[38:39]
v_pk_mul_f32 v[226:227], v[226:227], s[38:39]
v_cvt_pk_bf16_f32 v58, v224, v225
v_cvt_pk_bf16_f32 v59, v226, v227
v_lshlrev_b32 v220, 16, v60
v_and_b32 v221, s31, v60
v_lshlrev_b32 v222, 16, v61
v_and_b32 v223, s31, v61
v_pk_mul_f32 v[220:221], v[220:221], s[38:39]
v_pk_mul_f32 v[222:223], v[222:223], s[38:39]
v_cvt_pk_bf16_f32 v60, v220, v221
v_cvt_pk_bf16_f32 v61, v222, v223
v_lshlrev_b32 v224, 16, v62
v_and_b32 v225, s31, v62
v_lshlrev_b32 v226, 16, v63
v_and_b32 v227, s31, v63
v_pk_mul_f32 v[224:225], v[224:225], s[38:39]
v_pk_mul_f32 v[226:227], v[226:227], s[38:39]
v_cvt_pk_bf16_f32 v62, v224, v225
v_cvt_pk_bf16_f32 v63, v226, v227
v_mov_b32 v12, 0
v_mfma_f32_16x16x32_bf16 v[176:179], a[224:227], v[80:83], -4.0
ds_read_b64_tr_b16 a[134:135], v2 offset:4136
v_add_f32 v13, v13, v188
v_mfma_f32_16x16x32_bf16 v[176:179], a[228:231], v[84:87], v[176:179]
v_exp_f32 v189, v189
v_mfma_f32_16x16x32_bf16 v[176:179], a[232:235], v[88:91], v[176:179]
v_cvt_pk_bf16_f32 v198, v188, v189
v_add_f32 v13, v13, v189
v_mfma_f32_16x16x32_bf16 v[176:179], a[236:239], v[92:95], v[176:179]
v_exp_f32 v190, v190
v_mfma_f32_16x16x32_bf16 v[180:183], a[240:243], v[80:83], -4.0
ds_read_b64_tr_b16 a[136:137], v2 offset:256
v_add_f32 v13, v13, v190
v_mfma_f32_16x16x32_bf16 v[180:183], a[244:247], v[84:87], v[180:183]
v_exp_f32 v191, v191
v_mfma_f32_16x16x32_bf16 v[180:183], a[248:251], v[88:91], v[180:183]
v_cvt_pk_bf16_f32 v199, v190, v191
v_add_f32 v13, v13, v191
v_mfma_f32_16x16x32_bf16 v[180:183], a[252:255], v[92:95], v[180:183]
v_exp_f32 v176, v176
v_mfma_f32_16x16x32_bf16 a[96:99], a[160:163], v[196:199], a[96:99]
ds_read_b64_tr_b16 a[138:139], v2 offset:4384
v_add_f32 v14, v14, v176
v_mfma_f32_16x16x32_bf16 a[100:103], a[164:167], v[196:199], a[100:103]
v_exp_f32 v177, v177
v_mfma_f32_16x16x32_bf16 a[104:107], a[168:171], v[196:199], a[104:107]
v_cvt_pk_bf16_f32 v192, v176, v177
v_add_f32 v14, v14, v177
v_mfma_f32_16x16x32_bf16 a[108:111], a[172:175], v[196:199], a[108:111]
v_exp_f32 v178, v178
v_mfma_f32_16x16x32_bf16 a[112:115], a[176:179], v[196:199], a[112:115]
ds_read_b64_tr_b16 a[140:141], v2 offset:264
v_add_f32 v14, v14, v178
v_mfma_f32_16x16x32_bf16 a[116:119], a[180:183], v[196:199], a[116:119]
v_exp_f32 v179, v179
v_mfma_f32_16x16x32_bf16 a[120:123], a[184:187], v[196:199], a[120:123]
v_cvt_pk_bf16_f32 v193, v178, v179
v_add_f32 v14, v14, v179
v_mfma_f32_16x16x32_bf16 a[124:127], a[188:191], v[196:199], a[124:127]
v_exp_f32 v180, v180
v_mfma_f32_16x16x4_f32 v[200:203], v7, v13, 0
s_waitcnt vmcnt(8)
ds_read_b128 v[64:67], v8 offset:12288
ds_read_b128 v[68:71], v8 offset:12544
ds_read_b128 v[72:75], v8 offset:12800
ds_read_b128 v[76:79], v8 offset:13056
v_accvgpr_read_b32 v204, a96
v_accvgpr_read_b32 v205, a97
v_accvgpr_read_b32 v206, a98
v_accvgpr_read_b32 v207, a99
v_accvgpr_read_b32 v208, a100
v_accvgpr_read_b32 v209, a101
v_accvgpr_read_b32 v210, a102
v_accvgpr_read_b32 v211, a103
v_rcp_f32 v200, v200
v_subrev_u32 v202, s47, v201
v_max_u32 v9, v9, v202
v_accvgpr_read_b32 v212, a104
v_accvgpr_read_b32 v213, a105
v_accvgpr_read_b32 v214, a106
v_accvgpr_read_b32 v215, a107
v_accvgpr_read_b32 v216, a108
v_accvgpr_read_b32 v217, a109
v_accvgpr_read_b32 v218, a110
v_accvgpr_read_b32 v219, a111
v_pk_mul_f32 v[204:205], v[204:205], v[200:201] op_sel_hi:[1,0]
v_pk_mul_f32 v[206:207], v[206:207], v[200:201] op_sel_hi:[1,0]
v_pk_mul_f32 v[208:209], v[208:209], v[200:201] op_sel_hi:[1,0]
v_pk_mul_f32 v[210:211], v[210:211], v[200:201] op_sel_hi:[1,0]
v_cvt_pk_bf16_f32 v220, v204, v205
v_cvt_pk_bf16_f32 v221, v206, v207
v_cvt_pk_bf16_f32 v222, v208, v209
v_cvt_pk_bf16_f32 v223, v210, v211
ds_write_b128 v233, v[220:223] offset:12288
v_accvgpr_read_b32 v204, a112
v_accvgpr_read_b32 v205, a113
v_accvgpr_read_b32 v206, a114
v_accvgpr_read_b32 v207, a115
v_accvgpr_read_b32 v208, a116
v_accvgpr_read_b32 v209, a117
v_accvgpr_read_b32 v210, a118
v_accvgpr_read_b32 v211, a119
v_pk_mul_f32 v[212:213], v[212:213], v[200:201] op_sel_hi:[1,0]
v_pk_mul_f32 v[214:215], v[214:215], v[200:201] op_sel_hi:[1,0]
v_pk_mul_f32 v[216:217], v[216:217], v[200:201] op_sel_hi:[1,0]
v_pk_mul_f32 v[218:219], v[218:219], v[200:201] op_sel_hi:[1,0]
v_mfma_f32_32x32x16_bf16 a[96:111], v[228:231], v[228:231], 0
v_cvt_pk_bf16_f32 v224, v212, v213
v_cvt_pk_bf16_f32 v225, v214, v215
v_cvt_pk_bf16_f32 v226, v216, v217
v_cvt_pk_bf16_f32 v227, v218, v219
ds_write_b128 v234, v[224:227] offset:12288
v_accvgpr_read_b32 v212, a120
v_accvgpr_read_b32 v213, a121
v_accvgpr_read_b32 v214, a122
v_accvgpr_read_b32 v215, a123
v_accvgpr_read_b32 v216, a124
v_accvgpr_read_b32 v217, a125
v_accvgpr_read_b32 v218, a126
v_accvgpr_read_b32 v219, a127
v_pk_mul_f32 v[204:205], v[204:205], v[200:201] op_sel_hi:[1,0]
v_pk_mul_f32 v[206:207], v[206:207], v[200:201] op_sel_hi:[1,0]
v_pk_mul_f32 v[208:209], v[208:209], v[200:201] op_sel_hi:[1,0]
v_pk_mul_f32 v[210:211], v[210:211], v[200:201] op_sel_hi:[1,0]
v_cvt_pk_bf16_f32 v220, v204, v205
v_cvt_pk_bf16_f32 v221, v206, v207
v_cvt_pk_bf16_f32 v222, v208, v209
v_cvt_pk_bf16_f32 v223, v210, v211
ds_write_b128 v233, v[220:223] offset:12416
v_pk_mul_f32 v[212:213], v[212:213], v[200:201] op_sel_hi:[1,0]
v_pk_mul_f32 v[214:215], v[214:215], v[200:201] op_sel_hi:[1,0]
v_pk_mul_f32 v[216:217], v[216:217], v[200:201] op_sel_hi:[1,0]
v_pk_mul_f32 v[218:219], v[218:219], v[200:201] op_sel_hi:[1,0]
v_mfma_f32_32x32x16_bf16 a[112:127], v[228:231], v[228:231], 0
v_cvt_pk_bf16_f32 v224, v212, v213
v_cvt_pk_bf16_f32 v225, v214, v215
v_cvt_pk_bf16_f32 v226, v216, v217
v_cvt_pk_bf16_f32 v227, v218, v219
ds_write_b128 v234, v[224:227] offset:12416
s_waitcnt lgkmcnt(4)
v_lshlrev_b32 v220, 16, v64
v_and_b32 v221, s31, v64
v_lshlrev_b32 v222, 16, v65
v_and_b32 v223, s31, v65
v_pk_mul_f32 v[220:221], v[220:221], s[38:39]
v_pk_mul_f32 v[222:223], v[222:223], s[38:39]
v_cvt_pk_bf16_f32 v64, v220, v221
v_cvt_pk_bf16_f32 v65, v222, v223
v_lshlrev_b32 v224, 16, v66
v_and_b32 v225, s31, v66
v_lshlrev_b32 v226, 16, v67
v_and_b32 v227, s31, v67
v_pk_mul_f32 v[224:225], v[224:225], s[38:39]
v_pk_mul_f32 v[226:227], v[226:227], s[38:39]
v_cvt_pk_bf16_f32 v66, v224, v225
v_cvt_pk_bf16_f32 v67, v226, v227
v_lshlrev_b32 v220, 16, v68
v_and_b32 v221, s31, v68
v_lshlrev_b32 v222, 16, v69
v_and_b32 v223, s31, v69
v_pk_mul_f32 v[220:221], v[220:221], s[38:39]
v_pk_mul_f32 v[222:223], v[222:223], s[38:39]
v_cvt_pk_bf16_f32 v68, v220, v221
v_cvt_pk_bf16_f32 v69, v222, v223
v_lshlrev_b32 v224, 16, v70
v_and_b32 v225, s31, v70
v_lshlrev_b32 v226, 16, v71
v_and_b32 v227, s31, v71
v_pk_mul_f32 v[224:225], v[224:225], s[38:39]
v_pk_mul_f32 v[226:227], v[226:227], s[38:39]
v_cvt_pk_bf16_f32 v70, v224, v225
v_cvt_pk_bf16_f32 v71, v226, v227
v_lshlrev_b32 v220, 16, v72
v_and_b32 v221, s31, v72
v_lshlrev_b32 v222, 16, v73
v_and_b32 v223, s31, v73
v_pk_mul_f32 v[220:221], v[220:221], s[38:39]
v_pk_mul_f32 v[222:223], v[222:223], s[38:39]
v_cvt_pk_bf16_f32 v72, v220, v221
v_cvt_pk_bf16_f32 v73, v222, v223
v_lshlrev_b32 v224, 16, v74
v_and_b32 v225, s31, v74
v_lshlrev_b32 v226, 16, v75
v_and_b32 v227, s31, v75
v_pk_mul_f32 v[224:225], v[224:225], s[38:39]
v_pk_mul_f32 v[226:227], v[226:227], s[38:39]
v_cvt_pk_bf16_f32 v74, v224, v225
v_cvt_pk_bf16_f32 v75, v226, v227
v_lshlrev_b32 v220, 16, v76
v_and_b32 v221, s31, v76
v_lshlrev_b32 v222, 16, v77
v_and_b32 v223, s31, v77
v_pk_mul_f32 v[220:221], v[220:221], s[38:39]
v_pk_mul_f32 v[222:223], v[222:223], s[38:39]
v_cvt_pk_bf16_f32 v76, v220, v221
v_cvt_pk_bf16_f32 v77, v222, v223
v_lshlrev_b32 v224, 16, v78
v_and_b32 v225, s31, v78
v_lshlrev_b32 v226, 16, v79
v_and_b32 v227, s31, v79
v_pk_mul_f32 v[224:225], v[224:225], s[38:39]
v_pk_mul_f32 v[226:227], v[226:227], s[38:39]
v_cvt_pk_bf16_f32 v78, v224, v225
v_cvt_pk_bf16_f32 v79, v226, v227
v_mov_b32 v13, 0
v_mfma_f32_16x16x32_bf16 v[184:187], a[224:227], v[96:99], -4.0
ds_read_b64_tr_b16 a[142:143], v2 offset:4392
v_add_f32 v14, v14, v180
v_mfma_f32_16x16x32_bf16 v[184:187], a[228:231], v[100:103], v[184:187]
L_padhead3:
L_pad3:
s_cbranch_execz L_pad7
v_exp_f32 v181, v181
v_mfma_f32_16x16x32_bf16 v[184:187], a[232:235], v[104:107], v[184:187]
v_cvt_pk_bf16_f32 v194, v180, v181
v_add_f32 v14, v14, v181
v_mfma_f32_16x16x32_bf16 v[184:187], a[236:239], v[108:111], v[184:187]
v_exp_f32 v182, v182
v_mfma_f32_16x16x32_bf16 v[188:191], a[240:243], v[96:99], -4.0
ds_read_b64_tr_b16 a[144:145], v2 offset:512
v_add_f32 v14, v14, v182
v_mfma_f32_16x16x32_bf16 v[188:191], a[244:247], v[100:103], v[188:191]
v_exp_f32 v183, v183
v_mfma_f32_16x16x32_bf16 v[188:191], a[248:251], v[104:107], v[188:191]
ds_read_b64_tr_b16 a[146:147], v2 offset:4640
v_cvt_pk_bf16_f32 v195, v182, v183
v_add_f32 v14, v14, v183
v_mfma_f32_16x16x32_bf16 v[188:191], a[252:255], v[108:111], v[188:191]
v_exp_f32 v184, v184
v_mfma_f32_16x16x32_bf16 v[112:115], a[160:163], v[192:195], v[112:115]
ds_read_b64_tr_b16 a[148:149], v2 offset:520
v_add_f32 v15, v15, v184
v_mfma_f32_16x16x32_bf16 v[116:119], a[164:167], v[192:195], v[116:119]
v_exp_f32 v185, v185
v_mfma_f32_16x16x32_bf16 v[120:123], a[168:171], v[192:195], v[120:123]
v_cvt_pk_bf16_f32 v196, v184, v185
v_add_f32 v15, v15, v185
v_mfma_f32_16x16x32_bf16 v[124:127], a[172:175], v[192:195], v[124:127]
v_exp_f32 v186, v186
v_mfma_f32_16x16x32_bf16 v[128:131], a[176:179], v[192:195], v[128:131]
ds_read_b64_tr_b16 a[150:151], v2 offset:4648
v_add_f32 v15, v15, v186
v_mfma_f32_16x16x32_bf16 v[132:135], a[180:183], v[192:195], v[132:135]
v_exp_f32 v187, v187
v_mfma_f32_16x16x32_bf16 v[136:139], a[184:187], v[192:195], v[136:139]
v_cvt_pk_bf16_f32 v197, v186, v187
v_add_f32 v15, v15, v187
v_mfma_f32_16x16x32_bf16 v[140:143], a[188:191], v[192:195], v[140:143]
s_waitcnt lgkmcnt(8)
v_exp_f32 v188, v188
v_mfma_f32_16x16x4_f32 v[200:203], v7, v14, 0
s_waitcnt vmcnt(4)
ds_read_b128 v[80:83], v8 offset:16384
ds_read_b128 v[84:87], v8 offset:16640
ds_read_b128 v[88:91], v8 offset:16896
ds_read_b128 v[92:95], v8 offset:17152
s_nop 4
v_rcp_f32 v200, v200
v_subrev_u32 v202, s47, v201
v_max_u32 v9, v9, v202
v_pk_mul_f32 v[112:113], v[112:113], v[200:201] op_sel_hi:[1,0]
v_pk_mul_f32 v[114:115], v[114:115], v[200:201] op_sel_hi:[1,0]
v_pk_mul_f32 v[116:117], v[116:117], v[200:201] op_sel_hi:[1,0]
v_pk_mul_f32 v[118:119], v[118:119], v[200:201] op_sel_hi:[1,0]
v_cvt_pk_bf16_f32 v220, v112, v113
v_cvt_pk_bf16_f32 v221, v114, v115
v_cvt_pk_bf16_f32 v222, v116, v117
v_cvt_pk_bf16_f32 v223, v118, v119
ds_write_b128 v233, v[220:223] offset:16384
v_pk_mul_f32 v[120:121], v[120:121], v[200:201] op_sel_hi:[1,0]
v_pk_mul_f32 v[122:123], v[122:123], v[200:201] op_sel_hi:[1,0]
v_pk_mul_f32 v[124:125], v[124:125], v[200:201] op_sel_hi:[1,0]
v_pk_mul_f32 v[126:127], v[126:127], v[200:201] op_sel_hi:[1,0]
v_cvt_pk_bf16_f32 v224, v120, v121
v_cvt_pk_bf16_f32 v225, v122, v123
v_cvt_pk_bf16_f32 v226, v124, v125
v_cvt_pk_bf16_f32 v227, v126, v127
ds_write_b128 v234, v[224:227] offset:16384
v_pk_mul_f32 v[128:129], v[128:129], v[200:201] op_sel_hi:[1,0]
v_pk_mul_f32 v[130:131], v[130:131], v[200:201] op_sel_hi:[1,0]
v_pk_mul_f32 v[132:133], v[132:133], v[200:201] op_sel_hi:[1,0]
v_pk_mul_f32 v[134:135], v[134:135], v[200:201] op_sel_hi:[1,0]
v_cvt_pk_bf16_f32 v220, v128, v129
v_cvt_pk_bf16_f32 v221, v130, v131
v_cvt_pk_bf16_f32 v222, v132, v133
v_cvt_pk_bf16_f32 v223, v134, v135
ds_write_b128 v233, v[220:223] offset:16512
v_pk_mul_f32 v[136:137], v[136:137], v[200:201] op_sel_hi:[1,0]
v_pk_mul_f32 v[138:139], v[138:139], v[200:201] op_sel_hi:[1,0]
v_pk_mul_f32 v[140:141], v[140:141], v[200:201] op_sel_hi:[1,0]
v_pk_mul_f32 v[142:143], v[142:143], v[200:201] op_sel_hi:[1,0]
v_cvt_pk_bf16_f32 v224, v136, v137
v_cvt_pk_bf16_f32 v225, v138, v139
v_cvt_pk_bf16_f32 v226, v140, v141
v_cvt_pk_bf16_f32 v227, v142, v143
v_mfma_f32_32x32x16_bf16 v[112:127], v[228:231], v[228:231], 0
ds_write_b128 v234, v[224:227] offset:16512
s_waitcnt lgkmcnt(4)
v_lshlrev_b32 v220, 16, v80
v_and_b32 v221, s31, v80
v_lshlrev_b32 v222, 16, v81
v_and_b32 v223, s31, v81
v_pk_mul_f32 v[220:221], v[220:221], s[38:39]
v_pk_mul_f32 v[222:223], v[222:223], s[38:39]
v_cvt_pk_bf16_f32 v80, v220, v221
v_cvt_pk_bf16_f32 v81, v222, v223
v_lshlrev_b32 v224, 16, v82
v_and_b32 v225, s31, v82
v_lshlrev_b32 v226, 16, v83
v_and_b32 v227, s31, v83
v_pk_mul_f32 v[224:225], v[224:225], s[38:39]
v_pk_mul_f32 v[226:227], v[226:227], s[38:39]
v_cvt_pk_bf16_f32 v82, v224, v225
v_cvt_pk_bf16_f32 v83, v226, v227
v_lshlrev_b32 v220, 16, v84
v_and_b32 v221, s31, v84
v_lshlrev_b32 v222, 16, v85
v_and_b32 v223, s31, v85
v_pk_mul_f32 v[220:221], v[220:221], s[38:39]
v_pk_mul_f32 v[222:223], v[222:223], s[38:39]
v_cvt_pk_bf16_f32 v84, v220, v221
v_cvt_pk_bf16_f32 v85, v222, v223
v_lshlrev_b32 v224, 16, v86
v_and_b32 v225, s31, v86
v_lshlrev_b32 v226, 16, v87
v_and_b32 v227, s31, v87
v_pk_mul_f32 v[224:225], v[224:225], s[38:39]
v_pk_mul_f32 v[226:227], v[226:227], s[38:39]
v_cvt_pk_bf16_f32 v86, v224, v225
v_cvt_pk_bf16_f32 v87, v226, v227
v_lshlrev_b32 v220, 16, v88
v_and_b32 v221, s31, v88
v_lshlrev_b32 v222, 16, v89
v_and_b32 v223, s31, v89
v_pk_mul_f32 v[220:221], v[220:221], s[38:39]
v_pk_mul_f32 v[222:223], v[222:223], s[38:39]
v_cvt_pk_bf16_f32 v88, v220, v221
v_cvt_pk_bf16_f32 v89, v222, v223
v_lshlrev_b32 v224, 16, v90
v_and_b32 v225, s31, v90
v_lshlrev_b32 v226, 16, v91
v_and_b32 v227, s31, v91
v_pk_mul_f32 v[224:225], v[224:225], s[38:39]
v_pk_mul_f32 v[226:227], v[226:227], s[38:39]
v_cvt_pk_bf16_f32 v90, v224, v225
v_cvt_pk_bf16_f32 v91, v226, v227
v_lshlrev_b32 v220, 16, v92
v_and_b32 v221, s31, v92
v_lshlrev_b32 v222, 16, v93
v_and_b32 v223, s31, v93
v_pk_mul_f32 v[220:221], v[220:221], s[38:39]
v_pk_mul_f32 v[222:223], v[222:223], s[38:39]
v_cvt_pk_bf16_f32 v92, v220, v221
v_cvt_pk_bf16_f32 v93, v222, v223
v_lshlrev_b32 v224, 16, v94
v_and_b32 v225, s31, v94
v_lshlrev_b32 v226, 16, v95
v_and_b32 v227, s31, v95
v_pk_mul_f32 v[224:225], v[224:225], s[38:39]
v_pk_mul_f32 v[226:227], v[226:227], s[38:39]
v_cvt_pk_bf16_f32 v94, v224, v225
v_cvt_pk_bf16_f32 v95, v226, v227
v_mov_b32 v14, 0
v_mfma_f32_32x32x16_bf16 v[128:143], v[228:231], v[228:231], 0
v_mfma_f32_16x16x32_bf16 v[176:179], a[192:195], v[16:19], -4.0
ds_read_b64_tr_b16 a[152:153], v2 offset:768
v_add_f32 v15, v15, v188
v_mfma_f32_16x16x32_bf16 v[176:179], a[196:199], v[20:23], v[176:179]
v_exp_f32 v189, v189
v_mfma_f32_16x16x32_bf16 v[176:179], a[200:203], v[24:27], v[176:179]
v_cvt_pk_bf16_f32 v198, v188, v189
v_add_f32 v15, v15, v189
v_mfma_f32_16x16x32_bf16 v[176:179], a[204:207], v[28:31], v[176:179]
v_exp_f32 v190, v190
v_mfma_f32_16x16x32_bf16 v[180:183], a[208:211], v[16:19], -4.0
ds_read_b64_tr_b16 a[154:155], v2 offset:4896
v_add_f32 v15, v15, v190
v_mfma_f32_16x16x32_bf16 v[180:183], a[212:215], v[20:23], v[180:183]
v_exp_f32 v191, v191
v_mfma_f32_16x16x32_bf16 v[180:183], a[216:219], v[24:27], v[180:183]
v_cvt_pk_bf16_f32 v199, v190, v191
v_add_f32 v15, v15, v191
v_mfma_f32_16x16x32_bf16 v[180:183], a[220:223], v[28:31], v[180:183]
v_exp_f32 v176, v176
v_mfma_f32_16x16x32_bf16 v[144:147], a[160:163], v[196:199], v[144:147]
ds_read_b64_tr_b16 a[156:157], v2 offset:776
v_mov_b32 v6, v176
v_mfma_f32_16x16x32_bf16 v[148:151], a[164:167], v[196:199], v[148:151]
v_exp_f32 v177, v177
v_mfma_f32_16x16x32_bf16 v[152:155], a[168:171], v[196:199], v[152:155]
v_cvt_pk_bf16_f32 v192, v176, v177
v_add_f32 v6, v6, v177
v_mfma_f32_16x16x32_bf16 v[156:159], a[172:175], v[196:199], v[156:159]
v_exp_f32 v178, v178
v_mfma_f32_16x16x32_bf16 v[160:163], a[176:179], v[196:199], v[160:163]
ds_read_b64_tr_b16 a[158:159], v2 offset:4904
v_add_f32 v6, v6, v178
v_mfma_f32_16x16x32_bf16 v[164:167], a[180:183], v[196:199], v[164:167]
v_exp_f32 v179, v179
v_mfma_f32_16x16x32_bf16 v[168:171], a[184:187], v[196:199], v[168:171]
v_cvt_pk_bf16_f32 v193, v178, v179
v_add_f32 v6, v6, v179
v_mfma_f32_16x16x32_bf16 v[172:175], a[188:191], v[196:199], v[172:175]
v_exp_f32 v180, v180
v_mfma_f32_16x16x4_f32 v[200:203], v7, v15, 0
s_waitcnt vmcnt(0)
ds_read_b128 v[96:99], v8 offset:20480
ds_read_b128 v[100:103], v8 offset:20736
ds_read_b128 v[104:107], v8 offset:20992
ds_read_b128 v[108:111], v8 offset:21248
s_nop 4
v_rcp_f32 v200, v200
v_subrev_u32 v202, s47, v201
v_max_u32 v9, v9, v202
v_pk_mul_f32 v[144:145], v[144:145], v[200:201] op_sel_hi:[1,0]
v_pk_mul_f32 v[146:147], v[146:147], v[200:201] op_sel_hi:[1,0]
v_pk_mul_f32 v[148:149], v[148:149], v[200:201] op_sel_hi:[1,0]
v_pk_mul_f32 v[150:151], v[150:151], v[200:201] op_sel_hi:[1,0]
v_cvt_pk_bf16_f32 v220, v144, v145
v_cvt_pk_bf16_f32 v221, v146, v147
v_cvt_pk_bf16_f32 v222, v148, v149
v_cvt_pk_bf16_f32 v223, v150, v151
ds_write_b128 v233, v[220:223] offset:20480
v_pk_mul_f32 v[152:153], v[152:153], v[200:201] op_sel_hi:[1,0]
v_pk_mul_f32 v[154:155], v[154:155], v[200:201] op_sel_hi:[1,0]
v_pk_mul_f32 v[156:157], v[156:157], v[200:201] op_sel_hi:[1,0]
v_pk_mul_f32 v[158:159], v[158:159], v[200:201] op_sel_hi:[1,0]
v_cvt_pk_bf16_f32 v224, v152, v153
v_cvt_pk_bf16_f32 v225, v154, v155
v_cvt_pk_bf16_f32 v226, v156, v157
v_cvt_pk_bf16_f32 v227, v158, v159
ds_write_b128 v234, v[224:227] offset:20480
v_pk_mul_f32 v[160:161], v[160:161], v[200:201] op_sel_hi:[1,0]
v_pk_mul_f32 v[162:163], v[162:163], v[200:201] op_sel_hi:[1,0]
v_pk_mul_f32 v[164:165], v[164:165], v[200:201] op_sel_hi:[1,0]
v_pk_mul_f32 v[166:167], v[166:167], v[200:201] op_sel_hi:[1,0]
v_cvt_pk_bf16_f32 v220, v160, v161
v_cvt_pk_bf16_f32 v221, v162, v163
v_cvt_pk_bf16_f32 v222, v164, v165
v_cvt_pk_bf16_f32 v223, v166, v167
ds_write_b128 v233, v[220:223] offset:20608
v_pk_mul_f32 v[168:169], v[168:169], v[200:201] op_sel_hi:[1,0]
v_pk_mul_f32 v[170:171], v[170:171], v[200:201] op_sel_hi:[1,0]
v_pk_mul_f32 v[172:173], v[172:173], v[200:201] op_sel_hi:[1,0]
v_pk_mul_f32 v[174:175], v[174:175], v[200:201] op_sel_hi:[1,0]
v_cvt_pk_bf16_f32 v224, v168, v169
v_cvt_pk_bf16_f32 v225, v170, v171
v_cvt_pk_bf16_f32 v226, v172, v173
v_cvt_pk_bf16_f32 v227, v174, v175
v_mfma_f32_32x32x16_bf16 v[144:159], v[228:231], v[228:231], 0
ds_write_b128 v234, v[224:227] offset:20608
s_waitcnt lgkmcnt(4)
v_lshlrev_b32 v220, 16, v96
v_and_b32 v221, s31, v96
v_lshlrev_b32 v222, 16, v97
v_and_b32 v223, s31, v97
v_pk_mul_f32 v[220:221], v[220:221], s[38:39]
v_pk_mul_f32 v[222:223], v[222:223], s[38:39]
v_cvt_pk_bf16_f32 v96, v220, v221
v_cvt_pk_bf16_f32 v97, v222, v223
v_lshlrev_b32 v224, 16, v98
v_and_b32 v225, s31, v98
v_lshlrev_b32 v226, 16, v99
v_and_b32 v227, s31, v99
v_pk_mul_f32 v[224:225], v[224:225], s[38:39]
v_pk_mul_f32 v[226:227], v[226:227], s[38:39]
v_cvt_pk_bf16_f32 v98, v224, v225
v_cvt_pk_bf16_f32 v99, v226, v227
v_lshlrev_b32 v220, 16, v100
v_and_b32 v221, s31, v100
v_lshlrev_b32 v222, 16, v101
v_and_b32 v223, s31, v101
v_pk_mul_f32 v[220:221], v[220:221], s[38:39]
v_pk_mul_f32 v[222:223], v[222:223], s[38:39]
v_cvt_pk_bf16_f32 v100, v220, v221
v_cvt_pk_bf16_f32 v101, v222, v223
v_lshlrev_b32 v224, 16, v102
v_and_b32 v225, s31, v102
v_lshlrev_b32 v226, 16, v103
v_and_b32 v227, s31, v103
v_pk_mul_f32 v[224:225], v[224:225], s[38:39]
v_pk_mul_f32 v[226:227], v[226:227], s[38:39]
v_cvt_pk_bf16_f32 v102, v224, v225
v_cvt_pk_bf16_f32 v103, v226, v227
v_lshlrev_b32 v220, 16, v104
v_and_b32 v221, s31, v104
v_lshlrev_b32 v222, 16, v105
v_and_b32 v223, s31, v105
v_pk_mul_f32 v[220:221], v[220:221], s[38:39]
v_pk_mul_f32 v[222:223], v[222:223], s[38:39]
v_cvt_pk_bf16_f32 v104, v220, v221
v_cvt_pk_bf16_f32 v105, v222, v223
v_lshlrev_b32 v224, 16, v106
v_and_b32 v225, s31, v106
v_lshlrev_b32 v226, 16, v107
v_and_b32 v227, s31, v107
v_pk_mul_f32 v[224:225], v[224:225], s[38:39]
v_pk_mul_f32 v[226:227], v[226:227], s[38:39]
v_cvt_pk_bf16_f32 v106, v224, v225
v_cvt_pk_bf16_f32 v107, v226, v227
v_lshlrev_b32 v220, 16, v108
v_and_b32 v221, s31, v108
v_lshlrev_b32 v222, 16, v109
v_and_b32 v223, s31, v109
v_pk_mul_f32 v[220:221], v[220:221], s[38:39]
v_pk_mul_f32 v[222:223], v[222:223], s[38:39]
v_cvt_pk_bf16_f32 v108, v220, v221
v_cvt_pk_bf16_f32 v109, v222, v223
v_lshlrev_b32 v224, 16, v110
v_and_b32 v225, s31, v110
v_lshlrev_b32 v226, 16, v111
v_and_b32 v227, s31, v111
v_pk_mul_f32 v[224:225], v[224:225], s[38:39]
v_pk_mul_f32 v[226:227], v[226:227], s[38:39]
v_cvt_pk_bf16_f32 v110, v224, v225
v_cvt_pk_bf16_f32 v111, v226, v227
v_mov_b32 v15, 0
v_mfma_f32_32x32x16_bf16 v[160:175], v[228:231], v[228:231], 0
s_mov_b32 s29, 1
s_add_u32 s27, s27, 188416
s_mov_b32 s25, 0x7f000000
s_mov_b32 s37, 0
s_mov_b32 s26, 160000
s_mov_b32 s36, 6
s_mov_b32 s28, 0
s_mov_b32 s91, 1
s_sub_u32 s3, s27, 188416
.p2align 6
L_loop1A:
v_mfma_f32_16x16x32_bf16 v[184:187], a[192:195], v[32:35], -4.0
v_add_f32 v10, v10, v180
v_add_f32 v10, v10, v6
v_mfma_f32_16x16x32_bf16 v[184:187], a[196:199], v[36:39], v[184:187]
v_exp_f32 v181, v181
v_mfma_f32_16x16x32_bf16 v[184:187], a[200:203], v[40:43], v[184:187]
v_cvt_pk_bf16_f32 v194, v180, v181
v_add_f32 v10, v10, v181
v_mfma_f32_16x16x32_bf16 v[184:187], a[204:207], v[44:47], v[184:187]
v_exp_f32 v182, v182
v_mfma_f32_16x16x32_bf16 v[188:191], a[208:211], v[32:35], -4.0
v_add_f32 v10, v10, v182
v_mfma_f32_16x16x32_bf16 v[188:191], a[212:215], v[36:39], v[188:191]
v_exp_f32 v183, v183
v_mfma_f32_16x16x32_bf16 v[188:191], a[216:219], v[40:43], v[188:191]
s_waitcnt lgkmcnt(0)
v_cvt_pk_bf16_f32 v195, v182, v183
v_add_f32 v10, v10, v183
v_mfma_f32_16x16x32_bf16 v[188:191], a[220:223], v[44:47], v[188:191]
s_barrier
v_exp_f32 v184, v184
v_mfma_f32_16x16x32_bf16 a[0:3], a[128:131], v[192:195], a[0:3]
ds_read_b128 a[224:227], v1 offset:8192
v_add_f32 v11, v11, v184
v_mfma_f32_16x16x32_bf16 a[4:7], a[132:135], v[192:195], a[4:7]
v_exp_f32 v185, v185
v_mfma_f32_16x16x32_bf16 a[8:11], a[136:139], v[192:195], a[8:11]
s_cmp_ge_u32 s28, 6
v_cvt_pk_bf16_f32 v196, v184, v185
v_add_f32 v11, v11, v185
v_mfma_f32_16x16x32_bf16 a[12:15], a[140:143], v[192:195], a[12:15]
s_cselect_b32 s3, 0x7f000000, s3
v_exp_f32 v186, v186
v_mfma_f32_16x16x32_bf16 a[16:19], a[144:147], v[192:195], a[16:19]
ds_read_b128 a[228:231], v1 offset:8448
v_add_f32 v11, v11, v186
v_mfma_f32_16x16x32_bf16 a[20:23], a[148:151], v[192:195], a[20:23]
s_cmp_ge_u32 s28, 5
v_exp_f32 v187, v187
v_mfma_f32_16x16x32_bf16 a[24:27], a[152:155], v[192:195], a[24:27]
s_cselect_b32 s37, 0, 4096
v_cvt_pk_bf16_f32 v197, v186, v187
v_add_f32 v11, v11, v187
v_mfma_f32_16x16x32_bf16 a[28:31], a[156:159], v[192:195], a[28:31]
ds_read_b128 v[240:243], v235 offset:0
v_exp_f32 v188, v188
v_mfma_f32_16x16x32_bf16 v[176:179], a[192:195], v[48:51], -4.0
ds_read_b128 a[232:235], v1 offset:8704
v_add_f32 v11, v11, v188
v_mfma_f32_16x16x32_bf16 v[176:179], a[196:199], v[52:55], v[176:179]
v_exp_f32 v189, v189
v_mfma_f32_16x16x32_bf16 v[176:179], a[200:203], v[56:59], v[176:179]
v_cvt_pk_bf16_f32 v198, v188, v189
v_add_f32 v11, v11, v189
v_mfma_f32_16x16x32_bf16 v[176:179], a[204:207], v[60:63], v[176:179]
v_exp_f32 v190, v190
v_mfma_f32_16x16x32_bf16 v[180:183], a[208:211], v[48:51], -4.0
ds_read_b128 a[236:239], v1 offset:8960
v_add_f32 v11, v11, v190
v_mfma_f32_16x16x32_bf16 v[180:183], a[212:215], v[52:55], v[180:183]
v_exp_f32 v191, v191
v_mfma_f32_16x16x32_bf16 v[180:183], a[216:219], v[56:59], v[180:183]
v_cvt_pk_bf16_f32 v199, v190, v191
v_add_f32 v11, v11, v191
v_mfma_f32_16x16x32_bf16 v[180:183], a[220:223], v[60:63], v[180:183]
v_exp_f32 v176, v176
v_mfma_f32_16x16x32_bf16 a[32:35], a[128:131], v[196:199], a[32:35]
ds_read_b128 a[240:243], v1 offset:12288
v_add_f32 v12, v12, v176
v_mfma_f32_16x16x32_bf16 a[36:39], a[132:135], v[196:199], a[36:39]
v_exp_f32 v177, v177
v_mfma_f32_16x16x32_bf16 a[40:43], a[136:139], v[196:199], a[40:43]
v_cvt_pk_bf16_f32 v192, v176, v177
v_add_f32 v12, v12, v177
v_mfma_f32_16x16x32_bf16 a[44:47], a[140:143], v[196:199], a[44:47]
v_exp_f32 v178, v178
v_mfma_f32_16x16x32_bf16 a[48:51], a[144:147], v[196:199], a[48:51]
ds_read_b128 a[244:247], v1 offset:12544
v_add_f32 v12, v12, v178
v_mfma_f32_16x16x32_bf16 a[52:55], a[148:151], v[196:199], a[52:55]
ds_read_b128 a[248:251], v1 offset:12800
v_exp_f32 v179, v179
v_mfma_f32_16x16x32_bf16 a[56:59], a[152:155], v[196:199], a[56:59]
ds_read_b128 v[244:247], v236 offset:1024
v_cvt_pk_bf16_f32 v193, v178, v179
v_add_f32 v12, v12, v179
v_mfma_f32_16x16x32_bf16 a[60:63], a[156:159], v[196:199], a[60:63]
s_waitcnt lgkmcnt(6)
v_exp_f32 v180, v180
v_mfma_f32_16x16x32_bf16 v[184:187], a[192:195], v[64:67], -4.0
ds_read_b128 a[252:255], v1 offset:13056
v_add_f32 v12, v12, v180
v_mfma_f32_16x16x32_bf16 v[184:187], a[196:199], v[68:71], v[184:187]
v_exp_f32 v181, v181
v_mfma_f32_16x16x32_bf16 v[184:187], a[200:203], v[72:75], v[184:187]
v_cvt_pk_bf16_f32 v194, v180, v181
v_add_f32 v12, v12, v181
v_mfma_f32_16x16x32_bf16 v[184:187], a[204:207], v[76:79], v[184:187]
v_exp_f32 v182, v182
v_mfma_f32_16x16x32_bf16 v[188:191], a[208:211], v[64:67], -4.0
ds_read_b64_tr_b16 a[160:161], v2 offset:8256
v_add_f32 v12, v12, v182
v_mfma_f32_16x16x32_bf16 v[188:191], a[212:215], v[68:71], v[188:191]
v_exp_f32 v183, v183
v_mfma_f32_16x16x32_bf16 v[188:191], a[216:219], v[72:75], v[188:191]
v_cvt_pk_bf16_f32 v195, v182, v183
v_add_f32 v12, v12, v183
v_mfma_f32_16x16x32_bf16 v[188:191], a[220:223], v[76:79], v[188:191]
v_exp_f32 v184, v184
v_mfma_f32_16x16x32_bf16 a[64:67], a[128:131], v[192:195], a[64:67]
ds_read_b64_tr_b16 a[162:163], v2 offset:12384
v_add_f32 v13, v13, v184
v_mfma_f32_16x16x32_bf16 a[68:71], a[132:135], v[192:195], a[68:71]
v_exp_f32 v185, v185
v_mfma_f32_16x16x32_bf16 a[72:75], a[136:139], v[192:195], a[72:75]
v_cvt_pk_bf16_f32 v196, v184, v185
v_add_f32 v13, v13, v185
v_mfma_f32_16x16x32_bf16 a[76:79], a[140:143], v[192:195], a[76:79]
v_exp_f32 v186, v186
v_mfma_f32_16x16x32_bf16 a[80:83], a[144:147], v[192:195], a[80:83]
ds_read_b64_tr_b16 a[164:165], v2 offset:8264
v_add_f32 v13, v13, v186
v_mfma_f32_16x16x32_bf16 a[84:87], a[148:151], v[192:195], a[84:87]
buffer_store_dwordx4 v[240:243], v237, s[16:19], s3 offen offset:0 sc1
v_exp_f32 v187, v187
v_mfma_f32_16x16x32_bf16 a[88:91], a[152:155], v[192:195], a[88:91]
s_waitcnt lgkmcnt(4)
v_cvt_pk_bf16_f32 v197, v186, v187
v_add_f32 v13, v13, v187
v_mfma_f32_16x16x32_bf16 a[92:95], a[156:159], v[192:195], a[92:95]
v_exp_f32 v188, v188
v_mfma_f32_16x16x32_bf16 v[176:179], a[192:195], v[80:83], -4.0
ds_read_b64_tr_b16 a[166:167], v2 offset:12392
v_add_f32 v13, v13, v188
v_mfma_f32_16x16x32_bf16 v[176:179], a[196:199], v[84:87], v[176:179]
v_exp_f32 v189, v189
v_mfma_f32_16x16x32_bf16 v[176:179], a[200:203], v[88:91], v[176:179]
v_cvt_pk_bf16_f32 v198, v188, v189
v_add_f32 v13, v13, v189
v_mfma_f32_16x16x32_bf16 v[176:179], a[204:207], v[92:95], v[176:179]
v_exp_f32 v190, v190
v_mfma_f32_16x16x32_bf16 v[180:183], a[208:211], v[80:83], -4.0
ds_read_b64_tr_b16 a[168:169], v2 offset:8512
v_add_f32 v13, v13, v190
v_mfma_f32_16x16x32_bf16 v[180:183], a[212:215], v[84:87], v[180:183]
v_exp_f32 v191, v191
v_mfma_f32_16x16x32_bf16 v[180:183], a[216:219], v[88:91], v[180:183]
v_cvt_pk_bf16_f32 v199, v190, v191
v_add_f32 v13, v13, v191
v_mfma_f32_16x16x32_bf16 v[180:183], a[220:223], v[92:95], v[180:183]
v_exp_f32 v176, v176
v_mfma_f32_16x16x32_bf16 a[96:99], a[128:131], v[196:199], a[96:99]
ds_read_b64_tr_b16 a[170:171], v2 offset:12640
v_add_f32 v14, v14, v176
v_mfma_f32_16x16x32_bf16 a[100:103], a[132:135], v[196:199], a[100:103]
v_exp_f32 v177, v177
v_mfma_f32_16x16x32_bf16 a[104:107], a[136:139], v[196:199], a[104:107]
v_cvt_pk_bf16_f32 v192, v176, v177
v_add_f32 v14, v14, v177
v_mfma_f32_16x16x32_bf16 a[108:111], a[140:143], v[196:199], a[108:111]
buffer_store_dwordx4 v[244:247], v237, s[16:19], s3 offen offset:1024 sc1
v_exp_f32 v178, v178
v_mfma_f32_16x16x32_bf16 a[112:115], a[144:147], v[196:199], a[112:115]
ds_read_b64_tr_b16 a[172:173], v2 offset:8520
v_add_f32 v14, v14, v178
v_mfma_f32_16x16x32_bf16 a[116:119], a[148:151], v[196:199], a[116:119]
v_exp_f32 v179, v179
v_mfma_f32_16x16x32_bf16 a[120:123], a[152:155], v[196:199], a[120:123]
v_cvt_pk_bf16_f32 v193, v178, v179
v_add_f32 v14, v14, v179
v_mfma_f32_16x16x32_bf16 a[124:127], a[156:159], v[196:199], a[124:127]
v_exp_f32 v180, v180
v_mfma_f32_16x16x32_bf16 v[184:187], a[192:195], v[96:99], -4.0
ds_read_b64_tr_b16 a[174:175], v2 offset:12648
v_add_f32 v14, v14, v180
v_mfma_f32_16x16x32_bf16 v[184:187], a[196:199], v[100:103], v[184:187]
v_exp_f32 v181, v181
v_mfma_f32_16x16x32_bf16 v[184:187], a[200:203], v[104:107], v[184:187]
v_cvt_pk_bf16_f32 v194, v180, v181
v_add_f32 v14, v14, v181
v_mfma_f32_16x16x32_bf16 v[184:187], a[204:207], v[108:111], v[184:187]
v_exp_f32 v182, v182
v_mfma_f32_16x16x32_bf16 v[188:191], a[208:211], v[96:99], -4.0
ds_read_b64_tr_b16 a[176:177], v2 offset:8768
v_add_f32 v14, v14, v182
v_mfma_f32_16x16x32_bf16 v[188:191], a[212:215], v[100:103], v[188:191]
v_exp_f32 v183, v183
v_mfma_f32_16x16x32_bf16 v[188:191], a[216:219], v[104:107], v[188:191]
ds_read_b64_tr_b16 a[178:179], v2 offset:12896
v_cvt_pk_bf16_f32 v195, v182, v183
v_add_f32 v14, v14, v183
v_mfma_f32_16x16x32_bf16 v[188:191], a[220:223], v[108:111], v[188:191]
v_exp_f32 v184, v184
v_mfma_f32_16x16x32_bf16 v[112:115], a[128:131], v[192:195], v[112:115]
ds_read_b64_tr_b16 a[180:181], v2 offset:8776
v_add_f32 v15, v15, v184
v_mfma_f32_16x16x32_bf16 v[116:119], a[132:135], v[192:195], v[116:119]
v_exp_f32 v185, v185
v_mfma_f32_16x16x32_bf16 v[120:123], a[136:139], v[192:195], v[120:123]
v_cvt_pk_bf16_f32 v196, v184, v185
v_add_f32 v15, v15, v185
v_mfma_f32_16x16x32_bf16 v[124:127], a[140:143], v[192:195], v[124:127]
v_exp_f32 v186, v186
v_mfma_f32_16x16x32_bf16 v[128:131], a[144:147], v[192:195], v[128:131]
ds_read_b64_tr_b16 a[182:183], v2 offset:12904
v_add_f32 v15, v15, v186
v_mfma_f32_16x16x32_bf16 v[132:135], a[148:151], v[192:195], v[132:135]
v_exp_f32 v187, v187
v_mfma_f32_16x16x32_bf16 v[136:139], a[152:155], v[192:195], v[136:139]
v_cvt_pk_bf16_f32 v197, v186, v187
v_add_f32 v15, v15, v187
v_mfma_f32_16x16x32_bf16 v[140:143], a[156:159], v[192:195], v[140:143]
s_waitcnt lgkmcnt(8)
v_exp_f32 v188, v188
v_mfma_f32_16x16x32_bf16 v[176:179], a[224:227], v[16:19], -4.0
ds_read_b64_tr_b16 a[184:185], v2 offset:9024
v_add_f32 v15, v15, v188
v_mfma_f32_16x16x32_bf16 v[176:179], a[228:231], v[20:23], v[176:179]
v_exp_f32 v189, v189
v_mfma_f32_16x16x32_bf16 v[176:179], a[232:235], v[24:27], v[176:179]
v_cvt_pk_bf16_f32 v198, v188, v189
v_add_f32 v15, v15, v189
v_mfma_f32_16x16x32_bf16 v[176:179], a[236:239], v[28:31], v[176:179]
v_exp_f32 v190, v190
v_mfma_f32_16x16x32_bf16 v[180:183], a[240:243], v[16:19], -4.0
ds_read_b64_tr_b16 a[186:187], v2 offset:13152
v_add_f32 v15, v15, v190
v_mfma_f32_16x16x32_bf16 v[180:183], a[244:247], v[20:23], v[180:183]
v_exp_f32 v191, v191
v_mfma_f32_16x16x32_bf16 v[180:183], a[248:251], v[24:27], v[180:183]
v_cvt_pk_bf16_f32 v199, v190, v191
v_add_f32 v15, v15, v191
v_mfma_f32_16x16x32_bf16 v[180:183], a[252:255], v[28:31], v[180:183]
v_exp_f32 v176, v176
v_mfma_f32_16x16x32_bf16 v[144:147], a[128:131], v[196:199], v[144:147]
ds_read_b64_tr_b16 a[188:189], v2 offset:9032
v_add_f32 v10, v10, v176
v_mfma_f32_16x16x32_bf16 v[148:151], a[132:135], v[196:199], v[148:151]
v_exp_f32 v177, v177
v_mfma_f32_16x16x32_bf16 v[152:155], a[136:139], v[196:199], v[152:155]
v_cvt_pk_bf16_f32 v192, v176, v177
v_add_f32 v10, v10, v177
v_mfma_f32_16x16x32_bf16 v[156:159], a[140:143], v[196:199], v[156:159]
v_exp_f32 v178, v178
v_mfma_f32_16x16x32_bf16 v[160:163], a[144:147], v[196:199], v[160:163]
ds_read_b64_tr_b16 a[190:191], v2 offset:13160
v_add_f32 v10, v10, v178
v_mfma_f32_16x16x32_bf16 v[164:167], a[148:151], v[196:199], v[164:167]
v_exp_f32 v179, v179
v_mfma_f32_16x16x32_bf16 v[168:171], a[152:155], v[196:199], v[168:171]
v_cvt_pk_bf16_f32 v193, v178, v179
v_add_f32 v10, v10, v179
v_mfma_f32_16x16x32_bf16 v[172:175], a[156:159], v[196:199], v[172:175]
v_exp_f32 v180, v180
v_mfma_f32_16x16x32_bf16 v[184:187], a[224:227], v[32:35], -4.0
v_add_f32 v10, v10, v180
v_xor_b32 v1, 0x4000, v1
v_mfma_f32_16x16x32_bf16 v[184:187], a[228:231], v[36:39], v[184:187]
v_exp_f32 v181, v181
v_mfma_f32_16x16x32_bf16 v[184:187], a[232:235], v[40:43], v[184:187]
v_cvt_pk_bf16_f32 v194, v180, v181
v_add_f32 v10, v10, v181
v_mfma_f32_16x16x32_bf16 v[184:187], a[236:239], v[44:47], v[184:187]
v_exp_f32 v182, v182
v_mfma_f32_16x16x32_bf16 v[188:191], a[240:243], v[32:35], -4.0
v_add_f32 v10, v10, v182
v_add_u32 v2, s30, v2
v_mfma_f32_16x16x32_bf16 v[188:191], a[244:247], v[36:39], v[188:191]
s_sub_u32 s30, 0, s30
v_exp_f32 v183, v183
v_mfma_f32_16x16x32_bf16 v[188:191], a[248:251], v[40:43], v[188:191]
s_waitcnt lgkmcnt(0)
v_cvt_pk_bf16_f32 v195, v182, v183
v_add_f32 v10, v10, v183
v_mfma_f32_16x16x32_bf16 v[188:191], a[252:255], v[44:47], v[188:191]
s_barrier
v_exp_f32 v184, v184
v_mfma_f32_16x16x32_bf16 a[0:3], a[160:163], v[192:195], a[0:3]
ds_read_b128 a[192:195], v1 offset:0
v_add_f32 v11, v11, v184
v_mfma_f32_16x16x32_bf16 a[4:7], a[164:167], v[192:195], a[4:7]
v_exp_f32 v185, v185
v_mfma_f32_16x16x32_bf16 a[8:11], a[168:171], v[192:195], a[8:11]
ds_read_b128 v[248:251], v235 offset:2048
v_cvt_pk_bf16_f32 v196, v184, v185
v_add_f32 v11, v11, v185
v_mfma_f32_16x16x32_bf16 a[12:15], a[172:175], v[192:195], a[12:15]
v_exp_f32 v186, v186
v_mfma_f32_16x16x32_bf16 a[16:19], a[176:179], v[192:195], a[16:19]
ds_read_b128 a[196:199], v1 offset:256
v_add_f32 v11, v11, v186
v_mfma_f32_16x16x32_bf16 a[20:23], a[180:183], v[192:195], a[20:23]
v_exp_f32 v187, v187
v_mfma_f32_16x16x32_bf16 a[24:27], a[184:187], v[192:195], a[24:27]
v_cvt_pk_bf16_f32 v197, v186, v187
v_add_f32 v11, v11, v187
v_mfma_f32_16x16x32_bf16 a[28:31], a[188:191], v[192:195], a[28:31]
v_exp_f32 v188, v188
v_mfma_f32_16x16x32_bf16 v[176:179], a[224:227], v[48:51], -4.0
ds_read_b128 a[200:203], v1 offset:512
v_add_f32 v11, v11, v188
v_mfma_f32_16x16x32_bf16 v[176:179], a[228:231], v[52:55], v[176:179]
v_exp_f32 v189, v189
v_mfma_f32_16x16x32_bf16 v[176:179], a[232:235], v[56:59], v[176:179]
v_cvt_pk_bf16_f32 v198, v188, v189
v_add_f32 v11, v11, v189
v_mfma_f32_16x16x32_bf16 v[176:179], a[236:239], v[60:63], v[176:179]
v_exp_f32 v190, v190
v_mfma_f32_16x16x32_bf16 v[180:183], a[240:243], v[48:51], -4.0
ds_read_b128 a[204:207], v1 offset:768
v_add_f32 v11, v11, v190
v_mfma_f32_16x16x32_bf16 v[180:183], a[244:247], v[52:55], v[180:183]
v_exp_f32 v191, v191
v_mfma_f32_16x16x32_bf16 v[180:183], a[248:251], v[56:59], v[180:183]
L_pad4:
s_cbranch_execz L_pad8
v_cvt_pk_bf16_f32 v199, v190, v191
v_add_f32 v11, v11, v191
v_mfma_f32_16x16x32_bf16 v[180:183], a[252:255], v[60:63], v[180:183]
v_exp_f32 v176, v176
v_mfma_f32_16x16x32_bf16 a[32:35], a[160:163], v[196:199], a[32:35]
ds_read_b128 a[208:211], v1 offset:4096
v_add_f32 v12, v12, v176
v_mfma_f32_16x16x32_bf16 a[36:39], a[164:167], v[196:199], a[36:39]
ds_read_b128 v[252:255], v236 offset:3072
v_exp_f32 v177, v177
v_mfma_f32_16x16x32_bf16 a[40:43], a[168:171], v[196:199], a[40:43]
s_waitcnt lgkmcnt(5)
v_cvt_pk_bf16_f32 v192, v176, v177
v_add_f32 v12, v12, v177
v_mfma_f32_16x16x32_bf16 a[44:47], a[172:175], v[196:199], a[44:47]
v_exp_f32 v178, v178
v_mfma_f32_16x16x32_bf16 a[48:51], a[176:179], v[196:199], a[48:51]
ds_read_b128 a[212:215], v1 offset:4352
v_add_f32 v12, v12, v178
v_mfma_f32_16x16x32_bf16 a[52:55], a[180:183], v[196:199], a[52:55]
ds_read_b128 a[216:219], v1 offset:4608
v_exp_f32 v179, v179
v_mfma_f32_16x16x32_bf16 a[56:59], a[184:187], v[196:199], a[56:59]
v_cvt_pk_bf16_f32 v193, v178, v179
v_add_f32 v12, v12, v179
v_mfma_f32_16x16x32_bf16 a[60:63], a[188:191], v[196:199], a[60:63]
v_exp_f32 v180, v180
v_mfma_f32_16x16x32_bf16 v[184:187], a[224:227], v[64:67], -4.0
ds_read_b128 a[220:223], v1 offset:4864
v_add_f32 v12, v12, v180
v_mfma_f32_16x16x32_bf16 v[184:187], a[228:231], v[68:71], v[184:187]
v_exp_f32 v181, v181
v_mfma_f32_16x16x32_bf16 v[184:187], a[232:235], v[72:75], v[184:187]
v_cvt_pk_bf16_f32 v194, v180, v181
v_add_f32 v12, v12, v181
v_mfma_f32_16x16x32_bf16 v[184:187], a[236:239], v[76:79], v[184:187]
v_exp_f32 v182, v182
v_mfma_f32_16x16x32_bf16 v[188:191], a[240:243], v[64:67], -4.0
ds_read_b64_tr_b16 a[128:129], v2 offset:0
v_add_f32 v12, v12, v182
v_mfma_f32_16x16x32_bf16 v[188:191], a[244:247], v[68:71], v[188:191]
v_exp_f32 v183, v183
v_mfma_f32_16x16x32_bf16 v[188:191], a[248:251], v[72:75], v[188:191]
v_cvt_pk_bf16_f32 v195, v182, v183
v_add_f32 v12, v12, v183
v_mfma_f32_16x16x32_bf16 v[188:191], a[252:255], v[76:79], v[188:191]
buffer_store_dwordx4 v[248:251], v237, s[16:19], s3 offen offset:2048 sc1
v_exp_f32 v184, v184
v_mfma_f32_16x16x32_bf16 a[64:67], a[160:163], v[192:195], a[64:67]
ds_read_b64_tr_b16 a[130:131], v2 offset:4128
v_add_f32 v13, v13, v184
v_mfma_f32_16x16x32_bf16 a[68:71], a[164:167], v[192:195], a[68:71]
s_waitcnt lgkmcnt(5)
v_exp_f32 v185, v185
v_mfma_f32_16x16x32_bf16 a[72:75], a[168:171], v[192:195], a[72:75]
v_cvt_pk_bf16_f32 v196, v184, v185
v_add_f32 v13, v13, v185
v_mfma_f32_16x16x32_bf16 a[76:79], a[172:175], v[192:195], a[76:79]
v_exp_f32 v186, v186
v_mfma_f32_16x16x32_bf16 a[80:83], a[176:179], v[192:195], a[80:83]
ds_read_b64_tr_b16 a[132:133], v2 offset:8
v_add_f32 v13, v13, v186
v_mfma_f32_16x16x32_bf16 a[84:87], a[180:183], v[192:195], a[84:87]
v_exp_f32 v187, v187
v_mfma_f32_16x16x32_bf16 a[88:91], a[184:187], v[192:195], a[88:91]
v_cvt_pk_bf16_f32 v197, v186, v187
v_add_f32 v13, v13, v187
v_mfma_f32_16x16x32_bf16 a[92:95], a[188:191], v[192:195], a[92:95]
v_exp_f32 v188, v188
v_mfma_f32_16x16x32_bf16 v[176:179], a[224:227], v[80:83], -4.0
ds_read_b64_tr_b16 a[134:135], v2 offset:4136
v_add_f32 v13, v13, v188
v_mfma_f32_16x16x32_bf16 v[176:179], a[228:231], v[84:87], v[176:179]
v_exp_f32 v189, v189
v_mfma_f32_16x16x32_bf16 v[176:179], a[232:235], v[88:91], v[176:179]
v_cvt_pk_bf16_f32 v198, v188, v189
v_add_f32 v13, v13, v189
v_mfma_f32_16x16x32_bf16 v[176:179], a[236:239], v[92:95], v[176:179]
v_exp_f32 v190, v190
v_mfma_f32_16x16x32_bf16 v[180:183], a[240:243], v[80:83], -4.0
ds_read_b64_tr_b16 a[136:137], v2 offset:256
v_add_f32 v13, v13, v190
v_mfma_f32_16x16x32_bf16 v[180:183], a[244:247], v[84:87], v[180:183]
buffer_store_dwordx4 v[252:255], v237, s[16:19], s3 offen offset:3072 sc1
v_exp_f32 v191, v191
v_mfma_f32_16x16x32_bf16 v[180:183], a[248:251], v[88:91], v[180:183]
s_add_u32 s3, s3, 4096
v_cvt_pk_bf16_f32 v199, v190, v191
v_add_f32 v13, v13, v191
v_add_u32 v235, s37, v235
v_add_u32 v236, s37, v236
v_mfma_f32_16x16x32_bf16 v[180:183], a[252:255], v[92:95], v[180:183]
v_exp_f32 v176, v176
v_mfma_f32_16x16x32_bf16 a[96:99], a[160:163], v[196:199], a[96:99]
ds_read_b64_tr_b16 a[138:139], v2 offset:4384
v_add_f32 v14, v14, v176
v_mfma_f32_16x16x32_bf16 a[100:103], a[164:167], v[196:199], a[100:103]
v_exp_f32 v177, v177
v_mfma_f32_16x16x32_bf16 a[104:107], a[168:171], v[196:199], a[104:107]
v_cvt_pk_bf16_f32 v192, v176, v177
v_add_f32 v14, v14, v177
v_mfma_f32_16x16x32_bf16 a[108:111], a[172:175], v[196:199], a[108:111]
v_exp_f32 v178, v178
v_mfma_f32_16x16x32_bf16 a[112:115], a[176:179], v[196:199], a[112:115]
ds_read_b64_tr_b16 a[140:141], v2 offset:264
v_add_f32 v14, v14, v178
v_mfma_f32_16x16x32_bf16 a[116:119], a[180:183], v[196:199], a[116:119]
v_exp_f32 v179, v179
v_mfma_f32_16x16x32_bf16 a[120:123], a[184:187], v[196:199], a[120:123]
v_cvt_pk_bf16_f32 v193, v178, v179
v_add_f32 v14, v14, v179
v_mfma_f32_16x16x32_bf16 a[124:127], a[188:191], v[196:199], a[124:127]
v_exp_f32 v180, v180
v_mfma_f32_16x16x32_bf16 v[184:187], a[224:227], v[96:99], -4.0
ds_read_b64_tr_b16 a[142:143], v2 offset:4392
v_add_f32 v14, v14, v180
v_mfma_f32_16x16x32_bf16 v[184:187], a[228:231], v[100:103], v[184:187]
v_exp_f32 v181, v181
v_mfma_f32_16x16x32_bf16 v[184:187], a[232:235], v[104:107], v[184:187]
v_cvt_pk_bf16_f32 v194, v180, v181
v_add_f32 v14, v14, v181
v_mfma_f32_16x16x32_bf16 v[184:187], a[236:239], v[108:111], v[184:187]
v_exp_f32 v182, v182
v_mfma_f32_16x16x32_bf16 v[188:191], a[240:243], v[96:99], -4.0
ds_read_b64_tr_b16 a[144:145], v2 offset:512
v_add_f32 v14, v14, v182
v_mfma_f32_16x16x32_bf16 v[188:191], a[244:247], v[100:103], v[188:191]
v_exp_f32 v183, v183
v_mfma_f32_16x16x32_bf16 v[188:191], a[248:251], v[104:107], v[188:191]
ds_read_b64_tr_b16 a[146:147], v2 offset:4640
v_cvt_pk_bf16_f32 v195, v182, v183
v_add_f32 v14, v14, v183
v_mfma_f32_16x16x32_bf16 v[188:191], a[252:255], v[108:111], v[188:191]
v_exp_f32 v184, v184
v_mfma_f32_16x16x32_bf16 v[112:115], a[160:163], v[192:195], v[112:115]
ds_read_b64_tr_b16 a[148:149], v2 offset:520
v_add_f32 v15, v15, v184
v_mfma_f32_16x16x32_bf16 v[116:119], a[164:167], v[192:195], v[116:119]
v_exp_f32 v185, v185
v_mfma_f32_16x16x32_bf16 v[120:123], a[168:171], v[192:195], v[120:123]
v_cvt_pk_bf16_f32 v196, v184, v185
v_add_f32 v15, v15, v185
v_mfma_f32_16x16x32_bf16 v[124:127], a[172:175], v[192:195], v[124:127]
v_exp_f32 v186, v186
v_mfma_f32_16x16x32_bf16 v[128:131], a[176:179], v[192:195], v[128:131]
ds_read_b64_tr_b16 a[150:151], v2 offset:4648
v_add_f32 v15, v15, v186
v_mfma_f32_16x16x32_bf16 v[132:135], a[180:183], v[192:195], v[132:135]
v_exp_f32 v187, v187
v_mfma_f32_16x16x32_bf16 v[136:139], a[184:187], v[192:195], v[136:139]
v_cvt_pk_bf16_f32 v197, v186, v187
v_add_f32 v15, v15, v187
v_mfma_f32_16x16x32_bf16 v[140:143], a[188:191], v[192:195], v[140:143]
s_waitcnt lgkmcnt(8)
v_exp_f32 v188, v188
v_mfma_f32_16x16x32_bf16 v[176:179], a[192:195], v[16:19], -4.0
ds_read_b64_tr_b16 a[152:153], v2 offset:768
v_add_f32 v15, v15, v188
v_mfma_f32_16x16x32_bf16 v[176:179], a[196:199], v[20:23], v[176:179]
v_exp_f32 v189, v189
v_mfma_f32_16x16x32_bf16 v[176:179], a[200:203], v[24:27], v[176:179]
v_cvt_pk_bf16_f32 v198, v188, v189
v_add_f32 v15, v15, v189
v_mfma_f32_16x16x32_bf16 v[176:179], a[204:207], v[28:31], v[176:179]
v_exp_f32 v190, v190
v_mfma_f32_16x16x32_bf16 v[180:183], a[208:211], v[16:19], -4.0
ds_read_b64_tr_b16 a[154:155], v2 offset:4896
v_add_f32 v15, v15, v190
v_mfma_f32_16x16x32_bf16 v[180:183], a[212:215], v[20:23], v[180:183]
v_exp_f32 v191, v191
v_mfma_f32_16x16x32_bf16 v[180:183], a[216:219], v[24:27], v[180:183]
v_cvt_pk_bf16_f32 v199, v190, v191
v_add_f32 v15, v15, v191
v_mfma_f32_16x16x32_bf16 v[180:183], a[220:223], v[28:31], v[180:183]
v_exp_f32 v176, v176
v_mfma_f32_16x16x32_bf16 v[144:147], a[160:163], v[196:199], v[144:147]
ds_read_b64_tr_b16 a[156:157], v2 offset:776
v_mov_b32 v6, v176
v_mfma_f32_16x16x32_bf16 v[148:151], a[164:167], v[196:199], v[148:151]
v_exp_f32 v177, v177
v_mfma_f32_16x16x32_bf16 v[152:155], a[168:171], v[196:199], v[152:155]
v_cvt_pk_bf16_f32 v192, v176, v177
v_add_f32 v6, v6, v177
v_mfma_f32_16x16x32_bf16 v[156:159], a[172:175], v[196:199], v[156:159]
v_exp_f32 v178, v178
v_mfma_f32_16x16x32_bf16 v[160:163], a[176:179], v[196:199], v[160:163]
ds_read_b64_tr_b16 a[158:159], v2 offset:4904
v_add_f32 v6, v6, v178
v_exp_f32 v180, v180
v_mfma_f32_16x16x32_bf16 v[164:167], a[180:183], v[196:199], v[164:167]
s_add_u32 s28, s28, 1
v_exp_f32 v179, v179
v_mfma_f32_16x16x32_bf16 v[168:171], a[184:187], v[196:199], v[168:171]
s_cmp_lt_u32 s28, s36
v_cvt_pk_bf16_f32 v193, v178, v179
v_add_f32 v6, v6, v179
v_mfma_f32_16x16x32_bf16 v[172:175], a[188:191], v[196:199], v[172:175]
s_cbranch_scc1 L_loop1A
v_and_b32 v233, 0x7ff, v5
v_lshrrev_b32 v234, 11, v5
v_lshl_add_u32 v233, v234, 6, v233
s_mov_b32 vcc_lo, 0xff00ff00
s_mov_b32 vcc_hi, 0xff00ff00
v_add_u32 v8, 65792, v1
v_add_u32 v232, 57600, v2
v_mfma_f32_16x16x32_bf16 v[184:187], a[192:195], v[32:35], -4.0
v_add_f32 v10, v10, v180
v_add_f32 v10, v10, v6
v_mfma_f32_16x16x32_bf16 v[184:187], a[196:199], v[36:39], v[184:187]
v_exp_f32 v181, v181
v_mfma_f32_16x16x32_bf16 v[184:187], a[200:203], v[40:43], v[184:187]
v_cvt_pk_bf16_f32 v194, v180, v181
v_add_f32 v10, v10, v181
v_mfma_f32_16x16x32_bf16 v[184:187], a[204:207], v[44:47], v[184:187]
v_exp_f32 v182, v182
v_mfma_f32_16x16x32_bf16 v[188:191], a[208:211], v[32:35], -4.0
v_add_f32 v10, v10, v182
v_mfma_f32_16x16x32_bf16 v[188:191], a[212:215], v[36:39], v[188:191]
s_waitcnt lgkmcnt(0)
v_exp_f32 v183, v183
v_mfma_f32_16x16x32_bf16 v[188:191], a[216:219], v[40:43], v[188:191]
s_nop 0
v_cvt_pk_bf16_f32 v195, v182, v183
v_add_f32 v10, v10, v183
v_mfma_f32_16x16x32_bf16 v[188:191], a[220:223], v[44:47], v[188:191]
s_barrier
v_exp_f32 v184, v184
v_mfma_f32_16x16x32_bf16 a[0:3], a[128:131], v[192:195], a[0:3]
ds_read_b128 a[224:227], v1 offset:8192
v_add_f32 v11, v11, v184
v_mfma_f32_16x16x32_bf16 a[4:7], a[132:135], v[192:195], a[4:7]
v_exp_f32 v185, v185
v_mfma_f32_16x16x32_bf16 a[8:11], a[136:139], v[192:195], a[8:11]
ds_read_b128 a[228:231], v1 offset:8448
v_cvt_pk_bf16_f32 v196, v184, v185
v_add_f32 v11, v11, v185
v_mfma_f32_16x16x32_bf16 a[12:15], a[140:143], v[192:195], a[12:15]
ds_read_b64_tr_b16 a[160:161], v2 offset:8256
v_exp_f32 v186, v186
v_mfma_f32_16x16x32_bf16 a[16:19], a[144:147], v[192:195], a[16:19]
ds_read_b128 a[232:235], v1 offset:8704
v_add_f32 v11, v11, v186
v_mfma_f32_16x16x32_bf16 a[20:23], a[148:151], v[192:195], a[20:23]
v_exp_f32 v187, v187
v_mfma_f32_16x16x32_bf16 a[24:27], a[152:155], v[192:195], a[24:27]
ds_read_b128 a[236:239], v1 offset:8960
v_cvt_pk_bf16_f32 v197, v186, v187
v_add_f32 v11, v11, v187
v_mfma_f32_16x16x32_bf16 a[28:31], a[156:159], v[192:195], a[28:31]
ds_read_b64_tr_b16 a[162:163], v2 offset:12384
v_exp_f32 v188, v188
v_mfma_f32_16x16x32_bf16 v[176:179], a[192:195], v[48:51], -4.0
ds_read_b128 a[240:243], v1 offset:12288
v_add_f32 v11, v11, v188
v_mfma_f32_16x16x32_bf16 v[176:179], a[196:199], v[52:55], v[176:179]
v_exp_f32 v189, v189
v_mfma_f32_16x16x32_bf16 v[176:179], a[200:203], v[56:59], v[176:179]
ds_read_b128 a[244:247], v1 offset:12544
v_cvt_pk_bf16_f32 v198, v188, v189
v_add_f32 v11, v11, v189
v_mfma_f32_16x16x32_bf16 v[176:179], a[204:207], v[60:63], v[176:179]
v_exp_f32 v190, v190
v_mfma_f32_16x16x32_bf16 v[180:183], a[208:211], v[48:51], -4.0
ds_read_b128 a[248:251], v1 offset:12800
v_add_f32 v11, v11, v190
v_mfma_f32_16x16x32_bf16 v[180:183], a[212:215], v[52:55], v[180:183]
ds_read_b64_tr_b16 a[164:165], v2 offset:8264
v_exp_f32 v191, v191
v_mfma_f32_16x16x32_bf16 v[180:183], a[216:219], v[56:59], v[180:183]
ds_read_b128 a[252:255], v1 offset:13056
v_cvt_pk_bf16_f32 v199, v190, v191
v_add_f32 v11, v11, v191
v_mfma_f32_16x16x32_bf16 v[180:183], a[220:223], v[60:63], v[180:183]
v_exp_f32 v176, v176
v_mfma_f32_16x16x32_bf16 a[32:35], a[128:131], v[196:199], a[32:35]
ds_read_b64_tr_b16 a[166:167], v2 offset:12392
v_add_f32 v12, v12, v176
v_mfma_f32_16x16x32_bf16 a[36:39], a[132:135], v[196:199], a[36:39]
ds_read_b64_tr_b16 a[168:169], v2 offset:8512
v_exp_f32 v177, v177
v_mfma_f32_16x16x32_bf16 a[40:43], a[136:139], v[196:199], a[40:43]
v_cvt_pk_bf16_f32 v192, v176, v177
v_add_f32 v12, v12, v177
v_mfma_f32_16x16x32_bf16 a[44:47], a[140:143], v[196:199], a[44:47]
v_exp_f32 v178, v178
v_mfma_f32_16x16x32_bf16 a[48:51], a[144:147], v[196:199], a[48:51]
ds_read_b64_tr_b16 a[170:171], v2 offset:12640
v_add_f32 v12, v12, v178
v_mfma_f32_16x16x32_bf16 a[52:55], a[148:151], v[196:199], a[52:55]
ds_read_b64_tr_b16 a[172:173], v2 offset:8520
v_exp_f32 v179, v179
v_mfma_f32_16x16x32_bf16 a[56:59], a[152:155], v[196:199], a[56:59]
v_cvt_pk_bf16_f32 v193, v178, v179
v_add_f32 v12, v12, v179
v_mfma_f32_16x16x32_bf16 a[60:63], a[156:159], v[196:199], a[60:63]
s_waitcnt lgkmcnt(4)
v_exp_f32 v180, v180
v_mfma_f32_16x16x32_bf16 v[184:187], a[224:227], v[16:19], -4.0
ds_read_b64_tr_b16 a[174:175], v2 offset:12648
v_add_f32 v12, v12, v180
v_mfma_f32_16x16x32_bf16 v[184:187], a[228:231], v[20:23], v[184:187]
ds_read_b64_tr_b16 a[176:177], v2 offset:8768
v_exp_f32 v181, v181
v_mfma_f32_16x16x32_bf16 v[184:187], a[232:235], v[24:27], v[184:187]
v_cvt_pk_bf16_f32 v194, v180, v181
v_add_f32 v12, v12, v181
v_mfma_f32_16x16x32_bf16 v[184:187], a[236:239], v[28:31], v[184:187]
v_exp_f32 v182, v182
v_mfma_f32_16x16x32_bf16 v[188:191], a[240:243], v[16:19], -4.0
ds_read_b64_tr_b16 a[178:179], v2 offset:12896
v_add_f32 v12, v12, v182
v_mfma_f32_16x16x32_bf16 v[188:191], a[244:247], v[20:23], v[188:191]
ds_read_b64_tr_b16 a[180:181], v2 offset:8776
v_exp_f32 v183, v183
v_mfma_f32_16x16x32_bf16 v[188:191], a[248:251], v[24:27], v[188:191]
v_cvt_pk_bf16_f32 v195, v182, v183
v_add_f32 v12, v12, v183
v_mfma_f32_16x16x32_bf16 v[188:191], a[252:255], v[28:31], v[188:191]
ds_read_b64_tr_b16 a[182:183], v2 offset:12904
v_exp_f32 v184, v184
v_mfma_f32_16x16x32_bf16 a[64:67], a[128:131], v[192:195], a[64:67]
ds_read_b64_tr_b16 a[184:185], v2 offset:9024
v_add_f32 v10, v10, v184
v_mfma_f32_16x16x32_bf16 a[68:71], a[132:135], v[192:195], a[68:71]
v_exp_f32 v185, v185
v_mfma_f32_16x16x32_bf16 a[72:75], a[136:139], v[192:195], a[72:75]
v_cvt_pk_bf16_f32 v196, v184, v185
v_add_f32 v10, v10, v185
v_mfma_f32_16x16x32_bf16 a[76:79], a[140:143], v[192:195], a[76:79]
ds_read_b64_tr_b16 a[186:187], v2 offset:13152
v_exp_f32 v186, v186
v_mfma_f32_16x16x32_bf16 a[80:83], a[144:147], v[192:195], a[80:83]
ds_read_b64_tr_b16 a[188:189], v2 offset:9032
v_add_f32 v10, v10, v186
v_mfma_f32_16x16x32_bf16 a[84:87], a[148:151], v[192:195], a[84:87]
v_exp_f32 v187, v187
v_mfma_f32_16x16x32_bf16 a[88:91], a[152:155], v[192:195], a[88:91]
ds_read_b64_tr_b16 a[190:191], v2 offset:13160
v_cvt_pk_bf16_f32 v197, v186, v187
v_add_f32 v10, v10, v187
v_mfma_f32_16x16x32_bf16 a[92:95], a[156:159], v[192:195], a[92:95]
v_exp_f32 v188, v188
v_mfma_f32_16x16x32_bf16 v[176:179], a[224:227], v[32:35], -4.0
v_add_f32 v10, v10, v188
v_mfma_f32_16x16x32_bf16 v[176:179], a[228:231], v[36:39], v[176:179]
v_exp_f32 v189, v189
v_mfma_f32_16x16x32_bf16 v[176:179], a[232:235], v[40:43], v[176:179]
v_cvt_pk_bf16_f32 v198, v188, v189
v_add_f32 v10, v10, v189
v_mfma_f32_16x16x32_bf16 v[176:179], a[236:239], v[44:47], v[176:179]
v_exp_f32 v190, v190
v_mfma_f32_16x16x32_bf16 v[180:183], a[240:243], v[32:35], -4.0
v_add_f32 v10, v10, v190
v_mfma_f32_16x16x32_bf16 v[180:183], a[244:247], v[36:39], v[180:183]
v_exp_f32 v191, v191
v_mfma_f32_16x16x32_bf16 v[180:183], a[248:251], v[40:43], v[180:183]
v_cvt_pk_bf16_f32 v199, v190, v191
v_add_f32 v10, v10, v191
v_mfma_f32_16x16x32_bf16 v[180:183], a[252:255], v[44:47], v[180:183]
s_waitcnt lgkmcnt(0)
v_exp_f32 v176, v176
v_mfma_f32_16x16x32_bf16 a[0:3], a[160:163], v[196:199], a[0:3]
s_nop 0
v_add_f32 v11, v11, v176
v_mfma_f32_16x16x32_bf16 a[4:7], a[164:167], v[196:199], a[4:7]
s_barrier
v_exp_f32 v177, v177
v_mfma_f32_16x16x32_bf16 a[8:11], a[168:171], v[196:199], a[8:11]
v_cvt_pk_bf16_f32 v192, v176, v177
v_add_f32 v11, v11, v177
v_mfma_f32_16x16x32_bf16 a[12:15], a[172:175], v[196:199], a[12:15]
ds_read_b128 a[192:195], v1 offset:16384
v_exp_f32 v178, v178
v_mfma_f32_16x16x32_bf16 a[16:19], a[176:179], v[196:199], a[16:19]
ds_read_b128 a[196:199], v1 offset:16640
v_add_f32 v11, v11, v178
v_mfma_f32_16x16x32_bf16 a[20:23], a[180:183], v[196:199], a[20:23]
ds_read_b64_tr_b16 a[128:129], v2 offset:16512
v_exp_f32 v179, v179
v_mfma_f32_16x16x32_bf16 a[24:27], a[184:187], v[196:199], a[24:27]
ds_read_b128 a[200:203], v1 offset:16896
v_cvt_pk_bf16_f32 v193, v178, v179
v_add_f32 v11, v11, v179
v_mfma_f32_16x16x32_bf16 a[28:31], a[188:191], v[196:199], a[28:31]
v_exp_f32 v180, v180
v_mfma_f32_16x16x32_bf16 v[184:187], a[224:227], v[48:51], -4.0
ds_read_b128 a[204:207], v1 offset:17152
v_add_f32 v11, v11, v180
v_mfma_f32_16x16x32_bf16 v[184:187], a[228:231], v[52:55], v[184:187]
ds_read_b128 a[208:211], v1 offset:20480
v_exp_f32 v181, v181
v_mfma_f32_16x16x32_bf16 v[184:187], a[232:235], v[56:59], v[184:187]
ds_read_b64_tr_b16 a[130:131], v2 offset:20640
v_cvt_pk_bf16_f32 v194, v180, v181
v_add_f32 v11, v11, v181
v_mfma_f32_16x16x32_bf16 v[184:187], a[236:239], v[60:63], v[184:187]
ds_read_b128 a[212:215], v1 offset:20736
v_exp_f32 v182, v182
v_mfma_f32_16x16x32_bf16 v[188:191], a[240:243], v[48:51], -4.0
ds_read_b128 a[216:219], v1 offset:20992
v_add_f32 v11, v11, v182
v_mfma_f32_16x16x32_bf16 v[188:191], a[244:247], v[52:55], v[188:191]
v_exp_f32 v183, v183
v_mfma_f32_16x16x32_bf16 v[188:191], a[248:251], v[56:59], v[188:191]
ds_read_b128 a[220:223], v1 offset:21248
v_cvt_pk_bf16_f32 v195, v182, v183
v_add_f32 v11, v11, v183
v_mfma_f32_16x16x32_bf16 v[188:191], a[252:255], v[60:63], v[188:191]
ds_read_b64_tr_b16 a[132:133], v2 offset:16520
v_exp_f32 v184, v184
v_mfma_f32_16x16x32_bf16 a[32:35], a[160:163], v[192:195], a[32:35]
ds_read_b64_tr_b16 a[134:135], v2 offset:20648
v_add_f32 v12, v12, v184
v_mfma_f32_16x16x32_bf16 a[36:39], a[164:167], v[192:195], a[36:39]
v_exp_f32 v185, v185
v_mfma_f32_16x16x32_bf16 a[40:43], a[168:171], v[192:195], a[40:43]
ds_read_b64_tr_b16 a[136:137], v2 offset:16768
v_cvt_pk_bf16_f32 v196, v184, v185
v_add_f32 v12, v12, v185
v_mfma_f32_16x16x32_bf16 a[44:47], a[172:175], v[192:195], a[44:47]
v_exp_f32 v186, v186
v_mfma_f32_16x16x32_bf16 a[48:51], a[176:179], v[192:195], a[48:51]
ds_read_b64_tr_b16 a[138:139], v2 offset:20896
v_add_f32 v12, v12, v186
v_mfma_f32_16x16x32_bf16 a[52:55], a[180:183], v[192:195], a[52:55]
ds_read_b64_tr_b16 a[140:141], v2 offset:16776
v_exp_f32 v187, v187
v_mfma_f32_16x16x32_bf16 a[56:59], a[184:187], v[192:195], a[56:59]
v_cvt_pk_bf16_f32 v197, v186, v187
v_add_f32 v12, v12, v187
v_mfma_f32_16x16x32_bf16 a[60:63], a[188:191], v[192:195], a[60:63]
s_waitcnt lgkmcnt(5)
v_exp_f32 v188, v188
v_mfma_f32_16x16x32_bf16 v[176:179], a[192:195], v[16:19], -4.0
ds_read_b64_tr_b16 a[142:143], v2 offset:20904
v_add_f32 v12, v12, v188
v_mfma_f32_16x16x32_bf16 v[176:179], a[196:199], v[20:23], v[176:179]
ds_read_b64_tr_b16 a[144:145], v2 offset:17024
v_exp_f32 v189, v189
v_mfma_f32_16x16x32_bf16 v[176:179], a[200:203], v[24:27], v[176:179]
v_cvt_pk_bf16_f32 v198, v188, v189
v_add_f32 v12, v12, v189
v_mfma_f32_16x16x32_bf16 v[176:179], a[204:207], v[28:31], v[176:179]
ds_read_b64_tr_b16 a[146:147], v2 offset:21152
v_exp_f32 v190, v190
v_mfma_f32_16x16x32_bf16 v[180:183], a[208:211], v[16:19], -4.0
ds_read_b64_tr_b16 a[148:149], v2 offset:17032
v_add_f32 v12, v12, v190
v_mfma_f32_16x16x32_bf16 v[180:183], a[212:215], v[20:23], v[180:183]
v_exp_f32 v191, v191
v_mfma_f32_16x16x32_bf16 v[180:183], a[216:219], v[24:27], v[180:183]
s_nop 0
v_cvt_pk_bf16_f32 v199, v190, v191
v_add_f32 v12, v12, v191
v_mfma_f32_16x16x32_bf16 v[180:183], a[220:223], v[28:31], v[180:183]
s_barrier
v_exp_f32 v176, v176
v_mfma_f32_16x16x32_bf16 a[64:67], a[160:163], v[196:199], a[64:67]
ds_read_b64_tr_b16 a[150:151], v2 offset:21160
v_add_f32 v10, v10, v176
v_mfma_f32_16x16x32_bf16 a[68:71], a[164:167], v[196:199], a[68:71]
ds_read_b64_tr_b16 a[152:153], v2 offset:17280
v_exp_f32 v177, v177
v_mfma_f32_16x16x32_bf16 a[72:75], a[168:171], v[196:199], a[72:75]
ds_read_b128 a[224:227], v8 offset:0
v_cvt_pk_bf16_f32 v192, v176, v177
v_add_f32 v10, v10, v177
v_mfma_f32_16x16x32_bf16 a[76:79], a[172:175], v[196:199], a[76:79]
ds_read_b64_tr_b16 a[154:155], v2 offset:21408
v_exp_f32 v178, v178
v_mfma_f32_16x16x32_bf16 a[80:83], a[176:179], v[196:199], a[80:83]
ds_read_b64_tr_b16 a[156:157], v2 offset:17288
v_add_f32 v10, v10, v178
v_mfma_f32_16x16x32_bf16 a[84:87], a[180:183], v[196:199], a[84:87]
v_exp_f32 v179, v179
v_mfma_f32_16x16x32_bf16 a[88:91], a[184:187], v[196:199], a[88:91]
ds_read_b64_tr_b16 a[158:159], v2 offset:21416
v_cvt_pk_bf16_f32 v193, v178, v179
v_add_f32 v10, v10, v179
v_mfma_f32_16x16x32_bf16 a[92:95], a[188:191], v[196:199], a[92:95]
ds_read_b128 a[228:231], v8 offset:256
v_exp_f32 v180, v180
v_mfma_f32_16x16x32_bf16 v[184:187], a[192:195], v[32:35], -4.0
ds_read_b128 a[232:235], v8 offset:512
v_add_f32 v10, v10, v180
v_mfma_f32_16x16x32_bf16 v[184:187], a[196:199], v[36:39], v[184:187]
ds_read_b128 a[236:239], v8 offset:768
v_exp_f32 v181, v181
v_mfma_f32_16x16x32_bf16 v[184:187], a[200:203], v[40:43], v[184:187]
ds_read_b128 a[240:243], v8 offset:4096
v_cvt_pk_bf16_f32 v194, v180, v181
v_add_f32 v10, v10, v181
v_mfma_f32_16x16x32_bf16 v[184:187], a[204:207], v[44:47], v[184:187]
ds_read_b64_tr_b16 a[160:161], v232 offset:0
v_exp_f32 v182, v182
v_mfma_f32_16x16x32_bf16 v[188:191], a[208:211], v[32:35], -4.0
ds_read_b128 a[244:247], v8 offset:4352
v_add_f32 v10, v10, v182
v_mfma_f32_16x16x32_bf16 v[188:191], a[212:215], v[36:39], v[188:191]
ds_read_b128 a[248:251], v8 offset:4608
v_exp_f32 v183, v183
v_mfma_f32_16x16x32_bf16 v[188:191], a[216:219], v[40:43], v[188:191]
ds_read_b128 a[252:255], v8 offset:4864
v_cvt_pk_bf16_f32 v195, v182, v183
v_add_f32 v10, v10, v183
v_mfma_f32_16x16x32_bf16 v[188:191], a[220:223], v[44:47], v[188:191]
s_waitcnt lgkmcnt(8)
v_exp_f32 v184, v184
v_mfma_f32_16x16x32_bf16 a[0:3], a[128:131], v[192:195], a[0:3]
ds_read_b64_tr_b16 a[162:163], v232 offset:4128
v_add_f32 v11, v11, v184
v_mfma_f32_16x16x32_bf16 a[4:7], a[132:135], v[192:195], a[4:7]
v_exp_f32 v185, v185
v_mfma_f32_16x16x32_bf16 a[8:11], a[136:139], v[192:195], a[8:11]
ds_read_b64_tr_b16 a[164:165], v232 offset:8
v_cvt_pk_bf16_f32 v196, v184, v185
v_add_f32 v11, v11, v185
v_mfma_f32_16x16x32_bf16 a[12:15], a[140:143], v[192:195], a[12:15]
v_exp_f32 v186, v186
v_mfma_f32_16x16x32_bf16 a[16:19], a[144:147], v[192:195], a[16:19]
ds_read_b64_tr_b16 a[166:167], v232 offset:4136
v_add_f32 v11, v11, v186
v_mfma_f32_16x16x32_bf16 a[20:23], a[148:151], v[192:195], a[20:23]
ds_read_b64_tr_b16 a[168:169], v232 offset:256
v_exp_f32 v187, v187
v_mfma_f32_16x16x32_bf16 a[24:27], a[152:155], v[192:195], a[24:27]
v_cvt_pk_bf16_f32 v197, v186, v187
v_add_f32 v11, v11, v187
v_mfma_f32_16x16x32_bf16 a[28:31], a[156:159], v[192:195], a[28:31]
s_waitcnt lgkmcnt(4)
v_exp_f32 v188, v188
v_mfma_f32_16x16x32_bf16 v[176:179], a[224:227], v[16:19], -4.0
ds_read_b64_tr_b16 a[170:171], v232 offset:4384
v_add_f32 v11, v11, v188
v_mfma_f32_16x16x32_bf16 v[176:179], a[228:231], v[20:23], v[176:179]
ds_read_b64_tr_b16 a[172:173], v232 offset:264
v_exp_f32 v189, v189
v_mfma_f32_16x16x32_bf16 v[176:179], a[232:235], v[24:27], v[176:179]
v_cvt_pk_bf16_f32 v198, v188, v189
v_add_f32 v11, v11, v189
v_mfma_f32_16x16x32_bf16 v[176:179], a[236:239], v[28:31], v[176:179]
ds_read_b64_tr_b16 a[174:175], v232 offset:4392
v_exp_f32 v190, v190
v_mfma_f32_16x16x32_bf16 v[180:183], a[240:243], v[16:19], -4.0
ds_read_b64_tr_b16 a[176:177], v232 offset:512
v_add_f32 v11, v11, v190
v_mfma_f32_16x16x32_bf16 v[180:183], a[244:247], v[20:23], v[180:183]
ds_read_b64_tr_b16 a[178:179], v232 offset:4640
v_exp_f32 v191, v191
v_mfma_f32_16x16x32_bf16 v[180:183], a[248:251], v[24:27], v[180:183]
v_cvt_pk_bf16_f32 v199, v190, v191
v_add_f32 v11, v11, v191
v_mfma_f32_16x16x32_bf16 v[180:183], a[252:255], v[28:31], v[180:183]
ds_read_b64_tr_b16 a[180:181], v232 offset:520
v_exp_f32 v176, v176
v_mfma_f32_16x16x32_bf16 a[32:35], a[128:131], v[196:199], a[32:35]
ds_read_b64_tr_b16 a[182:183], v232 offset:4648
v_add_f32 v10, v10, v176
v_mfma_f32_16x16x32_bf16 a[36:39], a[132:135], v[196:199], a[36:39]
v_exp_f32 v177, v177
v_mfma_f32_16x16x32_bf16 a[40:43], a[136:139], v[196:199], a[40:43]
ds_read_b64_tr_b16 a[184:185], v232 offset:768
v_cvt_pk_bf16_f32 v192, v176, v177
v_add_f32 v10, v10, v177
v_mfma_f32_16x16x32_bf16 a[44:47], a[140:143], v[196:199], a[44:47]
v_exp_f32 v178, v178
v_mfma_f32_16x16x32_bf16 a[48:51], a[144:147], v[196:199], a[48:51]
ds_read_b64_tr_b16 a[186:187], v232 offset:4896
v_add_f32 v10, v10, v178
v_mfma_f32_16x16x32_bf16 a[52:55], a[148:151], v[196:199], a[52:55]
ds_read_b64_tr_b16 a[188:189], v232 offset:776
v_exp_f32 v179, v179
v_mfma_f32_16x16x32_bf16 a[56:59], a[152:155], v[196:199], a[56:59]
v_cvt_pk_bf16_f32 v193, v178, v179
v_add_f32 v10, v10, v179
v_mfma_f32_16x16x32_bf16 a[60:63], a[156:159], v[196:199], a[60:63]
ds_read_b64_tr_b16 a[190:191], v232 offset:4904
v_exp_f32 v180, v180
v_mfma_f32_16x16x32_bf16 v[184:187], a[192:195], v[48:51], -4.0
v_add_f32 v10, v10, v180
v_mfma_f32_16x16x32_bf16 v[184:187], a[196:199], v[52:55], v[184:187]
v_exp_f32 v181, v181
v_mfma_f32_16x16x32_bf16 v[184:187], a[200:203], v[56:59], v[184:187]
v_cvt_pk_bf16_f32 v194, v180, v181
v_add_f32 v10, v10, v181
v_mfma_f32_16x16x32_bf16 v[184:187], a[204:207], v[60:63], v[184:187]
v_exp_f32 v182, v182
v_mfma_f32_16x16x32_bf16 v[188:191], a[208:211], v[48:51], -4.0
v_add_f32 v10, v10, v182
v_mfma_f32_16x16x32_bf16 v[188:191], a[212:215], v[52:55], v[188:191]
v_exp_f32 v183, v183
v_mfma_f32_16x16x32_bf16 v[188:191], a[216:219], v[56:59], v[188:191]
v_cvt_pk_bf16_f32 v195, v182, v183
v_add_f32 v10, v10, v183
v_mfma_f32_16x16x32_bf16 v[188:191], a[220:223], v[60:63], v[188:191]
s_waitcnt lgkmcnt(0)
v_exp_f32 v184, v184
v_mfma_f32_16x16x32_bf16 a[0:3], a[160:163], v[192:195], a[0:3]
ds_read_b128 a[192:195], v1 offset:0
v_add_f32 v12, v12, v184
v_mfma_f32_16x16x32_bf16 a[4:7], a[164:167], v[192:195], a[4:7]
v_exp_f32 v185, v185
v_mfma_f32_16x16x32_bf16 a[8:11], a[168:171], v[192:195], a[8:11]
v_cvt_pk_bf16_f32 v196, v184, v185
v_add_f32 v12, v12, v185
v_mfma_f32_16x16x32_bf16 a[12:15], a[172:175], v[192:195], a[12:15]
v_exp_f32 v186, v186
v_mfma_f32_16x16x32_bf16 a[16:19], a[176:179], v[192:195], a[16:19]
ds_read_b128 a[196:199], v1 offset:256
v_add_f32 v12, v12, v186
v_mfma_f32_16x16x32_bf16 a[20:23], a[180:183], v[192:195], a[20:23]
v_exp_f32 v187, v187
v_mfma_f32_16x16x32_bf16 a[24:27], a[184:187], v[192:195], a[24:27]
v_cvt_pk_bf16_f32 v197, v186, v187
v_add_f32 v12, v12, v187
v_mfma_f32_16x16x32_bf16 a[28:31], a[188:191], v[192:195], a[28:31]
v_exp_f32 v188, v188
v_mfma_f32_16x16x4_f32 v[200:203], v7, v10, 0
s_add_u32 s3, s27, 0
v_accvgpr_read_b32 v204, a0
v_accvgpr_read_b32 v205, a1
v_accvgpr_read_b32 v206, a2
v_accvgpr_read_b32 v207, a3
v_accvgpr_read_b32 v208, a4
v_accvgpr_read_b32 v209, a5
v_accvgpr_read_b32 v210, a6
v_accvgpr_read_b32 v211, a7
v_accvgpr_read_b32 v212, a8
v_accvgpr_read_b32 v213, a9
v_accvgpr_read_b32 v214, a10
v_accvgpr_read_b32 v215, a11
v_accvgpr_read_b32 v216, a12
L_pad5:
s_cbranch_execz L_pad9
v_accvgpr_read_b32 v217, a13
v_accvgpr_read_b32 v218, a14
v_accvgpr_read_b32 v219, a15
v_rcp_f32 v200, v200
v_subrev_u32 v202, s47, v201
v_max_u32 v9, v9, v202
v_pk_mul_f32 v[204:205], v[204:205], v[200:201] op_sel_hi:[1,0]
v_pk_mul_f32 v[206:207], v[206:207], v[200:201] op_sel_hi:[1,0]
v_pk_mul_f32 v[208:209], v[208:209], v[200:201] op_sel_hi:[1,0]
v_pk_mul_f32 v[210:211], v[210:211], v[200:201] op_sel_hi:[1,0]
v_cvt_pk_bf16_f32 v220, v204, v205
v_cvt_pk_bf16_f32 v221, v206, v207
v_cvt_pk_bf16_f32 v222, v208, v209
v_cvt_pk_bf16_f32 v223, v210, v211
v_accvgpr_read_b32 v204, a16
v_accvgpr_read_b32 v205, a17
v_accvgpr_read_b32 v206, a18
v_accvgpr_read_b32 v207, a19
v_accvgpr_read_b32 v208, a20
v_accvgpr_read_b32 v209, a21
v_accvgpr_read_b32 v210, a22
v_accvgpr_read_b32 v211, a23
v_pk_mul_f32 v[212:213], v[212:213], v[200:201] op_sel_hi:[1,0]
v_pk_mul_f32 v[214:215], v[214:215], v[200:201] op_sel_hi:[1,0]
v_pk_mul_f32 v[216:217], v[216:217], v[200:201] op_sel_hi:[1,0]
v_pk_mul_f32 v[218:219], v[218:219], v[200:201] op_sel_hi:[1,0]
v_cvt_pk_bf16_f32 v224, v212, v213
v_cvt_pk_bf16_f32 v225, v214, v215
v_cvt_pk_bf16_f32 v226, v216, v217
v_cvt_pk_bf16_f32 v227, v218, v219
v_cndmask_b32_dpp v244, v220, v224, vcc row_ror:8 row_mask:0xf bank_mask:0xf
v_cndmask_b32_dpp v245, v221, v225, vcc row_ror:8 row_mask:0xf bank_mask:0xf
v_cndmask_b32_dpp v246, v222, v226, vcc row_ror:8 row_mask:0xf bank_mask:0xf
v_cndmask_b32_dpp v247, v223, v227, vcc row_ror:8 row_mask:0xf bank_mask:0xf
s_not_b64 vcc, vcc
v_cndmask_b32_dpp v240, v224, v220, vcc row_ror:8 row_mask:0xf bank_mask:0xf
v_cndmask_b32_dpp v241, v225, v221, vcc row_ror:8 row_mask:0xf bank_mask:0xf
v_cndmask_b32_dpp v242, v226, v222, vcc row_ror:8 row_mask:0xf bank_mask:0xf
v_cndmask_b32_dpp v243, v227, v223, vcc row_ror:8 row_mask:0xf bank_mask:0xf
s_not_b64 vcc, vcc
v_accvgpr_read_b32 v212, a24
v_accvgpr_read_b32 v213, a25
buffer_store_dwordx4 v[240:243], v233, s[16:19], s3 offen offset:0 sc1
v_accvgpr_read_b32 v214, a26
v_accvgpr_read_b32 v215, a27
v_accvgpr_read_b32 v216, a28
v_accvgpr_read_b32 v217, a29
v_accvgpr_read_b32 v218, a30
v_accvgpr_read_b32 v219, a31
v_pk_mul_f32 v[204:205], v[204:205], v[200:201] op_sel_hi:[1,0]
v_pk_mul_f32 v[206:207], v[206:207], v[200:201] op_sel_hi:[1,0]
v_pk_mul_f32 v[208:209], v[208:209], v[200:201] op_sel_hi:[1,0]
v_pk_mul_f32 v[210:211], v[210:211], v[200:201] op_sel_hi:[1,0]
v_cvt_pk_bf16_f32 v220, v204, v205
v_cvt_pk_bf16_f32 v221, v206, v207
v_cvt_pk_bf16_f32 v222, v208, v209
v_cvt_pk_bf16_f32 v223, v210, v211
v_pk_mul_f32 v[212:213], v[212:213], v[200:201] op_sel_hi:[1,0]
v_pk_mul_f32 v[214:215], v[214:215], v[200:201] op_sel_hi:[1,0]
v_pk_mul_f32 v[216:217], v[216:217], v[200:201] op_sel_hi:[1,0]
v_pk_mul_f32 v[218:219], v[218:219], v[200:201] op_sel_hi:[1,0]
v_cvt_pk_bf16_f32 v224, v212, v213
v_cvt_pk_bf16_f32 v225, v214, v215
v_cvt_pk_bf16_f32 v226, v216, v217
v_cvt_pk_bf16_f32 v227, v218, v219
v_cndmask_b32_dpp v252, v220, v224, vcc row_ror:8 row_mask:0xf bank_mask:0xf
v_cndmask_b32_dpp v253, v221, v225, vcc row_ror:8 row_mask:0xf bank_mask:0xf
v_cndmask_b32_dpp v254, v222, v226, vcc row_ror:8 row_mask:0xf bank_mask:0xf
v_cndmask_b32_dpp v255, v223, v227, vcc row_ror:8 row_mask:0xf bank_mask:0xf
s_not_b64 vcc, vcc
v_cndmask_b32_dpp v248, v224, v220, vcc row_ror:8 row_mask:0xf bank_mask:0xf
v_cndmask_b32_dpp v249, v225, v221, vcc row_ror:8 row_mask:0xf bank_mask:0xf
v_cndmask_b32_dpp v250, v226, v222, vcc row_ror:8 row_mask:0xf bank_mask:0xf
v_cndmask_b32_dpp v251, v227, v223, vcc row_ror:8 row_mask:0xf bank_mask:0xf
s_not_b64 vcc, vcc
v_mfma_f32_16x16x32_bf16 v[176:179], a[224:227], v[32:35], -4.0
ds_read_b128 a[200:203], v1 offset:512
v_add_f32 v12, v12, v188
v_mfma_f32_16x16x32_bf16 v[176:179], a[228:231], v[36:39], v[176:179]
v_exp_f32 v189, v189
v_mfma_f32_16x16x32_bf16 v[176:179], a[232:235], v[40:43], v[176:179]
v_cvt_pk_bf16_f32 v198, v188, v189
v_add_f32 v12, v12, v189
v_mfma_f32_16x16x32_bf16 v[176:179], a[236:239], v[44:47], v[176:179]
v_exp_f32 v190, v190
v_mfma_f32_16x16x32_bf16 v[180:183], a[240:243], v[32:35], -4.0
ds_read_b128 a[204:207], v1 offset:768
v_add_f32 v12, v12, v190
v_mfma_f32_16x16x32_bf16 v[180:183], a[244:247], v[36:39], v[180:183]
buffer_store_dwordx4 v[244:247], v233, s[16:19], s3 offen offset:2048 sc1
v_exp_f32 v191, v191
v_mfma_f32_16x16x32_bf16 v[180:183], a[248:251], v[40:43], v[180:183]
v_cvt_pk_bf16_f32 v199, v190, v191
v_add_f32 v12, v12, v191
v_mfma_f32_16x16x32_bf16 v[180:183], a[252:255], v[44:47], v[180:183]
v_exp_f32 v176, v176
v_mfma_f32_16x16x32_bf16 a[64:67], a[128:131], v[196:199], a[64:67]
ds_read_b128 a[208:211], v1 offset:4096
v_add_f32 v11, v11, v176
v_mfma_f32_16x16x32_bf16 a[68:71], a[132:135], v[196:199], a[68:71]
v_exp_f32 v177, v177
v_mfma_f32_16x16x32_bf16 a[72:75], a[136:139], v[196:199], a[72:75]
v_cvt_pk_bf16_f32 v192, v176, v177
v_add_f32 v11, v11, v177
v_mfma_f32_16x16x32_bf16 a[76:79], a[140:143], v[196:199], a[76:79]
v_exp_f32 v178, v178
v_mfma_f32_16x16x32_bf16 a[80:83], a[144:147], v[196:199], a[80:83]
ds_read_b128 a[212:215], v1 offset:4352
v_add_f32 v11, v11, v178
v_mfma_f32_16x16x32_bf16 a[84:87], a[148:151], v[196:199], a[84:87]
v_exp_f32 v179, v179
v_mfma_f32_16x16x32_bf16 a[88:91], a[152:155], v[196:199], a[88:91]
v_cvt_pk_bf16_f32 v193, v178, v179
v_add_f32 v11, v11, v179
v_mfma_f32_16x16x32_bf16 a[92:95], a[156:159], v[196:199], a[92:95]
v_exp_f32 v180, v180
v_mfma_f32_16x16x32_bf16 v[184:187], a[224:227], v[48:51], -4.0
ds_read_b128 a[216:219], v1 offset:4608
v_add_f32 v11, v11, v180
v_mfma_f32_16x16x32_bf16 v[184:187], a[228:231], v[52:55], v[184:187]
buffer_store_dwordx4 v[248:251], v233, s[16:19], s3 offen offset:128 sc1
v_exp_f32 v181, v181
v_mfma_f32_16x16x32_bf16 v[184:187], a[232:235], v[56:59], v[184:187]
ds_read_b64_tr_b16 a[128:129], v2 offset:0
v_cvt_pk_bf16_f32 v194, v180, v181
v_add_f32 v11, v11, v181
v_mfma_f32_16x16x32_bf16 v[184:187], a[236:239], v[60:63], v[184:187]
v_exp_f32 v182, v182
v_mfma_f32_16x16x32_bf16 v[188:191], a[240:243], v[48:51], -4.0
ds_read_b128 a[220:223], v1 offset:4864
v_add_f32 v11, v11, v182
v_mfma_f32_16x16x32_bf16 v[188:191], a[244:247], v[52:55], v[188:191]
ds_read_b64_tr_b16 a[130:131], v2 offset:4128
v_exp_f32 v183, v183
v_mfma_f32_16x16x32_bf16 v[188:191], a[248:251], v[56:59], v[188:191]
v_cvt_pk_bf16_f32 v195, v182, v183
v_add_f32 v11, v11, v183
v_mfma_f32_16x16x32_bf16 v[188:191], a[252:255], v[60:63], v[188:191]
ds_read_b64_tr_b16 a[132:133], v2 offset:8
v_exp_f32 v184, v184
v_mfma_f32_16x16x32_bf16 a[32:35], a[160:163], v[192:195], a[32:35]
ds_read_b64_tr_b16 a[134:135], v2 offset:4136
v_add_f32 v12, v12, v184
v_mfma_f32_16x16x32_bf16 a[36:39], a[164:167], v[192:195], a[36:39]
v_exp_f32 v185, v185
v_mfma_f32_16x16x32_bf16 a[40:43], a[168:171], v[192:195], a[40:43]
ds_read_b64_tr_b16 a[136:137], v2 offset:256
v_cvt_pk_bf16_f32 v196, v184, v185
v_add_f32 v12, v12, v185
v_mfma_f32_16x16x32_bf16 a[44:47], a[172:175], v[192:195], a[44:47]
v_exp_f32 v186, v186
v_mfma_f32_16x16x32_bf16 a[48:51], a[176:179], v[192:195], a[48:51]
ds_read_b64_tr_b16 a[138:139], v2 offset:4384
v_add_f32 v12, v12, v186
v_mfma_f32_16x16x32_bf16 a[52:55], a[180:183], v[192:195], a[52:55]
ds_read_b64_tr_b16 a[140:141], v2 offset:264
v_exp_f32 v187, v187
v_mfma_f32_16x16x32_bf16 a[56:59], a[184:187], v[192:195], a[56:59]
v_cvt_pk_bf16_f32 v197, v186, v187
v_add_f32 v12, v12, v187
v_mfma_f32_16x16x32_bf16 a[60:63], a[188:191], v[192:195], a[60:63]
s_waitcnt lgkmcnt(6)
v_exp_f32 v188, v188
v_mfma_f32_16x16x4_f32 v[200:203], v7, v11, 0
buffer_store_dwordx4 v[252:255], v233, s[16:19], s3 offen offset:2176 sc1
s_add_u32 s3, s27, 4096
v_accvgpr_read_b32 v204, a32
v_accvgpr_read_b32 v205, a33
v_accvgpr_read_b32 v206, a34
v_accvgpr_read_b32 v207, a35
v_accvgpr_read_b32 v208, a36
v_accvgpr_read_b32 v209, a37
v_accvgpr_read_b32 v210, a38
v_accvgpr_read_b32 v211, a39
v_accvgpr_read_b32 v212, a40
v_accvgpr_read_b32 v213, a41
v_accvgpr_read_b32 v214, a42
v_accvgpr_read_b32 v215, a43
v_accvgpr_read_b32 v216, a44
v_accvgpr_read_b32 v217, a45
v_accvgpr_read_b32 v218, a46
v_accvgpr_read_b32 v219, a47
v_rcp_f32 v200, v200
v_subrev_u32 v202, s47, v201
v_max_u32 v9, v9, v202
v_pk_mul_f32 v[204:205], v[204:205], v[200:201] op_sel_hi:[1,0]
v_pk_mul_f32 v[206:207], v[206:207], v[200:201] op_sel_hi:[1,0]
v_pk_mul_f32 v[208:209], v[208:209], v[200:201] op_sel_hi:[1,0]
v_pk_mul_f32 v[210:211], v[210:211], v[200:201] op_sel_hi:[1,0]
v_cvt_pk_bf16_f32 v220, v204, v205
v_cvt_pk_bf16_f32 v221, v206, v207
v_cvt_pk_bf16_f32 v222, v208, v209
v_cvt_pk_bf16_f32 v223, v210, v211
v_accvgpr_read_b32 v204, a48
v_accvgpr_read_b32 v205, a49
v_accvgpr_read_b32 v206, a50
v_accvgpr_read_b32 v207, a51
v_accvgpr_read_b32 v208, a52
v_accvgpr_read_b32 v209, a53
v_accvgpr_read_b32 v210, a54
v_accvgpr_read_b32 v211, a55
v_pk_mul_f32 v[212:213], v[212:213], v[200:201] op_sel_hi:[1,0]
v_pk_mul_f32 v[214:215], v[214:215], v[200:201] op_sel_hi:[1,0]
v_pk_mul_f32 v[216:217], v[216:217], v[200:201] op_sel_hi:[1,0]
v_pk_mul_f32 v[218:219], v[218:219], v[200:201] op_sel_hi:[1,0]
v_cvt_pk_bf16_f32 v224, v212, v213
v_cvt_pk_bf16_f32 v225, v214, v215
v_cvt_pk_bf16_f32 v226, v216, v217
v_cvt_pk_bf16_f32 v227, v218, v219
v_cndmask_b32_dpp v244, v220, v224, vcc row_ror:8 row_mask:0xf bank_mask:0xf
v_cndmask_b32_dpp v245, v221, v225, vcc row_ror:8 row_mask:0xf bank_mask:0xf
v_cndmask_b32_dpp v246, v222, v226, vcc row_ror:8 row_mask:0xf bank_mask:0xf
v_cndmask_b32_dpp v247, v223, v227, vcc row_ror:8 row_mask:0xf bank_mask:0xf
s_not_b64 vcc, vcc
v_cndmask_b32_dpp v240, v224, v220, vcc row_ror:8 row_mask:0xf bank_mask:0xf
v_cndmask_b32_dpp v241, v225, v221, vcc row_ror:8 row_mask:0xf bank_mask:0xf
v_cndmask_b32_dpp v242, v226, v222, vcc row_ror:8 row_mask:0xf bank_mask:0xf
v_cndmask_b32_dpp v243, v227, v223, vcc row_ror:8 row_mask:0xf bank_mask:0xf
s_not_b64 vcc, vcc
v_accvgpr_read_b32 v212, a56
v_accvgpr_read_b32 v213, a57
buffer_store_dwordx4 v[240:243], v233, s[16:19], s3 offen offset:0 sc1
v_accvgpr_read_b32 v214, a58
v_accvgpr_read_b32 v215, a59
v_accvgpr_read_b32 v216, a60
v_accvgpr_read_b32 v217, a61
v_accvgpr_read_b32 v218, a62
v_accvgpr_read_b32 v219, a63
v_pk_mul_f32 v[204:205], v[204:205], v[200:201] op_sel_hi:[1,0]
v_pk_mul_f32 v[206:207], v[206:207], v[200:201] op_sel_hi:[1,0]
v_pk_mul_f32 v[208:209], v[208:209], v[200:201] op_sel_hi:[1,0]
v_pk_mul_f32 v[210:211], v[210:211], v[200:201] op_sel_hi:[1,0]
v_cvt_pk_bf16_f32 v220, v204, v205
v_cvt_pk_bf16_f32 v221, v206, v207
v_cvt_pk_bf16_f32 v222, v208, v209
v_cvt_pk_bf16_f32 v223, v210, v211
v_pk_mul_f32 v[212:213], v[212:213], v[200:201] op_sel_hi:[1,0]
v_pk_mul_f32 v[214:215], v[214:215], v[200:201] op_sel_hi:[1,0]
v_pk_mul_f32 v[216:217], v[216:217], v[200:201] op_sel_hi:[1,0]
v_pk_mul_f32 v[218:219], v[218:219], v[200:201] op_sel_hi:[1,0]
v_cvt_pk_bf16_f32 v224, v212, v213
v_cvt_pk_bf16_f32 v225, v214, v215
v_cvt_pk_bf16_f32 v226, v216, v217
v_cvt_pk_bf16_f32 v227, v218, v219
v_cndmask_b32_dpp v252, v220, v224, vcc row_ror:8 row_mask:0xf bank_mask:0xf
v_cndmask_b32_dpp v253, v221, v225, vcc row_ror:8 row_mask:0xf bank_mask:0xf
v_cndmask_b32_dpp v254, v222, v226, vcc row_ror:8 row_mask:0xf bank_mask:0xf
v_cndmask_b32_dpp v255, v223, v227, vcc row_ror:8 row_mask:0xf bank_mask:0xf
s_not_b64 vcc, vcc
v_cndmask_b32_dpp v248, v224, v220, vcc row_ror:8 row_mask:0xf bank_mask:0xf
v_cndmask_b32_dpp v249, v225, v221, vcc row_ror:8 row_mask:0xf bank_mask:0xf
v_cndmask_b32_dpp v250, v226, v222, vcc row_ror:8 row_mask:0xf bank_mask:0xf
v_cndmask_b32_dpp v251, v227, v223, vcc row_ror:8 row_mask:0xf bank_mask:0xf
s_not_b64 vcc, vcc
v_mfma_f32_16x16x32_bf16 v[176:179], a[192:195], v[64:67], -4.0
ds_read_b64_tr_b16 a[142:143], v2 offset:4392
v_add_f32 v12, v12, v188
v_mfma_f32_16x16x32_bf16 v[176:179], a[196:199], v[68:71], v[176:179]
buffer_store_dwordx4 v[244:247], v233, s[16:19], s3 offen offset:2048 sc1
v_exp_f32 v189, v189
v_mfma_f32_16x16x32_bf16 v[176:179], a[200:203], v[72:75], v[176:179]
ds_read_b64_tr_b16 a[144:145], v2 offset:512
v_cvt_pk_bf16_f32 v198, v188, v189
v_add_f32 v12, v12, v189
v_mfma_f32_16x16x32_bf16 v[176:179], a[204:207], v[76:79], v[176:179]
v_exp_f32 v190, v190
v_mfma_f32_16x16x32_bf16 v[180:183], a[208:211], v[64:67], -4.0
ds_read_b64_tr_b16 a[146:147], v2 offset:4640
v_add_f32 v12, v12, v190
v_mfma_f32_16x16x32_bf16 v[180:183], a[212:215], v[68:71], v[180:183]
ds_read_b64_tr_b16 a[148:149], v2 offset:520
v_exp_f32 v191, v191
v_mfma_f32_16x16x32_bf16 v[180:183], a[216:219], v[72:75], v[180:183]
v_cvt_pk_bf16_f32 v199, v190, v191
v_add_f32 v12, v12, v191
v_mfma_f32_16x16x32_bf16 v[180:183], a[220:223], v[76:79], v[180:183]
ds_read_b64_tr_b16 a[150:151], v2 offset:4648
v_exp_f32 v176, v176
v_mfma_f32_16x16x32_bf16 a[64:67], a[160:163], v[196:199], a[64:67]
ds_read_b64_tr_b16 a[152:153], v2 offset:768
v_add_f32 v13, v13, v176
v_mfma_f32_16x16x32_bf16 a[68:71], a[164:167], v[196:199], a[68:71]
buffer_store_dwordx4 v[248:251], v233, s[16:19], s3 offen offset:128 sc1
v_exp_f32 v177, v177
v_mfma_f32_16x16x32_bf16 a[72:75], a[168:171], v[196:199], a[72:75]
ds_read_b128 a[224:227], v1 offset:8192
v_cvt_pk_bf16_f32 v192, v176, v177
v_add_f32 v13, v13, v177
v_mfma_f32_16x16x32_bf16 a[76:79], a[172:175], v[196:199], a[76:79]
ds_read_b64_tr_b16 a[154:155], v2 offset:4896
v_exp_f32 v178, v178
v_mfma_f32_16x16x32_bf16 a[80:83], a[176:179], v[196:199], a[80:83]
ds_read_b64_tr_b16 a[156:157], v2 offset:776
v_add_f32 v13, v13, v178
v_mfma_f32_16x16x32_bf16 a[84:87], a[180:183], v[196:199], a[84:87]
v_exp_f32 v179, v179
v_mfma_f32_16x16x32_bf16 a[88:91], a[184:187], v[196:199], a[88:91]
ds_read_b64_tr_b16 a[158:159], v2 offset:4904
v_cvt_pk_bf16_f32 v193, v178, v179
v_add_f32 v13, v13, v179
v_mfma_f32_16x16x32_bf16 a[92:95], a[188:191], v[196:199], a[92:95]
v_exp_f32 v180, v180
v_mfma_f32_16x16x4_f32 v[200:203], v7, v12, 0
buffer_store_dwordx4 v[252:255], v233, s[16:19], s3 offen offset:2176 sc1
s_add_u32 s3, s27, 8192
v_accvgpr_read_b32 v204, a64
v_accvgpr_read_b32 v205, a65
v_accvgpr_read_b32 v206, a66
v_accvgpr_read_b32 v207, a67
v_accvgpr_read_b32 v208, a68
v_accvgpr_read_b32 v209, a69
v_accvgpr_read_b32 v210, a70
v_accvgpr_read_b32 v211, a71
v_accvgpr_read_b32 v212, a72
v_accvgpr_read_b32 v213, a73
v_accvgpr_read_b32 v214, a74
v_accvgpr_read_b32 v215, a75
v_accvgpr_read_b32 v216, a76
v_accvgpr_read_b32 v217, a77
v_accvgpr_read_b32 v218, a78
v_accvgpr_read_b32 v219, a79
v_rcp_f32 v200, v200
v_subrev_u32 v202, s47, v201
v_max_u32 v9, v9, v202
v_pk_mul_f32 v[204:205], v[204:205], v[200:201] op_sel_hi:[1,0]
v_pk_mul_f32 v[206:207], v[206:207], v[200:201] op_sel_hi:[1,0]
v_pk_mul_f32 v[208:209], v[208:209], v[200:201] op_sel_hi:[1,0]
v_pk_mul_f32 v[210:211], v[210:211], v[200:201] op_sel_hi:[1,0]
v_cvt_pk_bf16_f32 v220, v204, v205
v_cvt_pk_bf16_f32 v221, v206, v207
v_cvt_pk_bf16_f32 v222, v208, v209
v_cvt_pk_bf16_f32 v223, v210, v211
v_accvgpr_read_b32 v204, a80
v_accvgpr_read_b32 v205, a81
v_accvgpr_read_b32 v206, a82
v_accvgpr_read_b32 v207, a83
v_accvgpr_read_b32 v208, a84
v_accvgpr_read_b32 v209, a85
v_accvgpr_read_b32 v210, a86
v_accvgpr_read_b32 v211, a87
v_pk_mul_f32 v[212:213], v[212:213], v[200:201] op_sel_hi:[1,0]
v_pk_mul_f32 v[214:215], v[214:215], v[200:201] op_sel_hi:[1,0]
v_pk_mul_f32 v[216:217], v[216:217], v[200:201] op_sel_hi:[1,0]
v_pk_mul_f32 v[218:219], v[218:219], v[200:201] op_sel_hi:[1,0]
v_cvt_pk_bf16_f32 v224, v212, v213
v_cvt_pk_bf16_f32 v225, v214, v215
v_cvt_pk_bf16_f32 v226, v216, v217
v_cvt_pk_bf16_f32 v227, v218, v219
v_cndmask_b32_dpp v244, v220, v224, vcc row_ror:8 row_mask:0xf bank_mask:0xf
v_cndmask_b32_dpp v245, v221, v225, vcc row_ror:8 row_mask:0xf bank_mask:0xf
v_cndmask_b32_dpp v246, v222, v226, vcc row_ror:8 row_mask:0xf bank_mask:0xf
v_cndmask_b32_dpp v247, v223, v227, vcc row_ror:8 row_mask:0xf bank_mask:0xf
s_not_b64 vcc, vcc
v_cndmask_b32_dpp v240, v224, v220, vcc row_ror:8 row_mask:0xf bank_mask:0xf
v_cndmask_b32_dpp v241, v225, v221, vcc row_ror:8 row_mask:0xf bank_mask:0xf
v_cndmask_b32_dpp v242, v226, v222, vcc row_ror:8 row_mask:0xf bank_mask:0xf
v_cndmask_b32_dpp v243, v227, v223, vcc row_ror:8 row_mask:0xf bank_mask:0xf
s_not_b64 vcc, vcc
v_accvgpr_read_b32 v212, a88
v_accvgpr_read_b32 v213, a89
buffer_store_dwordx4 v[240:243], v233, s[16:19], s3 offen offset:0 sc1
v_accvgpr_read_b32 v214, a90
v_accvgpr_read_b32 v215, a91
v_accvgpr_read_b32 v216, a92
v_accvgpr_read_b32 v217, a93
v_accvgpr_read_b32 v218, a94
v_accvgpr_read_b32 v219, a95
v_pk_mul_f32 v[204:205], v[204:205], v[200:201] op_sel_hi:[1,0]
v_pk_mul_f32 v[206:207], v[206:207], v[200:201] op_sel_hi:[1,0]
v_pk_mul_f32 v[208:209], v[208:209], v[200:201] op_sel_hi:[1,0]
v_pk_mul_f32 v[210:211], v[210:211], v[200:201] op_sel_hi:[1,0]
v_cvt_pk_bf16_f32 v220, v204, v205
v_cvt_pk_bf16_f32 v221, v206, v207
v_cvt_pk_bf16_f32 v222, v208, v209
v_cvt_pk_bf16_f32 v223, v210, v211
v_pk_mul_f32 v[212:213], v[212:213], v[200:201] op_sel_hi:[1,0]
v_pk_mul_f32 v[214:215], v[214:215], v[200:201] op_sel_hi:[1,0]
v_pk_mul_f32 v[216:217], v[216:217], v[200:201] op_sel_hi:[1,0]
v_pk_mul_f32 v[218:219], v[218:219], v[200:201] op_sel_hi:[1,0]
v_cvt_pk_bf16_f32 v224, v212, v213
v_cvt_pk_bf16_f32 v225, v214, v215
v_cvt_pk_bf16_f32 v226, v216, v217
v_cvt_pk_bf16_f32 v227, v218, v219
v_cndmask_b32_dpp v252, v220, v224, vcc row_ror:8 row_mask:0xf bank_mask:0xf
v_cndmask_b32_dpp v253, v221, v225, vcc row_ror:8 row_mask:0xf bank_mask:0xf
v_cndmask_b32_dpp v254, v222, v226, vcc row_ror:8 row_mask:0xf bank_mask:0xf
v_cndmask_b32_dpp v255, v223, v227, vcc row_ror:8 row_mask:0xf bank_mask:0xf
s_not_b64 vcc, vcc
v_cndmask_b32_dpp v248, v224, v220, vcc row_ror:8 row_mask:0xf bank_mask:0xf
v_cndmask_b32_dpp v249, v225, v221, vcc row_ror:8 row_mask:0xf bank_mask:0xf
v_cndmask_b32_dpp v250, v226, v222, vcc row_ror:8 row_mask:0xf bank_mask:0xf
v_cndmask_b32_dpp v251, v227, v223, vcc row_ror:8 row_mask:0xf bank_mask:0xf
s_not_b64 vcc, vcc
v_mfma_f32_16x16x32_bf16 v[184:187], a[192:195], v[80:83], -4.0
ds_read_b128 a[228:231], v1 offset:8448
v_add_f32 v13, v13, v180
v_mfma_f32_16x16x32_bf16 v[184:187], a[196:199], v[84:87], v[184:187]
v_exp_f32 v181, v181
v_mfma_f32_16x16x32_bf16 v[184:187], a[200:203], v[88:91], v[184:187]
ds_read_b64_tr_b16 a[160:161], v2 offset:8256
v_cvt_pk_bf16_f32 v194, v180, v181
v_add_f32 v13, v13, v181
v_mfma_f32_16x16x32_bf16 v[184:187], a[204:207], v[92:95], v[184:187]
v_exp_f32 v182, v182
v_mfma_f32_16x16x32_bf16 v[188:191], a[208:211], v[80:83], -4.0
ds_read_b128 a[232:235], v1 offset:8704
v_add_f32 v13, v13, v182
v_mfma_f32_16x16x32_bf16 v[188:191], a[212:215], v[84:87], v[188:191]
v_exp_f32 v183, v183
v_mfma_f32_16x16x32_bf16 v[188:191], a[216:219], v[88:91], v[188:191]
s_waitcnt lgkmcnt(3)
v_cvt_pk_bf16_f32 v195, v182, v183
v_add_f32 v13, v13, v183
v_mfma_f32_16x16x32_bf16 v[188:191], a[220:223], v[92:95], v[188:191]
buffer_store_dwordx4 v[244:247], v233, s[16:19], s3 offen offset:2048 sc1
v_exp_f32 v184, v184
v_mfma_f32_16x16x32_bf16 a[96:99], a[128:131], v[192:195], a[96:99]
ds_read_b128 a[236:239], v1 offset:8960
v_add_f32 v14, v14, v184
v_mfma_f32_16x16x32_bf16 a[100:103], a[132:135], v[192:195], a[100:103]
ds_read_b64_tr_b16 a[162:163], v2 offset:12384
v_exp_f32 v185, v185
v_mfma_f32_16x16x32_bf16 a[104:107], a[136:139], v[192:195], a[104:107]
v_cvt_pk_bf16_f32 v196, v184, v185
v_add_f32 v14, v14, v185
v_mfma_f32_16x16x32_bf16 a[108:111], a[140:143], v[192:195], a[108:111]
v_exp_f32 v186, v186
v_mfma_f32_16x16x32_bf16 a[112:115], a[144:147], v[192:195], a[112:115]
ds_read_b128 a[240:243], v1 offset:12288
v_add_f32 v14, v14, v186
v_mfma_f32_16x16x32_bf16 a[116:119], a[148:151], v[192:195], a[116:119]
ds_read_b64_tr_b16 a[164:165], v2 offset:8264
v_exp_f32 v187, v187
v_mfma_f32_16x16x32_bf16 a[120:123], a[152:155], v[192:195], a[120:123]
v_cvt_pk_bf16_f32 v197, v186, v187
v_add_f32 v14, v14, v187
v_mfma_f32_16x16x32_bf16 a[124:127], a[156:159], v[192:195], a[124:127]
ds_read_b128 a[244:247], v1 offset:12544
v_exp_f32 v188, v188
v_mfma_f32_16x16x32_bf16 v[176:179], a[192:195], v[96:99], -4.0
ds_read_b128 a[248:251], v1 offset:12800
v_add_f32 v14, v14, v188
v_mfma_f32_16x16x32_bf16 v[176:179], a[196:199], v[100:103], v[176:179]
v_exp_f32 v189, v189
v_mfma_f32_16x16x32_bf16 v[176:179], a[200:203], v[104:107], v[176:179]
ds_read_b64_tr_b16 a[166:167], v2 offset:12392
v_cvt_pk_bf16_f32 v198, v188, v189
v_add_f32 v14, v14, v189
v_mfma_f32_16x16x32_bf16 v[176:179], a[204:207], v[108:111], v[176:179]
v_exp_f32 v190, v190
v_mfma_f32_16x16x32_bf16 v[180:183], a[208:211], v[96:99], -4.0
ds_read_b128 a[252:255], v1 offset:13056
v_add_f32 v14, v14, v190
v_mfma_f32_16x16x32_bf16 v[180:183], a[212:215], v[100:103], v[180:183]
v_exp_f32 v191, v191
v_mfma_f32_16x16x32_bf16 v[180:183], a[216:219], v[104:107], v[180:183]
ds_read_b64_tr_b16 a[168:169], v2 offset:8512
v_cvt_pk_bf16_f32 v199, v190, v191
v_add_f32 v14, v14, v191
v_mfma_f32_16x16x32_bf16 v[180:183], a[220:223], v[108:111], v[180:183]
buffer_store_dwordx4 v[248:251], v233, s[16:19], s3 offen offset:128 sc1
v_exp_f32 v176, v176
v_mfma_f32_16x16x32_bf16 v[112:115], a[128:131], v[196:199], v[112:115]
ds_read_b64_tr_b16 a[170:171], v2 offset:12640
v_add_f32 v15, v15, v176
v_mfma_f32_16x16x32_bf16 v[116:119], a[132:135], v[196:199], v[116:119]
v_exp_f32 v177, v177
v_mfma_f32_16x16x32_bf16 v[120:123], a[136:139], v[196:199], v[120:123]
v_cvt_pk_bf16_f32 v192, v176, v177
v_add_f32 v15, v15, v177
v_mfma_f32_16x16x32_bf16 v[124:127], a[140:143], v[196:199], v[124:127]
ds_read_b64_tr_b16 a[172:173], v2 offset:8520
v_exp_f32 v178, v178
v_mfma_f32_16x16x32_bf16 v[128:131], a[144:147], v[196:199], v[128:131]
ds_read_b64_tr_b16 a[174:175], v2 offset:12648
v_add_f32 v15, v15, v178
v_mfma_f32_16x16x32_bf16 v[132:135], a[148:151], v[196:199], v[132:135]
v_exp_f32 v179, v179
v_mfma_f32_16x16x32_bf16 v[136:139], a[152:155], v[196:199], v[136:139]
v_cvt_pk_bf16_f32 v193, v178, v179
v_add_f32 v15, v15, v179
v_mfma_f32_16x16x32_bf16 v[140:143], a[156:159], v[196:199], v[140:143]
s_waitcnt lgkmcnt(4)
v_exp_f32 v180, v180
v_mfma_f32_16x16x32_bf16 v[184:187], a[224:227], v[64:67], -4.0
ds_read_b64_tr_b16 a[176:177], v2 offset:8768
v_add_f32 v15, v15, v180
v_mfma_f32_16x16x32_bf16 v[184:187], a[228:231], v[68:71], v[184:187]
ds_read_b64_tr_b16 a[178:179], v2 offset:12896
v_exp_f32 v181, v181
v_mfma_f32_16x16x32_bf16 v[184:187], a[232:235], v[72:75], v[184:187]
v_cvt_pk_bf16_f32 v194, v180, v181
v_add_f32 v15, v15, v181
v_mfma_f32_16x16x32_bf16 v[184:187], a[236:239], v[76:79], v[184:187]
v_exp_f32 v182, v182
v_mfma_f32_16x16x32_bf16 v[188:191], a[240:243], v[64:67], -4.0
ds_read_b64_tr_b16 a[180:181], v2 offset:8776
v_add_f32 v15, v15, v182
v_mfma_f32_16x16x32_bf16 v[188:191], a[244:247], v[68:71], v[188:191]
ds_read_b64_tr_b16 a[182:183], v2 offset:12904
v_exp_f32 v183, v183
v_mfma_f32_16x16x32_bf16 v[188:191], a[248:251], v[72:75], v[188:191]
v_cvt_pk_bf16_f32 v195, v182, v183
v_add_f32 v15, v15, v183
v_mfma_f32_16x16x32_bf16 v[188:191], a[252:255], v[76:79], v[188:191]
buffer_store_dwordx4 v[252:255], v233, s[16:19], s3 offen offset:2176 sc1
v_exp_f32 v184, v184
v_mfma_f32_16x16x32_bf16 v[144:147], a[128:131], v[192:195], v[144:147]
ds_read_b64_tr_b16 a[184:185], v2 offset:9024
v_add_f32 v13, v13, v184
v_mfma_f32_16x16x32_bf16 v[148:151], a[132:135], v[192:195], v[148:151]
ds_read_b128 a[192:195], v1 offset:16384
v_exp_f32 v185, v185
v_mfma_f32_16x16x32_bf16 v[152:155], a[136:139], v[192:195], v[152:155]
ds_read_b64_tr_b16 a[186:187], v2 offset:13152
v_cvt_pk_bf16_f32 v196, v184, v185
v_add_f32 v13, v13, v185
v_mfma_f32_16x16x32_bf16 v[156:159], a[140:143], v[192:195], v[156:159]
v_exp_f32 v186, v186
v_mfma_f32_16x16x32_bf16 v[160:163], a[144:147], v[192:195], v[160:163]
ds_read_b64_tr_b16 a[188:189], v2 offset:9032
v_add_f32 v13, v13, v186
v_mfma_f32_16x16x32_bf16 v[164:167], a[148:151], v[192:195], v[164:167]
v_exp_f32 v187, v187
v_mfma_f32_16x16x32_bf16 v[168:171], a[152:155], v[192:195], v[168:171]
ds_read_b64_tr_b16 a[190:191], v2 offset:13160
v_cvt_pk_bf16_f32 v197, v186, v187
v_add_f32 v13, v13, v187
v_mfma_f32_16x16x32_bf16 v[172:175], a[156:159], v[192:195], v[172:175]
v_exp_f32 v188, v188
v_mfma_f32_16x16x32_bf16 v[176:179], a[224:227], v[80:83], -4.0
ds_read_b128 a[196:199], v1 offset:16640
v_add_f32 v13, v13, v188
v_mfma_f32_16x16x32_bf16 v[176:179], a[228:231], v[84:87], v[176:179]
v_exp_f32 v189, v189
v_mfma_f32_16x16x32_bf16 v[176:179], a[232:235], v[88:91], v[176:179]
ds_read_b64_tr_b16 a[128:129], v2 offset:16512
v_cvt_pk_bf16_f32 v198, v188, v189
v_add_f32 v13, v13, v189
v_mfma_f32_16x16x32_bf16 v[176:179], a[236:239], v[92:95], v[176:179]
v_exp_f32 v190, v190
v_mfma_f32_16x16x32_bf16 v[180:183], a[240:243], v[80:83], -4.0
ds_read_b128 a[200:203], v1 offset:16896
v_add_f32 v13, v13, v190
v_mfma_f32_16x16x32_bf16 v[180:183], a[244:247], v[84:87], v[180:183]
v_exp_f32 v191, v191
v_mfma_f32_16x16x32_bf16 v[180:183], a[248:251], v[88:91], v[180:183]
ds_read_b64_tr_b16 a[130:131], v2 offset:20640
v_cvt_pk_bf16_f32 v199, v190, v191
v_add_f32 v13, v13, v191
v_mfma_f32_16x16x32_bf16 v[180:183], a[252:255], v[92:95], v[180:183]
s_waitcnt lgkmcnt(4)
v_exp_f32 v176, v176
v_mfma_f32_16x16x32_bf16 a[96:99], a[160:163], v[196:199], a[96:99]
ds_read_b128 a[204:207], v1 offset:17152
v_add_f32 v14, v14, v176
v_mfma_f32_16x16x32_bf16 a[100:103], a[164:167], v[196:199], a[100:103]
v_exp_f32 v177, v177
v_mfma_f32_16x16x32_bf16 a[104:107], a[168:171], v[196:199], a[104:107]
v_cvt_pk_bf16_f32 v192, v176, v177
v_add_f32 v14, v14, v177
v_mfma_f32_16x16x32_bf16 a[108:111], a[172:175], v[196:199], a[108:111]
v_exp_f32 v178, v178
v_mfma_f32_16x16x32_bf16 a[112:115], a[176:179], v[196:199], a[112:115]
ds_read_b128 a[208:211], v1 offset:20480
v_add_f32 v14, v14, v178
v_mfma_f32_16x16x32_bf16 a[116:119], a[180:183], v[196:199], a[116:119]
ds_read_b64_tr_b16 a[132:133], v2 offset:16520
v_exp_f32 v179, v179
v_mfma_f32_16x16x32_bf16 a[120:123], a[184:187], v[196:199], a[120:123]
v_cvt_pk_bf16_f32 v193, v178, v179
v_add_f32 v14, v14, v179
v_mfma_f32_16x16x32_bf16 a[124:127], a[188:191], v[196:199], a[124:127]
ds_read_b128 a[212:215], v1 offset:20736
v_exp_f32 v180, v180
v_mfma_f32_16x16x32_bf16 v[184:187], a[224:227], v[96:99], -4.0
ds_read_b128 a[216:219], v1 offset:20992
v_add_f32 v14, v14, v180
v_mfma_f32_16x16x32_bf16 v[184:187], a[228:231], v[100:103], v[184:187]
v_exp_f32 v181, v181
v_mfma_f32_16x16x32_bf16 v[184:187], a[232:235], v[104:107], v[184:187]
ds_read_b64_tr_b16 a[134:135], v2 offset:20648
v_cvt_pk_bf16_f32 v194, v180, v181
v_add_f32 v14, v14, v181
v_mfma_f32_16x16x32_bf16 v[184:187], a[236:239], v[108:111], v[184:187]
L_pad6:
s_cbranch_execz L_pad10
v_exp_f32 v182, v182
v_mfma_f32_16x16x32_bf16 v[188:191], a[240:243], v[96:99], -4.0
ds_read_b128 a[220:223], v1 offset:21248
v_add_f32 v14, v14, v182
v_mfma_f32_16x16x32_bf16 v[188:191], a[244:247], v[100:103], v[188:191]
v_exp_f32 v183, v183
v_mfma_f32_16x16x32_bf16 v[188:191], a[248:251], v[104:107], v[188:191]
ds_read_b64_tr_b16 a[136:137], v2 offset:16768
v_cvt_pk_bf16_f32 v195, v182, v183
v_add_f32 v14, v14, v183
v_mfma_f32_16x16x32_bf16 v[188:191], a[252:255], v[108:111], v[188:191]
v_exp_f32 v184, v184
v_mfma_f32_16x16x32_bf16 v[112:115], a[160:163], v[192:195], v[112:115]
ds_read_b64_tr_b16 a[138:139], v2 offset:20896
v_add_f32 v15, v15, v184
v_mfma_f32_16x16x32_bf16 v[116:119], a[164:167], v[192:195], v[116:119]
v_exp_f32 v185, v185
v_mfma_f32_16x16x32_bf16 v[120:123], a[168:171], v[192:195], v[120:123]
ds_read_b128 a[224:227], v8 offset:0
v_cvt_pk_bf16_f32 v196, v184, v185
v_add_f32 v15, v15, v185
v_mfma_f32_16x16x32_bf16 v[124:127], a[172:175], v[192:195], v[124:127]
ds_read_b64_tr_b16 a[140:141], v2 offset:16776
v_exp_f32 v186, v186
v_mfma_f32_16x16x32_bf16 v[128:131], a[176:179], v[192:195], v[128:131]
ds_read_b64_tr_b16 a[142:143], v2 offset:20904
v_add_f32 v15, v15, v186
v_mfma_f32_16x16x32_bf16 v[132:135], a[180:183], v[192:195], v[132:135]
v_exp_f32 v187, v187
v_mfma_f32_16x16x32_bf16 v[136:139], a[184:187], v[192:195], v[136:139]
v_cvt_pk_bf16_f32 v197, v186, v187
v_add_f32 v15, v15, v187
v_mfma_f32_16x16x32_bf16 v[140:143], a[188:191], v[192:195], v[140:143]
s_waitcnt lgkmcnt(5)
v_exp_f32 v188, v188
v_mfma_f32_16x16x32_bf16 v[176:179], a[192:195], v[64:67], -4.0
ds_read_b64_tr_b16 a[144:145], v2 offset:17024
v_add_f32 v15, v15, v188
v_mfma_f32_16x16x32_bf16 v[176:179], a[196:199], v[68:71], v[176:179]
ds_read_b64_tr_b16 a[146:147], v2 offset:21152
v_exp_f32 v189, v189
v_mfma_f32_16x16x32_bf16 v[176:179], a[200:203], v[72:75], v[176:179]
ds_read_b128 a[228:231], v8 offset:256
v_cvt_pk_bf16_f32 v198, v188, v189
v_add_f32 v15, v15, v189
v_mfma_f32_16x16x32_bf16 v[176:179], a[204:207], v[76:79], v[176:179]
v_exp_f32 v190, v190
v_mfma_f32_16x16x32_bf16 v[180:183], a[208:211], v[64:67], -4.0
ds_read_b64_tr_b16 a[148:149], v2 offset:17032
v_add_f32 v15, v15, v190
v_mfma_f32_16x16x32_bf16 v[180:183], a[212:215], v[68:71], v[180:183]
ds_read_b64_tr_b16 a[150:151], v2 offset:21160
v_exp_f32 v191, v191
v_mfma_f32_16x16x32_bf16 v[180:183], a[216:219], v[72:75], v[180:183]
v_cvt_pk_bf16_f32 v199, v190, v191
v_add_f32 v15, v15, v191
v_mfma_f32_16x16x32_bf16 v[180:183], a[220:223], v[76:79], v[180:183]
ds_read_b128 a[232:235], v8 offset:512
v_exp_f32 v176, v176
v_mfma_f32_16x16x32_bf16 v[144:147], a[160:163], v[196:199], v[144:147]
ds_read_b64_tr_b16 a[152:153], v2 offset:17280
v_add_f32 v13, v13, v176
v_mfma_f32_16x16x32_bf16 v[148:151], a[164:167], v[196:199], v[148:151]
v_exp_f32 v177, v177
v_mfma_f32_16x16x32_bf16 v[152:155], a[168:171], v[196:199], v[152:155]
ds_read_b64_tr_b16 a[154:155], v2 offset:21408
v_cvt_pk_bf16_f32 v192, v176, v177
v_add_f32 v13, v13, v177
v_mfma_f32_16x16x32_bf16 v[156:159], a[172:175], v[196:199], v[156:159]
ds_read_b128 a[236:239], v8 offset:768
v_exp_f32 v178, v178
v_mfma_f32_16x16x32_bf16 v[160:163], a[176:179], v[196:199], v[160:163]
ds_read_b64_tr_b16 a[156:157], v2 offset:17288
v_add_f32 v13, v13, v178
v_mfma_f32_16x16x32_bf16 v[164:167], a[180:183], v[196:199], v[164:167]
v_exp_f32 v179, v179
v_mfma_f32_16x16x32_bf16 v[168:171], a[184:187], v[196:199], v[168:171]
ds_read_b64_tr_b16 a[158:159], v2 offset:21416
v_cvt_pk_bf16_f32 v193, v178, v179
v_add_f32 v13, v13, v179
v_mfma_f32_16x16x32_bf16 v[172:175], a[188:191], v[196:199], v[172:175]
v_exp_f32 v180, v180
v_mfma_f32_16x16x32_bf16 v[184:187], a[192:195], v[80:83], -4.0
ds_read_b128 a[240:243], v8 offset:4096
v_add_f32 v13, v13, v180
v_mfma_f32_16x16x32_bf16 v[184:187], a[196:199], v[84:87], v[184:187]
ds_read_b128 a[244:247], v8 offset:4352
v_exp_f32 v181, v181
v_mfma_f32_16x16x32_bf16 v[184:187], a[200:203], v[88:91], v[184:187]
v_cvt_pk_bf16_f32 v194, v180, v181
v_add_f32 v13, v13, v181
v_mfma_f32_16x16x32_bf16 v[184:187], a[204:207], v[92:95], v[184:187]
ds_read_b64_tr_b16 a[160:161], v232 offset:0
v_exp_f32 v182, v182
v_mfma_f32_16x16x32_bf16 v[188:191], a[208:211], v[80:83], -4.0
ds_read_b128 a[248:251], v8 offset:4608
v_add_f32 v13, v13, v182
v_mfma_f32_16x16x32_bf16 v[188:191], a[212:215], v[84:87], v[188:191]
ds_read_b128 a[252:255], v8 offset:4864
v_exp_f32 v183, v183
v_mfma_f32_16x16x32_bf16 v[188:191], a[216:219], v[88:91], v[188:191]
v_cvt_pk_bf16_f32 v195, v182, v183
v_add_f32 v13, v13, v183
v_mfma_f32_16x16x32_bf16 v[188:191], a[220:223], v[92:95], v[188:191]
s_waitcnt lgkmcnt(5)
v_exp_f32 v184, v184
v_mfma_f32_16x16x32_bf16 a[96:99], a[128:131], v[192:195], a[96:99]
ds_read_b64_tr_b16 a[162:163], v232 offset:4128
v_add_f32 v14, v14, v184
v_mfma_f32_16x16x32_bf16 a[100:103], a[132:135], v[192:195], a[100:103]
ds_read_b64_tr_b16 a[164:165], v232 offset:8
v_exp_f32 v185, v185
v_mfma_f32_16x16x32_bf16 a[104:107], a[136:139], v[192:195], a[104:107]
v_cvt_pk_bf16_f32 v196, v184, v185
v_add_f32 v14, v14, v185
v_mfma_f32_16x16x32_bf16 a[108:111], a[140:143], v[192:195], a[108:111]
ds_read_b64_tr_b16 a[166:167], v232 offset:4136
v_exp_f32 v186, v186
v_mfma_f32_16x16x32_bf16 a[112:115], a[144:147], v[192:195], a[112:115]
ds_read_b64_tr_b16 a[168:169], v232 offset:256
v_add_f32 v14, v14, v186
v_mfma_f32_16x16x32_bf16 a[116:119], a[148:151], v[192:195], a[116:119]
v_exp_f32 v187, v187
v_mfma_f32_16x16x32_bf16 a[120:123], a[152:155], v[192:195], a[120:123]
ds_read_b64_tr_b16 a[170:171], v232 offset:4384
v_cvt_pk_bf16_f32 v197, v186, v187
v_add_f32 v14, v14, v187
v_mfma_f32_16x16x32_bf16 a[124:127], a[156:159], v[192:195], a[124:127]
s_waitcnt lgkmcnt(5)
v_exp_f32 v188, v188
v_mfma_f32_16x16x32_bf16 v[176:179], a[224:227], v[64:67], -4.0
ds_read_b64_tr_b16 a[172:173], v232 offset:264
v_add_f32 v14, v14, v188
v_mfma_f32_16x16x32_bf16 v[176:179], a[228:231], v[68:71], v[176:179]
v_exp_f32 v189, v189
v_mfma_f32_16x16x32_bf16 v[176:179], a[232:235], v[72:75], v[176:179]
ds_read_b64_tr_b16 a[174:175], v232 offset:4392
v_cvt_pk_bf16_f32 v198, v188, v189
v_add_f32 v14, v14, v189
v_mfma_f32_16x16x32_bf16 v[176:179], a[236:239], v[76:79], v[176:179]
v_exp_f32 v190, v190
v_mfma_f32_16x16x32_bf16 v[180:183], a[240:243], v[64:67], -4.0
ds_read_b64_tr_b16 a[176:177], v232 offset:512
v_add_f32 v14, v14, v190
v_mfma_f32_16x16x32_bf16 v[180:183], a[244:247], v[68:71], v[180:183]
ds_read_b64_tr_b16 a[178:179], v232 offset:4640
v_exp_f32 v191, v191
v_mfma_f32_16x16x32_bf16 v[180:183], a[248:251], v[72:75], v[180:183]
v_cvt_pk_bf16_f32 v199, v190, v191
v_add_f32 v14, v14, v191
v_mfma_f32_16x16x32_bf16 v[180:183], a[252:255], v[76:79], v[180:183]
ds_read_b64_tr_b16 a[180:181], v232 offset:520
v_exp_f32 v176, v176
v_mfma_f32_16x16x32_bf16 v[112:115], a[128:131], v[196:199], v[112:115]
ds_read_b64_tr_b16 a[182:183], v232 offset:4648
v_add_f32 v13, v13, v176
v_mfma_f32_16x16x32_bf16 v[116:119], a[132:135], v[196:199], v[116:119]
v_exp_f32 v177, v177
v_mfma_f32_16x16x32_bf16 v[120:123], a[136:139], v[196:199], v[120:123]
ds_read_b64_tr_b16 a[184:185], v232 offset:768
v_cvt_pk_bf16_f32 v192, v176, v177
v_add_f32 v13, v13, v177
v_mfma_f32_16x16x32_bf16 v[124:127], a[140:143], v[196:199], v[124:127]
v_exp_f32 v178, v178
v_mfma_f32_16x16x32_bf16 v[128:131], a[144:147], v[196:199], v[128:131]
ds_read_b64_tr_b16 a[186:187], v232 offset:4896
v_add_f32 v13, v13, v178
v_mfma_f32_16x16x32_bf16 v[132:135], a[148:151], v[196:199], v[132:135]
ds_read_b64_tr_b16 a[188:189], v232 offset:776
v_exp_f32 v179, v179
v_mfma_f32_16x16x32_bf16 v[136:139], a[152:155], v[196:199], v[136:139]
v_cvt_pk_bf16_f32 v193, v178, v179
v_add_f32 v13, v13, v179
v_mfma_f32_16x16x32_bf16 v[140:143], a[156:159], v[196:199], v[140:143]
ds_read_b64_tr_b16 a[190:191], v232 offset:4904
v_exp_f32 v180, v180
v_mfma_f32_16x16x32_bf16 v[184:187], a[192:195], v[96:99], -4.0
v_add_f32 v13, v13, v180
v_mfma_f32_16x16x32_bf16 v[184:187], a[196:199], v[100:103], v[184:187]
v_exp_f32 v181, v181
v_mfma_f32_16x16x32_bf16 v[184:187], a[200:203], v[104:107], v[184:187]
v_cvt_pk_bf16_f32 v194, v180, v181
v_add_f32 v13, v13, v181
v_mfma_f32_16x16x32_bf16 v[184:187], a[204:207], v[108:111], v[184:187]
v_exp_f32 v182, v182
v_mfma_f32_16x16x32_bf16 v[188:191], a[208:211], v[96:99], -4.0
v_add_f32 v13, v13, v182
v_mfma_f32_16x16x32_bf16 v[188:191], a[212:215], v[100:103], v[188:191]
v_exp_f32 v183, v183
v_mfma_f32_16x16x32_bf16 v[188:191], a[216:219], v[104:107], v[188:191]
v_cvt_pk_bf16_f32 v195, v182, v183
v_add_f32 v13, v13, v183
v_mfma_f32_16x16x32_bf16 v[188:191], a[220:223], v[108:111], v[188:191]
s_waitcnt lgkmcnt(0)
v_exp_f32 v184, v184
v_mfma_f32_16x16x32_bf16 a[96:99], a[160:163], v[192:195], a[96:99]
v_add_f32 v15, v15, v184
v_mfma_f32_16x16x32_bf16 a[100:103], a[164:167], v[192:195], a[100:103]
v_exp_f32 v185, v185
v_mfma_f32_16x16x32_bf16 a[104:107], a[168:171], v[192:195], a[104:107]
v_cvt_pk_bf16_f32 v196, v184, v185
v_add_f32 v15, v15, v185
v_mfma_f32_16x16x32_bf16 a[108:111], a[172:175], v[192:195], a[108:111]
v_exp_f32 v186, v186
v_mfma_f32_16x16x32_bf16 a[112:115], a[176:179], v[192:195], a[112:115]
v_add_f32 v15, v15, v186
v_mfma_f32_16x16x32_bf16 a[116:119], a[180:183], v[192:195], a[116:119]
v_exp_f32 v187, v187
v_mfma_f32_16x16x32_bf16 a[120:123], a[184:187], v[192:195], a[120:123]
v_cvt_pk_bf16_f32 v197, v186, v187
v_add_f32 v15, v15, v187
v_mfma_f32_16x16x32_bf16 a[124:127], a[188:191], v[192:195], a[124:127]
v_exp_f32 v188, v188
v_mfma_f32_16x16x4_f32 v[200:203], v7, v13, 0
s_add_u32 s3, s27, 12288
v_accvgpr_read_b32 v204, a96
v_accvgpr_read_b32 v205, a97
v_accvgpr_read_b32 v206, a98
v_accvgpr_read_b32 v207, a99
v_accvgpr_read_b32 v208, a100
v_accvgpr_read_b32 v209, a101
v_accvgpr_read_b32 v210, a102
v_accvgpr_read_b32 v211, a103
v_accvgpr_read_b32 v212, a104
v_accvgpr_read_b32 v213, a105
v_accvgpr_read_b32 v214, a106
v_accvgpr_read_b32 v215, a107
v_accvgpr_read_b32 v216, a108
v_accvgpr_read_b32 v217, a109
v_accvgpr_read_b32 v218, a110
v_accvgpr_read_b32 v219, a111
v_rcp_f32 v200, v200
v_subrev_u32 v202, s47, v201
v_max_u32 v9, v9, v202
v_pk_mul_f32 v[204:205], v[204:205], v[200:201] op_sel_hi:[1,0]
v_pk_mul_f32 v[206:207], v[206:207], v[200:201] op_sel_hi:[1,0]
v_pk_mul_f32 v[208:209], v[208:209], v[200:201] op_sel_hi:[1,0]
v_pk_mul_f32 v[210:211], v[210:211], v[200:201] op_sel_hi:[1,0]
v_cvt_pk_bf16_f32 v220, v204, v205
v_cvt_pk_bf16_f32 v221, v206, v207
v_cvt_pk_bf16_f32 v222, v208, v209
v_cvt_pk_bf16_f32 v223, v210, v211
v_accvgpr_read_b32 v204, a112
v_accvgpr_read_b32 v205, a113
v_accvgpr_read_b32 v206, a114
v_accvgpr_read_b32 v207, a115
v_accvgpr_read_b32 v208, a116
v_accvgpr_read_b32 v209, a117
v_accvgpr_read_b32 v210, a118
v_accvgpr_read_b32 v211, a119
v_pk_mul_f32 v[212:213], v[212:213], v[200:201] op_sel_hi:[1,0]
v_pk_mul_f32 v[214:215], v[214:215], v[200:201] op_sel_hi:[1,0]
v_pk_mul_f32 v[216:217], v[216:217], v[200:201] op_sel_hi:[1,0]
v_pk_mul_f32 v[218:219], v[218:219], v[200:201] op_sel_hi:[1,0]
v_cvt_pk_bf16_f32 v224, v212, v213
v_cvt_pk_bf16_f32 v225, v214, v215
v_cvt_pk_bf16_f32 v226, v216, v217
v_cvt_pk_bf16_f32 v227, v218, v219
v_cndmask_b32_dpp v244, v220, v224, vcc row_ror:8 row_mask:0xf bank_mask:0xf
v_cndmask_b32_dpp v245, v221, v225, vcc row_ror:8 row_mask:0xf bank_mask:0xf
v_cndmask_b32_dpp v246, v222, v226, vcc row_ror:8 row_mask:0xf bank_mask:0xf
v_cndmask_b32_dpp v247, v223, v227, vcc row_ror:8 row_mask:0xf bank_mask:0xf
s_not_b64 vcc, vcc
v_cndmask_b32_dpp v240, v224, v220, vcc row_ror:8 row_mask:0xf bank_mask:0xf
v_cndmask_b32_dpp v241, v225, v221, vcc row_ror:8 row_mask:0xf bank_mask:0xf
v_cndmask_b32_dpp v242, v226, v222, vcc row_ror:8 row_mask:0xf bank_mask:0xf
v_cndmask_b32_dpp v243, v227, v223, vcc row_ror:8 row_mask:0xf bank_mask:0xf
s_not_b64 vcc, vcc
v_accvgpr_read_b32 v212, a120
v_accvgpr_read_b32 v213, a121
buffer_store_dwordx4 v[240:243], v233, s[16:19], s3 offen offset:0 sc1
v_accvgpr_read_b32 v214, a122
v_accvgpr_read_b32 v215, a123
v_accvgpr_read_b32 v216, a124
v_accvgpr_read_b32 v217, a125
v_accvgpr_read_b32 v218, a126
v_accvgpr_read_b32 v219, a127
v_pk_mul_f32 v[204:205], v[204:205], v[200:201] op_sel_hi:[1,0]
v_pk_mul_f32 v[206:207], v[206:207], v[200:201] op_sel_hi:[1,0]
v_pk_mul_f32 v[208:209], v[208:209], v[200:201] op_sel_hi:[1,0]
v_pk_mul_f32 v[210:211], v[210:211], v[200:201] op_sel_hi:[1,0]
v_cvt_pk_bf16_f32 v220, v204, v205
v_cvt_pk_bf16_f32 v221, v206, v207
v_cvt_pk_bf16_f32 v222, v208, v209
v_cvt_pk_bf16_f32 v223, v210, v211
v_pk_mul_f32 v[212:213], v[212:213], v[200:201] op_sel_hi:[1,0]
v_pk_mul_f32 v[214:215], v[214:215], v[200:201] op_sel_hi:[1,0]
v_pk_mul_f32 v[216:217], v[216:217], v[200:201] op_sel_hi:[1,0]
v_pk_mul_f32 v[218:219], v[218:219], v[200:201] op_sel_hi:[1,0]
v_cvt_pk_bf16_f32 v224, v212, v213
v_cvt_pk_bf16_f32 v225, v214, v215
v_cvt_pk_bf16_f32 v226, v216, v217
v_cvt_pk_bf16_f32 v227, v218, v219
v_cndmask_b32_dpp v252, v220, v224, vcc row_ror:8 row_mask:0xf bank_mask:0xf
v_cndmask_b32_dpp v253, v221, v225, vcc row_ror:8 row_mask:0xf bank_mask:0xf
v_cndmask_b32_dpp v254, v222, v226, vcc row_ror:8 row_mask:0xf bank_mask:0xf
v_cndmask_b32_dpp v255, v223, v227, vcc row_ror:8 row_mask:0xf bank_mask:0xf
s_not_b64 vcc, vcc
v_cndmask_b32_dpp v248, v224, v220, vcc row_ror:8 row_mask:0xf bank_mask:0xf
v_cndmask_b32_dpp v249, v225, v221, vcc row_ror:8 row_mask:0xf bank_mask:0xf
v_cndmask_b32_dpp v250, v226, v222, vcc row_ror:8 row_mask:0xf bank_mask:0xf
v_cndmask_b32_dpp v251, v227, v223, vcc row_ror:8 row_mask:0xf bank_mask:0xf
s_not_b64 vcc, vcc
v_mfma_f32_16x16x32_bf16 v[176:179], a[224:227], v[80:83], -4.0
v_add_f32 v15, v15, v188
v_mfma_f32_16x16x32_bf16 v[176:179], a[228:231], v[84:87], v[176:179]
v_exp_f32 v189, v189
v_mfma_f32_16x16x32_bf16 v[176:179], a[232:235], v[88:91], v[176:179]
v_cvt_pk_bf16_f32 v198, v188, v189
v_add_f32 v15, v15, v189
v_mfma_f32_16x16x32_bf16 v[176:179], a[236:239], v[92:95], v[176:179]
v_exp_f32 v190, v190
v_mfma_f32_16x16x32_bf16 v[180:183], a[240:243], v[80:83], -4.0
v_add_f32 v15, v15, v190
v_mfma_f32_16x16x32_bf16 v[180:183], a[244:247], v[84:87], v[180:183]
buffer_store_dwordx4 v[244:247], v233, s[16:19], s3 offen offset:2048 sc1
v_exp_f32 v191, v191
v_mfma_f32_16x16x32_bf16 v[180:183], a[248:251], v[88:91], v[180:183]
v_cvt_pk_bf16_f32 v199, v190, v191
v_add_f32 v15, v15, v191
v_mfma_f32_16x16x32_bf16 v[180:183], a[252:255], v[92:95], v[180:183]
v_exp_f32 v176, v176
v_mfma_f32_16x16x32_bf16 v[144:147], a[128:131], v[196:199], v[144:147]
v_add_f32 v14, v14, v176
v_mfma_f32_16x16x32_bf16 v[148:151], a[132:135], v[196:199], v[148:151]
v_exp_f32 v177, v177
v_mfma_f32_16x16x32_bf16 v[152:155], a[136:139], v[196:199], v[152:155]
v_cvt_pk_bf16_f32 v192, v176, v177
v_add_f32 v14, v14, v177
v_mfma_f32_16x16x32_bf16 v[156:159], a[140:143], v[196:199], v[156:159]
v_exp_f32 v178, v178
v_mfma_f32_16x16x32_bf16 v[160:163], a[144:147], v[196:199], v[160:163]
v_add_f32 v14, v14, v178
v_mfma_f32_16x16x32_bf16 v[164:167], a[148:151], v[196:199], v[164:167]
v_exp_f32 v179, v179
v_mfma_f32_16x16x32_bf16 v[168:171], a[152:155], v[196:199], v[168:171]
v_cvt_pk_bf16_f32 v193, v178, v179
v_add_f32 v14, v14, v179
v_mfma_f32_16x16x32_bf16 v[172:175], a[156:159], v[196:199], v[172:175]
v_exp_f32 v180, v180
v_mfma_f32_16x16x32_bf16 v[184:187], a[224:227], v[96:99], -4.0
v_add_f32 v14, v14, v180
v_mfma_f32_16x16x32_bf16 v[184:187], a[228:231], v[100:103], v[184:187]
buffer_store_dwordx4 v[248:251], v233, s[16:19], s3 offen offset:128 sc1
v_exp_f32 v181, v181
v_mfma_f32_16x16x32_bf16 v[184:187], a[232:235], v[104:107], v[184:187]
v_cvt_pk_bf16_f32 v194, v180, v181
v_add_f32 v14, v14, v181
v_mfma_f32_16x16x32_bf16 v[184:187], a[236:239], v[108:111], v[184:187]
v_exp_f32 v182, v182
v_mfma_f32_16x16x32_bf16 v[188:191], a[240:243], v[96:99], -4.0
v_add_f32 v14, v14, v182
v_mfma_f32_16x16x32_bf16 v[188:191], a[244:247], v[100:103], v[188:191]
v_exp_f32 v183, v183
v_mfma_f32_16x16x32_bf16 v[188:191], a[248:251], v[104:107], v[188:191]
v_cvt_pk_bf16_f32 v195, v182, v183
v_add_f32 v14, v14, v183
v_mfma_f32_16x16x32_bf16 v[188:191], a[252:255], v[108:111], v[188:191]
v_exp_f32 v184, v184
v_mfma_f32_16x16x32_bf16 v[112:115], a[160:163], v[192:195], v[112:115]
v_add_f32 v15, v15, v184
v_mfma_f32_16x16x32_bf16 v[116:119], a[164:167], v[192:195], v[116:119]
v_exp_f32 v185, v185
v_mfma_f32_16x16x32_bf16 v[120:123], a[168:171], v[192:195], v[120:123]
v_cvt_pk_bf16_f32 v196, v184, v185
v_add_f32 v15, v15, v185
v_mfma_f32_16x16x32_bf16 v[124:127], a[172:175], v[192:195], v[124:127]
v_exp_f32 v186, v186
v_mfma_f32_16x16x32_bf16 v[128:131], a[176:179], v[192:195], v[128:131]
v_add_f32 v15, v15, v186
v_mfma_f32_16x16x32_bf16 v[132:135], a[180:183], v[192:195], v[132:135]
v_exp_f32 v187, v187
v_mfma_f32_16x16x32_bf16 v[136:139], a[184:187], v[192:195], v[136:139]
v_cvt_pk_bf16_f32 v197, v186, v187
v_add_f32 v15, v15, v187
v_mfma_f32_16x16x32_bf16 v[140:143], a[188:191], v[192:195], v[140:143]
v_exp_f32 v188, v188
v_mfma_f32_16x16x4_f32 v[200:203], v7, v14, 0
buffer_store_dwordx4 v[252:255], v233, s[16:19], s3 offen offset:2176 sc1
s_add_u32 s3, s27, 16384
s_nop 7
v_rcp_f32 v200, v200
v_subrev_u32 v202, s47, v201
v_max_u32 v9, v9, v202
v_pk_mul_f32 v[112:113], v[112:113], v[200:201] op_sel_hi:[1,0]
v_pk_mul_f32 v[114:115], v[114:115], v[200:201] op_sel_hi:[1,0]
v_pk_mul_f32 v[116:117], v[116:117], v[200:201] op_sel_hi:[1,0]
v_pk_mul_f32 v[118:119], v[118:119], v[200:201] op_sel_hi:[1,0]
v_cvt_pk_bf16_f32 v220, v112, v113
v_cvt_pk_bf16_f32 v221, v114, v115
v_cvt_pk_bf16_f32 v222, v116, v117
v_cvt_pk_bf16_f32 v223, v118, v119
v_pk_mul_f32 v[120:121], v[120:121], v[200:201] op_sel_hi:[1,0]
v_pk_mul_f32 v[122:123], v[122:123], v[200:201] op_sel_hi:[1,0]
v_pk_mul_f32 v[124:125], v[124:125], v[200:201] op_sel_hi:[1,0]
v_pk_mul_f32 v[126:127], v[126:127], v[200:201] op_sel_hi:[1,0]
v_cvt_pk_bf16_f32 v224, v120, v121
v_cvt_pk_bf16_f32 v225, v122, v123
v_cvt_pk_bf16_f32 v226, v124, v125
v_cvt_pk_bf16_f32 v227, v126, v127
v_cndmask_b32_dpp v244, v220, v224, vcc row_ror:8 row_mask:0xf bank_mask:0xf
v_cndmask_b32_dpp v245, v221, v225, vcc row_ror:8 row_mask:0xf bank_mask:0xf
v_cndmask_b32_dpp v246, v222, v226, vcc row_ror:8 row_mask:0xf bank_mask:0xf
v_cndmask_b32_dpp v247, v223, v227, vcc row_ror:8 row_mask:0xf bank_mask:0xf
s_not_b64 vcc, vcc
v_cndmask_b32_dpp v240, v224, v220, vcc row_ror:8 row_mask:0xf bank_mask:0xf
v_cndmask_b32_dpp v241, v225, v221, vcc row_ror:8 row_mask:0xf bank_mask:0xf
v_cndmask_b32_dpp v242, v226, v222, vcc row_ror:8 row_mask:0xf bank_mask:0xf
v_cndmask_b32_dpp v243, v227, v223, vcc row_ror:8 row_mask:0xf bank_mask:0xf
s_not_b64 vcc, vcc
v_pk_mul_f32 v[128:129], v[128:129], v[200:201] op_sel_hi:[1,0]
v_pk_mul_f32 v[130:131], v[130:131], v[200:201] op_sel_hi:[1,0]
buffer_store_dwordx4 v[240:243], v233, s[16:19], s3 offen offset:0 sc1
v_pk_mul_f32 v[132:133], v[132:133], v[200:201] op_sel_hi:[1,0]
v_pk_mul_f32 v[134:135], v[134:135], v[200:201] op_sel_hi:[1,0]
v_cvt_pk_bf16_f32 v220, v128, v129
v_cvt_pk_bf16_f32 v221, v130, v131
v_cvt_pk_bf16_f32 v222, v132, v133
v_cvt_pk_bf16_f32 v223, v134, v135
v_pk_mul_f32 v[136:137], v[136:137], v[200:201] op_sel_hi:[1,0]
v_pk_mul_f32 v[138:139], v[138:139], v[200:201] op_sel_hi:[1,0]
v_pk_mul_f32 v[140:141], v[140:141], v[200:201] op_sel_hi:[1,0]
v_pk_mul_f32 v[142:143], v[142:143], v[200:201] op_sel_hi:[1,0]
v_cvt_pk_bf16_f32 v224, v136, v137
v_cvt_pk_bf16_f32 v225, v138, v139
v_cvt_pk_bf16_f32 v226, v140, v141
v_cvt_pk_bf16_f32 v227, v142, v143
v_cndmask_b32_dpp v252, v220, v224, vcc row_ror:8 row_mask:0xf bank_mask:0xf
v_cndmask_b32_dpp v253, v221, v225, vcc row_ror:8 row_mask:0xf bank_mask:0xf
v_cndmask_b32_dpp v254, v222, v226, vcc row_ror:8 row_mask:0xf bank_mask:0xf
v_cndmask_b32_dpp v255, v223, v227, vcc row_ror:8 row_mask:0xf bank_mask:0xf
s_not_b64 vcc, vcc
v_cndmask_b32_dpp v248, v224, v220, vcc row_ror:8 row_mask:0xf bank_mask:0xf
v_cndmask_b32_dpp v249, v225, v221, vcc row_ror:8 row_mask:0xf bank_mask:0xf
v_cndmask_b32_dpp v250, v226, v222, vcc row_ror:8 row_mask:0xf bank_mask:0xf
v_cndmask_b32_dpp v251, v227, v223, vcc row_ror:8 row_mask:0xf bank_mask:0xf
s_not_b64 vcc, vcc
v_exp_f32 v189, v189
v_exp_f32 v190, v190
v_exp_f32 v191, v191
buffer_store_dwordx4 v[244:247], v233, s[16:19], s3 offen offset:2048 sc1
v_add_f32 v15, v15, v188
v_cvt_pk_bf16_f32 v198, v188, v189
v_add_f32 v15, v15, v189
v_add_f32 v15, v15, v190
v_cvt_pk_bf16_f32 v199, v190, v191
v_add_f32 v15, v15, v191
s_nop 0
v_mfma_f32_16x16x32_bf16 v[144:147], a[160:163], v[196:199], v[144:147]
v_mfma_f32_16x16x32_bf16 v[148:151], a[164:167], v[196:199], v[148:151]
buffer_store_dwordx4 v[248:251], v233, s[16:19], s3 offen offset:128 sc1
v_mfma_f32_16x16x32_bf16 v[152:155], a[168:171], v[196:199], v[152:155]
v_mfma_f32_16x16x32_bf16 v[156:159], a[172:175], v[196:199], v[156:159]
v_mfma_f32_16x16x32_bf16 v[160:163], a[176:179], v[196:199], v[160:163]
v_mfma_f32_16x16x32_bf16 v[164:167], a[180:183], v[196:199], v[164:167]
v_mfma_f32_16x16x32_bf16 v[168:171], a[184:187], v[196:199], v[168:171]
v_mfma_f32_16x16x32_bf16 v[172:175], a[188:191], v[196:199], v[172:175]
v_mfma_f32_16x16x4_f32 v[200:203], v7, v15, 0
buffer_store_dwordx4 v[252:255], v233, s[16:19], s3 offen offset:2176 sc1
s_add_u32 s3, s27, 20480
s_nop 7
v_rcp_f32 v200, v200
v_subrev_u32 v202, s47, v201
v_max_u32 v9, v9, v202
v_pk_mul_f32 v[144:145], v[144:145], v[200:201] op_sel_hi:[1,0]
v_pk_mul_f32 v[146:147], v[146:147], v[200:201] op_sel_hi:[1,0]
v_pk_mul_f32 v[148:149], v[148:149], v[200:201] op_sel_hi:[1,0]
v_pk_mul_f32 v[150:151], v[150:151], v[200:201] op_sel_hi:[1,0]
v_cvt_pk_bf16_f32 v220, v144, v145
v_cvt_pk_bf16_f32 v221, v146, v147
v_cvt_pk_bf16_f32 v222, v148, v149
v_cvt_pk_bf16_f32 v223, v150, v151
v_pk_mul_f32 v[152:153], v[152:153], v[200:201] op_sel_hi:[1,0]
v_pk_mul_f32 v[154:155], v[154:155], v[200:201] op_sel_hi:[1,0]
v_pk_mul_f32 v[156:157], v[156:157], v[200:201] op_sel_hi:[1,0]
v_pk_mul_f32 v[158:159], v[158:159], v[200:201] op_sel_hi:[1,0]
v_cvt_pk_bf16_f32 v224, v152, v153
v_cvt_pk_bf16_f32 v225, v154, v155
v_cvt_pk_bf16_f32 v226, v156, v157
v_cvt_pk_bf16_f32 v227, v158, v159
v_cndmask_b32_dpp v244, v220, v224, vcc row_ror:8 row_mask:0xf bank_mask:0xf
v_cndmask_b32_dpp v245, v221, v225, vcc row_ror:8 row_mask:0xf bank_mask:0xf
v_cndmask_b32_dpp v246, v222, v226, vcc row_ror:8 row_mask:0xf bank_mask:0xf
v_cndmask_b32_dpp v247, v223, v227, vcc row_ror:8 row_mask:0xf bank_mask:0xf
s_not_b64 vcc, vcc
v_cndmask_b32_dpp v240, v224, v220, vcc row_ror:8 row_mask:0xf bank_mask:0xf
v_cndmask_b32_dpp v241, v225, v221, vcc row_ror:8 row_mask:0xf bank_mask:0xf
v_cndmask_b32_dpp v242, v226, v222, vcc row_ror:8 row_mask:0xf bank_mask:0xf
v_cndmask_b32_dpp v243, v227, v223, vcc row_ror:8 row_mask:0xf bank_mask:0xf
s_not_b64 vcc, vcc
v_pk_mul_f32 v[160:161], v[160:161], v[200:201] op_sel_hi:[1,0]
v_pk_mul_f32 v[162:163], v[162:163], v[200:201] op_sel_hi:[1,0]
buffer_store_dwordx4 v[240:243], v233, s[16:19], s3 offen offset:0 sc1
v_pk_mul_f32 v[164:165], v[164:165], v[200:201] op_sel_hi:[1,0]
v_pk_mul_f32 v[166:167], v[166:167], v[200:201] op_sel_hi:[1,0]
v_cvt_pk_bf16_f32 v220, v160, v161
v_cvt_pk_bf16_f32 v221, v162, v163
v_cvt_pk_bf16_f32 v222, v164, v165
v_cvt_pk_bf16_f32 v223, v166, v167
v_pk_mul_f32 v[168:169], v[168:169], v[200:201] op_sel_hi:[1,0]
v_pk_mul_f32 v[170:171], v[170:171], v[200:201] op_sel_hi:[1,0]
buffer_store_dwordx4 v[244:247], v233, s[16:19], s3 offen offset:2048 sc1
v_pk_mul_f32 v[172:173], v[172:173], v[200:201] op_sel_hi:[1,0]
v_pk_mul_f32 v[174:175], v[174:175], v[200:201] op_sel_hi:[1,0]
v_cvt_pk_bf16_f32 v224, v168, v169
v_cvt_pk_bf16_f32 v225, v170, v171
v_cvt_pk_bf16_f32 v226, v172, v173
v_cvt_pk_bf16_f32 v227, v174, v175
v_cndmask_b32_dpp v252, v220, v224, vcc row_ror:8 row_mask:0xf bank_mask:0xf
v_cndmask_b32_dpp v253, v221, v225, vcc row_ror:8 row_mask:0xf bank_mask:0xf
v_cndmask_b32_dpp v254, v222, v226, vcc row_ror:8 row_mask:0xf bank_mask:0xf
v_cndmask_b32_dpp v255, v223, v227, vcc row_ror:8 row_mask:0xf bank_mask:0xf
s_not_b64 vcc, vcc
v_cndmask_b32_dpp v248, v224, v220, vcc row_ror:8 row_mask:0xf bank_mask:0xf
v_cndmask_b32_dpp v249, v225, v221, vcc row_ror:8 row_mask:0xf bank_mask:0xf
v_cndmask_b32_dpp v250, v226, v222, vcc row_ror:8 row_mask:0xf bank_mask:0xf
v_cndmask_b32_dpp v251, v227, v223, vcc row_ror:8 row_mask:0xf bank_mask:0xf
s_not_b64 vcc, vcc
s_nop 0
buffer_store_dwordx4 v[248:251], v233, s[16:19], s3 offen offset:128 sc1
buffer_store_dwordx4 v[252:255], v233, s[16:19], s3 offen offset:2176 sc1
v_cmp_le_u32 vcc, 0x28000000, v9
s_nop 4
s_cbranch_vccnz L_fallback
s_endpgm
L_varB:
s_mov_b32 s101, 5
s_waitcnt vmcnt(8)
s_add_u32 m0, s46, 4096
s_add_u32 s32, s27, 4096
buffer_load_dwordx4 v3, s[4:7], s32 offen offset:0 nt lds
buffer_load_dwordx4 v3, s[4:7], s32 offen offset:1024 nt lds
buffer_load_dwordx4 v4, s[4:7], s32 offen offset:2048 nt lds
buffer_load_dwordx4 v4, s[4:7], s32 offen offset:3072 nt lds
s_waitcnt vmcnt(8)
s_barrier
ds_read_b128 a[192:195], v1 offset:0
ds_read_b128 a[196:199], v1 offset:256
ds_read_b128 a[200:203], v1 offset:512
ds_read_b128 a[204:207], v1 offset:768
ds_read_b128 a[208:211], v1 offset:4096
ds_read_b128 a[212:215], v1 offset:4352
ds_read_b128 a[216:219], v1 offset:4608
ds_read_b128 a[220:223], v1 offset:4864
s_waitcnt vmcnt(4)
ds_read_b128 v[16:19], v8 offset:0
ds_read_b128 v[20:23], v8 offset:256
ds_read_b128 v[24:27], v8 offset:512
ds_read_b128 v[28:31], v8 offset:768
ds_read_b128 a[224:227], v1 offset:8192
ds_read_b128 a[228:231], v1 offset:8448
ds_read_b128 a[232:235], v1 offset:8704
ds_read_b128 a[236:239], v1 offset:8960
ds_read_b128 a[240:243], v1 offset:12288
ds_read_b128 a[244:247], v1 offset:12544
ds_read_b128 a[248:251], v1 offset:12800
ds_read_b128 a[252:255], v1 offset:13056
s_add_u32 m0, s46, 8192
s_add_u32 s32, s27, 8192
buffer_load_dwordx4 v3, s[4:7], s32 offen offset:0 nt lds
buffer_load_dwordx4 v3, s[4:7], s32 offen offset:1024 nt lds
buffer_load_dwordx4 v4, s[4:7], s32 offen offset:2048 nt lds
buffer_load_dwordx4 v4, s[4:7], s32 offen offset:3072 nt lds
s_waitcnt lgkmcnt(8)
v_lshlrev_b32 v220, 16, v16
v_and_b32 v221, s31, v16
v_lshlrev_b32 v222, 16, v17
v_and_b32 v223, s31, v17
ds_read_b64_tr_b16 a[128:129], v2 offset:0
v_pk_mul_f32 v[220:221], v[220:221], s[38:39]
v_pk_mul_f32 v[222:223], v[222:223], s[38:39]
v_cvt_pk_bf16_f32 v16, v220, v221
v_cvt_pk_bf16_f32 v17, v222, v223
ds_read_b64_tr_b16 a[130:131], v2 offset:4128
v_lshlrev_b32 v224, 16, v18
v_and_b32 v225, s31, v18
v_lshlrev_b32 v226, 16, v19
v_and_b32 v227, s31, v19
ds_read_b64_tr_b16 a[132:133], v2 offset:8
v_pk_mul_f32 v[224:225], v[224:225], s[38:39]
v_pk_mul_f32 v[226:227], v[226:227], s[38:39]
v_cvt_pk_bf16_f32 v18, v224, v225
v_cvt_pk_bf16_f32 v19, v226, v227
ds_read_b64_tr_b16 a[134:135], v2 offset:4136
v_lshlrev_b32 v220, 16, v20
v_and_b32 v221, s31, v20
v_lshlrev_b32 v222, 16, v21
v_and_b32 v223, s31, v21
ds_read_b64_tr_b16 a[136:137], v2 offset:256
v_pk_mul_f32 v[220:221], v[220:221], s[38:39]
v_pk_mul_f32 v[222:223], v[222:223], s[38:39]
v_cvt_pk_bf16_f32 v20, v220, v221
L_pad7:
s_cbranch_execz L_pad11
v_cvt_pk_bf16_f32 v21, v222, v223
ds_read_b64_tr_b16 a[138:139], v2 offset:4384
v_lshlrev_b32 v224, 16, v22
v_and_b32 v225, s31, v22
v_lshlrev_b32 v226, 16, v23
v_and_b32 v227, s31, v23
ds_read_b64_tr_b16 a[140:141], v2 offset:264
v_pk_mul_f32 v[224:225], v[224:225], s[38:39]
v_pk_mul_f32 v[226:227], v[226:227], s[38:39]
v_cvt_pk_bf16_f32 v22, v224, v225
v_cvt_pk_bf16_f32 v23, v226, v227
ds_read_b64_tr_b16 a[142:143], v2 offset:4392
v_lshlrev_b32 v220, 16, v24
v_and_b32 v221, s31, v24
v_lshlrev_b32 v222, 16, v25
v_and_b32 v223, s31, v25
ds_read_b64_tr_b16 a[144:145], v2 offset:512
v_pk_mul_f32 v[220:221], v[220:221], s[38:39]
v_pk_mul_f32 v[222:223], v[222:223], s[38:39]
v_cvt_pk_bf16_f32 v24, v220, v221
v_cvt_pk_bf16_f32 v25, v222, v223
ds_read_b64_tr_b16 a[146:147], v2 offset:4640
v_lshlrev_b32 v224, 16, v26
v_and_b32 v225, s31, v26
v_lshlrev_b32 v226, 16, v27
v_and_b32 v227, s31, v27
ds_read_b64_tr_b16 a[148:149], v2 offset:520
v_pk_mul_f32 v[224:225], v[224:225], s[38:39]
v_pk_mul_f32 v[226:227], v[226:227], s[38:39]
v_cvt_pk_bf16_f32 v26, v224, v225
v_cvt_pk_bf16_f32 v27, v226, v227
ds_read_b64_tr_b16 a[150:151], v2 offset:4648
v_lshlrev_b32 v220, 16, v28
v_and_b32 v221, s31, v28
v_lshlrev_b32 v222, 16, v29
v_and_b32 v223, s31, v29
ds_read_b64_tr_b16 a[152:153], v2 offset:768
v_pk_mul_f32 v[220:221], v[220:221], s[38:39]
v_pk_mul_f32 v[222:223], v[222:223], s[38:39]
v_cvt_pk_bf16_f32 v28, v220, v221
v_cvt_pk_bf16_f32 v29, v222, v223
ds_read_b64_tr_b16 a[154:155], v2 offset:4896
v_lshlrev_b32 v224, 16, v30
v_and_b32 v225, s31, v30
v_lshlrev_b32 v226, 16, v31
v_and_b32 v227, s31, v31
ds_read_b64_tr_b16 a[156:157], v2 offset:776
v_pk_mul_f32 v[224:225], v[224:225], s[38:39]
v_pk_mul_f32 v[226:227], v[226:227], s[38:39]
v_cvt_pk_bf16_f32 v30, v224, v225
v_cvt_pk_bf16_f32 v31, v226, v227
ds_read_b64_tr_b16 a[158:159], v2 offset:4904
v_mov_b32 v10, 0
s_waitcnt lgkmcnt(14)
v_mfma_f32_16x16x32_bf16 v[176:179], a[192:195], v[16:19], -4.0
ds_read_b64_tr_b16 a[160:161], v2 offset:8256
ds_read_b64_tr_b16 a[162:163], v2 offset:12384
v_mfma_f32_16x16x32_bf16 v[176:179], a[196:199], v[20:23], v[176:179]
ds_read_b64_tr_b16 a[164:165], v2 offset:8264
ds_read_b64_tr_b16 a[166:167], v2 offset:12392
v_mfma_f32_16x16x32_bf16 v[176:179], a[200:203], v[24:27], v[176:179]
ds_read_b64_tr_b16 a[168:169], v2 offset:8512
ds_read_b64_tr_b16 a[170:171], v2 offset:12640
v_mfma_f32_16x16x32_bf16 v[176:179], a[204:207], v[28:31], v[176:179]
ds_read_b64_tr_b16 a[172:173], v2 offset:8520
ds_read_b64_tr_b16 a[174:175], v2 offset:12648
v_mfma_f32_16x16x32_bf16 v[180:183], a[208:211], v[16:19], -4.0
ds_read_b64_tr_b16 a[176:177], v2 offset:8768
ds_read_b64_tr_b16 a[178:179], v2 offset:12896
v_mfma_f32_16x16x32_bf16 v[180:183], a[212:215], v[20:23], v[180:183]
ds_read_b64_tr_b16 a[180:181], v2 offset:8776
ds_read_b64_tr_b16 a[182:183], v2 offset:12904
v_mfma_f32_16x16x32_bf16 v[180:183], a[216:219], v[24:27], v[180:183]
ds_read_b64_tr_b16 a[184:185], v2 offset:9024
ds_read_b64_tr_b16 a[186:187], v2 offset:13152
v_mfma_f32_16x16x32_bf16 v[180:183], a[220:223], v[28:31], v[180:183]
ds_read_b64_tr_b16 a[188:189], v2 offset:9032
ds_read_b64_tr_b16 a[190:191], v2 offset:13160
v_exp_f32 v176, v176
v_exp_f32 v177, v177
v_exp_f32 v178, v178
v_exp_f32 v179, v179
s_nop 1
v_exp_f32 v180, v180
v_add_f32 v6, v176, v177
v_cvt_pk_bf16_f32 v192, v176, v177
v_add_f32 v6, v6, v178
v_cvt_pk_bf16_f32 v193, v178, v179
v_add_f32 v6, v6, v179
s_waitcnt lgkmcnt(0)
v_mfma_f32_16x16x32_bf16 v[184:187], a[224:227], v[16:19], -4.0
v_add_f32 v10, v10, v180
v_add_f32 v10, v10, v6
v_mfma_f32_16x16x32_bf16 v[184:187], a[228:231], v[20:23], v[184:187]
v_exp_f32 v181, v181
v_mfma_f32_16x16x32_bf16 v[184:187], a[232:235], v[24:27], v[184:187]
v_cvt_pk_bf16_f32 v194, v180, v181
v_add_f32 v10, v10, v181
v_mfma_f32_16x16x32_bf16 v[184:187], a[236:239], v[28:31], v[184:187]
v_exp_f32 v182, v182
v_mfma_f32_16x16x32_bf16 v[188:191], a[240:243], v[16:19], -4.0
v_add_f32 v10, v10, v182
v_mfma_f32_16x16x32_bf16 v[188:191], a[244:247], v[20:23], v[188:191]
v_exp_f32 v183, v183
v_mfma_f32_16x16x32_bf16 v[188:191], a[248:251], v[24:27], v[188:191]
v_cvt_pk_bf16_f32 v195, v182, v183
v_add_f32 v10, v10, v183
v_mfma_f32_16x16x32_bf16 v[188:191], a[252:255], v[28:31], v[188:191]
v_exp_f32 v184, v184
v_mfma_f32_16x16x32_bf16 a[0:3], a[128:131], v[192:195], 0
v_add_f32 v10, v10, v184
v_mfma_f32_16x16x32_bf16 a[4:7], a[132:135], v[192:195], 0
v_exp_f32 v185, v185
v_mfma_f32_16x16x32_bf16 a[8:11], a[136:139], v[192:195], 0
v_cvt_pk_bf16_f32 v196, v184, v185
v_add_f32 v10, v10, v185
v_mfma_f32_16x16x32_bf16 a[12:15], a[140:143], v[192:195], 0
v_exp_f32 v186, v186
v_mfma_f32_16x16x32_bf16 a[16:19], a[144:147], v[192:195], 0
v_add_f32 v10, v10, v186
v_mfma_f32_16x16x32_bf16 a[20:23], a[148:151], v[192:195], 0
v_exp_f32 v187, v187
v_mfma_f32_16x16x32_bf16 a[24:27], a[152:155], v[192:195], 0
v_cvt_pk_bf16_f32 v197, v186, v187
v_add_f32 v10, v10, v187
v_mfma_f32_16x16x32_bf16 a[28:31], a[156:159], v[192:195], 0
v_exp_f32 v188, v188
s_barrier
s_waitcnt vmcnt(4)
ds_read_b128 v[32:35], v8 offset:4096
ds_read_b128 v[36:39], v8 offset:4352
ds_read_b128 v[40:43], v8 offset:4608
ds_read_b128 v[44:47], v8 offset:4864
s_add_u32 m0, s46, 12288
s_add_u32 s32, s27, 12288
buffer_load_dwordx4 v3, s[4:7], s32 offen offset:0 nt lds
buffer_load_dwordx4 v3, s[4:7], s32 offen offset:1024 nt lds
buffer_load_dwordx4 v4, s[4:7], s32 offen offset:2048 nt lds
buffer_load_dwordx4 v4, s[4:7], s32 offen offset:3072 nt lds
s_waitcnt lgkmcnt(0)
v_lshlrev_b32 v220, 16, v32
v_and_b32 v221, s31, v32
v_lshlrev_b32 v222, 16, v33
v_and_b32 v223, s31, v33
v_pk_mul_f32 v[220:221], v[220:221], s[38:39]
v_pk_mul_f32 v[222:223], v[222:223], s[38:39]
v_cvt_pk_bf16_f32 v32, v220, v221
v_cvt_pk_bf16_f32 v33, v222, v223
v_lshlrev_b32 v224, 16, v34
v_and_b32 v225, s31, v34
v_lshlrev_b32 v226, 16, v35
v_and_b32 v227, s31, v35
v_pk_mul_f32 v[224:225], v[224:225], s[38:39]
v_pk_mul_f32 v[226:227], v[226:227], s[38:39]
v_cvt_pk_bf16_f32 v34, v224, v225
v_cvt_pk_bf16_f32 v35, v226, v227
v_lshlrev_b32 v220, 16, v36
v_and_b32 v221, s31, v36
v_lshlrev_b32 v222, 16, v37
v_and_b32 v223, s31, v37
v_pk_mul_f32 v[220:221], v[220:221], s[38:39]
v_pk_mul_f32 v[222:223], v[222:223], s[38:39]
v_cvt_pk_bf16_f32 v36, v220, v221
v_cvt_pk_bf16_f32 v37, v222, v223
v_lshlrev_b32 v224, 16, v38
v_and_b32 v225, s31, v38
v_lshlrev_b32 v226, 16, v39
v_and_b32 v227, s31, v39
v_pk_mul_f32 v[224:225], v[224:225], s[38:39]
v_pk_mul_f32 v[226:227], v[226:227], s[38:39]
v_cvt_pk_bf16_f32 v38, v224, v225
v_cvt_pk_bf16_f32 v39, v226, v227
v_lshlrev_b32 v220, 16, v40
v_and_b32 v221, s31, v40
v_lshlrev_b32 v222, 16, v41
v_and_b32 v223, s31, v41
v_pk_mul_f32 v[220:221], v[220:221], s[38:39]
v_pk_mul_f32 v[222:223], v[222:223], s[38:39]
v_cvt_pk_bf16_f32 v40, v220, v221
v_cvt_pk_bf16_f32 v41, v222, v223
v_lshlrev_b32 v224, 16, v42
v_and_b32 v225, s31, v42
v_lshlrev_b32 v226, 16, v43
v_and_b32 v227, s31, v43
v_pk_mul_f32 v[224:225], v[224:225], s[38:39]
v_pk_mul_f32 v[226:227], v[226:227], s[38:39]
v_cvt_pk_bf16_f32 v42, v224, v225
v_cvt_pk_bf16_f32 v43, v226, v227
v_lshlrev_b32 v220, 16, v44
v_and_b32 v221, s31, v44
v_lshlrev_b32 v222, 16, v45
v_and_b32 v223, s31, v45
v_pk_mul_f32 v[220:221], v[220:221], s[38:39]
v_pk_mul_f32 v[222:223], v[222:223], s[38:39]
v_cvt_pk_bf16_f32 v44, v220, v221
v_cvt_pk_bf16_f32 v45, v222, v223
v_lshlrev_b32 v224, 16, v46
v_and_b32 v225, s31, v46
v_lshlrev_b32 v226, 16, v47
v_and_b32 v227, s31, v47
v_pk_mul_f32 v[224:225], v[224:225], s[38:39]
v_pk_mul_f32 v[226:227], v[226:227], s[38:39]
v_cvt_pk_bf16_f32 v46, v224, v225
v_cvt_pk_bf16_f32 v47, v226, v227
v_mov_b32 v11, 0
s_nop 0
v_mfma_f32_16x16x32_bf16 v[176:179], a[192:195], v[32:35], -4.0
v_add_f32 v10, v10, v188
v_mfma_f32_16x16x32_bf16 v[176:179], a[196:199], v[36:39], v[176:179]
v_exp_f32 v189, v189
v_mfma_f32_16x16x32_bf16 v[176:179], a[200:203], v[40:43], v[176:179]
v_cvt_pk_bf16_f32 v198, v188, v189
v_add_f32 v10, v10, v189
v_mfma_f32_16x16x32_bf16 v[176:179], a[204:207], v[44:47], v[176:179]
v_exp_f32 v190, v190
v_mfma_f32_16x16x32_bf16 v[180:183], a[208:211], v[32:35], -4.0
v_add_f32 v10, v10, v190
v_mfma_f32_16x16x32_bf16 v[180:183], a[212:215], v[36:39], v[180:183]
v_exp_f32 v191, v191
v_mfma_f32_16x16x32_bf16 v[180:183], a[216:219], v[40:43], v[180:183]
v_cvt_pk_bf16_f32 v199, v190, v191
v_add_f32 v10, v10, v191
v_mfma_f32_16x16x32_bf16 v[180:183], a[220:223], v[44:47], v[180:183]
v_exp_f32 v176, v176
v_mfma_f32_16x16x32_bf16 a[0:3], a[160:163], v[196:199], a[0:3]
v_add_f32 v11, v11, v176
v_mfma_f32_16x16x32_bf16 a[4:7], a[164:167], v[196:199], a[4:7]
v_exp_f32 v177, v177
v_mfma_f32_16x16x32_bf16 a[8:11], a[168:171], v[196:199], a[8:11]
v_cvt_pk_bf16_f32 v192, v176, v177
v_add_f32 v11, v11, v177
v_mfma_f32_16x16x32_bf16 a[12:15], a[172:175], v[196:199], a[12:15]
v_exp_f32 v178, v178
v_mfma_f32_16x16x32_bf16 a[16:19], a[176:179], v[196:199], a[16:19]
v_add_f32 v11, v11, v178
v_mfma_f32_16x16x32_bf16 a[20:23], a[180:183], v[196:199], a[20:23]
v_exp_f32 v179, v179
v_mfma_f32_16x16x32_bf16 a[24:27], a[184:187], v[196:199], a[24:27]
v_cvt_pk_bf16_f32 v193, v178, v179
v_add_f32 v11, v11, v179
v_mfma_f32_16x16x32_bf16 a[28:31], a[188:191], v[196:199], a[28:31]
v_exp_f32 v180, v180
v_mfma_f32_16x16x32_bf16 v[184:187], a[224:227], v[32:35], -4.0
v_add_f32 v11, v11, v180
v_mfma_f32_16x16x32_bf16 v[184:187], a[228:231], v[36:39], v[184:187]
v_exp_f32 v181, v181
v_mfma_f32_16x16x32_bf16 v[184:187], a[232:235], v[40:43], v[184:187]
v_cvt_pk_bf16_f32 v194, v180, v181
v_add_f32 v11, v11, v181
v_mfma_f32_16x16x32_bf16 v[184:187], a[236:239], v[44:47], v[184:187]
v_exp_f32 v182, v182
v_mfma_f32_16x16x32_bf16 v[188:191], a[240:243], v[32:35], -4.0
v_add_f32 v11, v11, v182
v_mfma_f32_16x16x32_bf16 v[188:191], a[244:247], v[36:39], v[188:191]
v_exp_f32 v183, v183
v_mfma_f32_16x16x32_bf16 v[188:191], a[248:251], v[40:43], v[188:191]
v_cvt_pk_bf16_f32 v195, v182, v183
v_add_f32 v11, v11, v183
v_mfma_f32_16x16x32_bf16 v[188:191], a[252:255], v[44:47], v[188:191]
v_exp_f32 v184, v184
v_mfma_f32_16x16x32_bf16 a[32:35], a[128:131], v[192:195], 0
v_add_f32 v11, v11, v184
v_mfma_f32_16x16x32_bf16 a[36:39], a[132:135], v[192:195], 0
v_exp_f32 v185, v185
v_mfma_f32_16x16x32_bf16 a[40:43], a[136:139], v[192:195], 0
v_cvt_pk_bf16_f32 v196, v184, v185
v_add_f32 v11, v11, v185
v_mfma_f32_16x16x32_bf16 a[44:47], a[140:143], v[192:195], 0
v_exp_f32 v186, v186
v_mfma_f32_16x16x32_bf16 a[48:51], a[144:147], v[192:195], 0
v_add_f32 v11, v11, v186
v_mfma_f32_16x16x32_bf16 a[52:55], a[148:151], v[192:195], 0
v_exp_f32 v187, v187
v_mfma_f32_16x16x32_bf16 a[56:59], a[152:155], v[192:195], 0
v_cvt_pk_bf16_f32 v197, v186, v187
v_add_f32 v11, v11, v187
v_mfma_f32_16x16x32_bf16 a[60:63], a[156:159], v[192:195], 0
v_exp_f32 v188, v188
s_waitcnt vmcnt(4)
ds_read_b128 v[48:51], v8 offset:8192
ds_read_b128 v[52:55], v8 offset:8448
ds_read_b128 v[56:59], v8 offset:8704
ds_read_b128 v[60:63], v8 offset:8960
s_add_u32 m0, s46, 16384
s_add_u32 s32, s27, 16384
buffer_load_dwordx4 v3, s[4:7], s32 offen offset:0 nt lds
buffer_load_dwordx4 v3, s[4:7], s32 offen offset:1024 nt lds
buffer_load_dwordx4 v4, s[4:7], s32 offen offset:2048 nt lds
buffer_load_dwordx4 v4, s[4:7], s32 offen offset:3072 nt lds
s_waitcnt lgkmcnt(0)
v_lshlrev_b32 v220, 16, v48
v_and_b32 v221, s31, v48
v_lshlrev_b32 v222, 16, v49
v_and_b32 v223, s31, v49
v_pk_mul_f32 v[220:221], v[220:221], s[38:39]
v_pk_mul_f32 v[222:223], v[222:223], s[38:39]
v_cvt_pk_bf16_f32 v48, v220, v221
v_cvt_pk_bf16_f32 v49, v222, v223
v_lshlrev_b32 v224, 16, v50
v_and_b32 v225, s31, v50
v_lshlrev_b32 v226, 16, v51
v_and_b32 v227, s31, v51
v_pk_mul_f32 v[224:225], v[224:225], s[38:39]
v_pk_mul_f32 v[226:227], v[226:227], s[38:39]
v_cvt_pk_bf16_f32 v50, v224, v225
v_cvt_pk_bf16_f32 v51, v226, v227
v_lshlrev_b32 v220, 16, v52
v_and_b32 v221, s31, v52
v_lshlrev_b32 v222, 16, v53
v_and_b32 v223, s31, v53
v_pk_mul_f32 v[220:221], v[220:221], s[38:39]
v_pk_mul_f32 v[222:223], v[222:223], s[38:39]
v_cvt_pk_bf16_f32 v52, v220, v221
v_cvt_pk_bf16_f32 v53, v222, v223
v_lshlrev_b32 v224, 16, v54
v_and_b32 v225, s31, v54
v_lshlrev_b32 v226, 16, v55
v_and_b32 v227, s31, v55
v_pk_mul_f32 v[224:225], v[224:225], s[38:39]
v_pk_mul_f32 v[226:227], v[226:227], s[38:39]
v_cvt_pk_bf16_f32 v54, v224, v225
v_cvt_pk_bf16_f32 v55, v226, v227
v_lshlrev_b32 v220, 16, v56
v_and_b32 v221, s31, v56
v_lshlrev_b32 v222, 16, v57
v_and_b32 v223, s31, v57
v_pk_mul_f32 v[220:221], v[220:221], s[38:39]
v_pk_mul_f32 v[222:223], v[222:223], s[38:39]
v_cvt_pk_bf16_f32 v56, v220, v221
v_cvt_pk_bf16_f32 v57, v222, v223
v_lshlrev_b32 v224, 16, v58
v_and_b32 v225, s31, v58
v_lshlrev_b32 v226, 16, v59
v_and_b32 v227, s31, v59
v_pk_mul_f32 v[224:225], v[224:225], s[38:39]
v_pk_mul_f32 v[226:227], v[226:227], s[38:39]
v_cvt_pk_bf16_f32 v58, v224, v225
v_cvt_pk_bf16_f32 v59, v226, v227
v_lshlrev_b32 v220, 16, v60
v_and_b32 v221, s31, v60
v_lshlrev_b32 v222, 16, v61
v_and_b32 v223, s31, v61
v_pk_mul_f32 v[220:221], v[220:221], s[38:39]
v_pk_mul_f32 v[222:223], v[222:223], s[38:39]
v_cvt_pk_bf16_f32 v60, v220, v221
v_cvt_pk_bf16_f32 v61, v222, v223
v_lshlrev_b32 v224, 16, v62
v_and_b32 v225, s31, v62
v_lshlrev_b32 v226, 16, v63
v_and_b32 v227, s31, v63
v_pk_mul_f32 v[224:225], v[224:225], s[38:39]
v_pk_mul_f32 v[226:227], v[226:227], s[38:39]
v_cvt_pk_bf16_f32 v62, v224, v225
v_cvt_pk_bf16_f32 v63, v226, v227
v_mov_b32 v12, 0
s_nop 0
v_mfma_f32_16x16x32_bf16 v[176:179], a[192:195], v[48:51], -4.0
v_add_f32 v11, v11, v188
v_mfma_f32_16x16x32_bf16 v[176:179], a[196:199], v[52:55], v[176:179]
v_exp_f32 v189, v189
v_mfma_f32_16x16x32_bf16 v[176:179], a[200:203], v[56:59], v[176:179]
v_cvt_pk_bf16_f32 v198, v188, v189
v_add_f32 v11, v11, v189
v_mfma_f32_16x16x32_bf16 v[176:179], a[204:207], v[60:63], v[176:179]
v_exp_f32 v190, v190
v_mfma_f32_16x16x32_bf16 v[180:183], a[208:211], v[48:51], -4.0
v_add_f32 v11, v11, v190
v_mfma_f32_16x16x32_bf16 v[180:183], a[212:215], v[52:55], v[180:183]
v_exp_f32 v191, v191
v_mfma_f32_16x16x32_bf16 v[180:183], a[216:219], v[56:59], v[180:183]
v_cvt_pk_bf16_f32 v199, v190, v191
v_add_f32 v11, v11, v191
v_mfma_f32_16x16x32_bf16 v[180:183], a[220:223], v[60:63], v[180:183]
v_exp_f32 v176, v176
v_mfma_f32_16x16x32_bf16 a[32:35], a[160:163], v[196:199], a[32:35]
v_add_f32 v12, v12, v176
v_mfma_f32_16x16x32_bf16 a[36:39], a[164:167], v[196:199], a[36:39]
v_exp_f32 v177, v177
v_mfma_f32_16x16x32_bf16 a[40:43], a[168:171], v[196:199], a[40:43]
v_cvt_pk_bf16_f32 v192, v176, v177
v_add_f32 v12, v12, v177
v_mfma_f32_16x16x32_bf16 a[44:47], a[172:175], v[196:199], a[44:47]
v_exp_f32 v178, v178
v_mfma_f32_16x16x32_bf16 a[48:51], a[176:179], v[196:199], a[48:51]
v_add_f32 v12, v12, v178
v_mfma_f32_16x16x32_bf16 a[52:55], a[180:183], v[196:199], a[52:55]
v_exp_f32 v179, v179
v_mfma_f32_16x16x32_bf16 a[56:59], a[184:187], v[196:199], a[56:59]
v_cvt_pk_bf16_f32 v193, v178, v179
v_add_f32 v12, v12, v179
v_mfma_f32_16x16x32_bf16 a[60:63], a[188:191], v[196:199], a[60:63]
v_exp_f32 v180, v180
v_mfma_f32_16x16x32_bf16 v[184:187], a[224:227], v[48:51], -4.0
v_add_f32 v12, v12, v180
v_mfma_f32_16x16x32_bf16 v[184:187], a[228:231], v[52:55], v[184:187]
v_exp_f32 v181, v181
v_mfma_f32_16x16x32_bf16 v[184:187], a[232:235], v[56:59], v[184:187]
v_cvt_pk_bf16_f32 v194, v180, v181
v_add_f32 v12, v12, v181
v_mfma_f32_16x16x32_bf16 v[184:187], a[236:239], v[60:63], v[184:187]
v_exp_f32 v182, v182
v_mfma_f32_16x16x32_bf16 v[188:191], a[240:243], v[48:51], -4.0
v_add_f32 v12, v12, v182
v_mfma_f32_16x16x32_bf16 v[188:191], a[244:247], v[52:55], v[188:191]
v_exp_f32 v183, v183
v_mfma_f32_16x16x32_bf16 v[188:191], a[248:251], v[56:59], v[188:191]
v_cvt_pk_bf16_f32 v195, v182, v183
v_add_f32 v12, v12, v183
v_mfma_f32_16x16x32_bf16 v[188:191], a[252:255], v[60:63], v[188:191]
v_exp_f32 v184, v184
v_mfma_f32_16x16x32_bf16 a[64:67], a[128:131], v[192:195], 0
v_add_f32 v12, v12, v184
v_mfma_f32_16x16x32_bf16 a[68:71], a[132:135], v[192:195], 0
v_exp_f32 v185, v185
v_mfma_f32_16x16x32_bf16 a[72:75], a[136:139], v[192:195], 0
v_cvt_pk_bf16_f32 v196, v184, v185
v_add_f32 v12, v12, v185
v_mfma_f32_16x16x32_bf16 a[76:79], a[140:143], v[192:195], 0
v_exp_f32 v186, v186
v_mfma_f32_16x16x32_bf16 a[80:83], a[144:147], v[192:195], 0
v_add_f32 v12, v12, v186
v_mfma_f32_16x16x32_bf16 a[84:87], a[148:151], v[192:195], 0
v_exp_f32 v187, v187
v_mfma_f32_16x16x32_bf16 a[88:91], a[152:155], v[192:195], 0
v_cvt_pk_bf16_f32 v197, v186, v187
v_add_f32 v12, v12, v187
v_mfma_f32_16x16x32_bf16 a[92:95], a[156:159], v[192:195], 0
v_exp_f32 v188, v188
s_waitcnt vmcnt(4)
ds_read_b128 v[64:67], v8 offset:12288
ds_read_b128 v[68:71], v8 offset:12544
ds_read_b128 v[72:75], v8 offset:12800
ds_read_b128 v[76:79], v8 offset:13056
s_mov_b32 m0, s22
s_nop 0
buffer_load_dwordx4 v232, s[8:11], s21 offen nt lds
buffer_load_dwordx4 v232, s[8:11], s21 offen offset:1024 nt lds
s_mov_b32 m0, s23
s_nop 0
buffer_load_dwordx4 v3, s[12:15], s21 offen nt lds
s_add_u32 m0, s23, 8
s_nop 0
buffer_load_dwordx4 v3, s[12:15], s21 offen offset:1024 nt lds
s_add_u32 s22, s22, 8192
s_and_b32 s22, s22, 0x7fff
s_add_u32 s21, s21, 8192
s_add_u32 s23, s23, 8256
s_cmp_eq_u32 s23, s35
s_cselect_b32 s23, s34, s23
s_waitcnt lgkmcnt(0)
v_lshlrev_b32 v220, 16, v64
v_and_b32 v221, s31, v64
v_lshlrev_b32 v222, 16, v65
v_and_b32 v223, s31, v65
v_pk_mul_f32 v[220:221], v[220:221], s[38:39]
v_pk_mul_f32 v[222:223], v[222:223], s[38:39]
v_cvt_pk_bf16_f32 v64, v220, v221
v_cvt_pk_bf16_f32 v65, v222, v223
v_lshlrev_b32 v224, 16, v66
v_and_b32 v225, s31, v66
v_lshlrev_b32 v226, 16, v67
v_and_b32 v227, s31, v67
v_pk_mul_f32 v[224:225], v[224:225], s[38:39]
v_pk_mul_f32 v[226:227], v[226:227], s[38:39]
v_cvt_pk_bf16_f32 v66, v224, v225
v_cvt_pk_bf16_f32 v67, v226, v227
v_lshlrev_b32 v220, 16, v68
v_and_b32 v221, s31, v68
v_lshlrev_b32 v222, 16, v69
v_and_b32 v223, s31, v69
v_pk_mul_f32 v[220:221], v[220:221], s[38:39]
v_pk_mul_f32 v[222:223], v[222:223], s[38:39]
v_cvt_pk_bf16_f32 v68, v220, v221
v_cvt_pk_bf16_f32 v69, v222, v223
v_lshlrev_b32 v224, 16, v70
v_and_b32 v225, s31, v70
v_lshlrev_b32 v226, 16, v71
v_and_b32 v227, s31, v71
v_pk_mul_f32 v[224:225], v[224:225], s[38:39]
v_pk_mul_f32 v[226:227], v[226:227], s[38:39]
v_cvt_pk_bf16_f32 v70, v224, v225
v_cvt_pk_bf16_f32 v71, v226, v227
v_lshlrev_b32 v220, 16, v72
v_and_b32 v221, s31, v72
v_lshlrev_b32 v222, 16, v73
v_and_b32 v223, s31, v73
v_pk_mul_f32 v[220:221], v[220:221], s[38:39]
v_pk_mul_f32 v[222:223], v[222:223], s[38:39]
v_cvt_pk_bf16_f32 v72, v220, v221
v_cvt_pk_bf16_f32 v73, v222, v223
v_lshlrev_b32 v224, 16, v74
v_and_b32 v225, s31, v74
v_lshlrev_b32 v226, 16, v75
v_and_b32 v227, s31, v75
v_pk_mul_f32 v[224:225], v[224:225], s[38:39]
v_pk_mul_f32 v[226:227], v[226:227], s[38:39]
v_cvt_pk_bf16_f32 v74, v224, v225
v_cvt_pk_bf16_f32 v75, v226, v227
v_lshlrev_b32 v220, 16, v76
v_and_b32 v221, s31, v76
v_lshlrev_b32 v222, 16, v77
v_and_b32 v223, s31, v77
v_pk_mul_f32 v[220:221], v[220:221], s[38:39]
v_pk_mul_f32 v[222:223], v[222:223], s[38:39]
v_cvt_pk_bf16_f32 v76, v220, v221
v_cvt_pk_bf16_f32 v77, v222, v223
v_lshlrev_b32 v224, 16, v78
v_and_b32 v225, s31, v78
v_lshlrev_b32 v226, 16, v79
v_and_b32 v227, s31, v79
v_pk_mul_f32 v[224:225], v[224:225], s[38:39]
v_pk_mul_f32 v[226:227], v[226:227], s[38:39]
v_cvt_pk_bf16_f32 v78, v224, v225
v_cvt_pk_bf16_f32 v79, v226, v227
v_mov_b32 v13, 0
s_nop 0
v_mfma_f32_16x16x32_bf16 v[176:179], a[192:195], v[64:67], -4.0
v_add_f32 v12, v12, v188
v_mfma_f32_16x16x32_bf16 v[176:179], a[196:199], v[68:71], v[176:179]
v_exp_f32 v189, v189
v_mfma_f32_16x16x32_bf16 v[176:179], a[200:203], v[72:75], v[176:179]
v_cvt_pk_bf16_f32 v198, v188, v189
v_add_f32 v12, v12, v189
v_mfma_f32_16x16x32_bf16 v[176:179], a[204:207], v[76:79], v[176:179]
v_exp_f32 v190, v190
v_mfma_f32_16x16x32_bf16 v[180:183], a[208:211], v[64:67], -4.0
v_add_f32 v12, v12, v190
v_mfma_f32_16x16x32_bf16 v[180:183], a[212:215], v[68:71], v[180:183]
v_exp_f32 v191, v191
v_mfma_f32_16x16x32_bf16 v[180:183], a[216:219], v[72:75], v[180:183]
v_cvt_pk_bf16_f32 v199, v190, v191
v_add_f32 v12, v12, v191
v_mfma_f32_16x16x32_bf16 v[180:183], a[220:223], v[76:79], v[180:183]
v_exp_f32 v176, v176
v_mfma_f32_16x16x32_bf16 a[64:67], a[160:163], v[196:199], a[64:67]
v_add_f32 v13, v13, v176
v_mfma_f32_16x16x32_bf16 a[68:71], a[164:167], v[196:199], a[68:71]
v_exp_f32 v177, v177
v_mfma_f32_16x16x32_bf16 a[72:75], a[168:171], v[196:199], a[72:75]
v_cvt_pk_bf16_f32 v192, v176, v177
v_add_f32 v13, v13, v177
v_mfma_f32_16x16x32_bf16 a[76:79], a[172:175], v[196:199], a[76:79]
v_exp_f32 v178, v178
v_mfma_f32_16x16x32_bf16 a[80:83], a[176:179], v[196:199], a[80:83]
v_add_f32 v13, v13, v178
v_mfma_f32_16x16x32_bf16 a[84:87], a[180:183], v[196:199], a[84:87]
v_exp_f32 v179, v179
v_mfma_f32_16x16x32_bf16 a[88:91], a[184:187], v[196:199], a[88:91]
v_cvt_pk_bf16_f32 v193, v178, v179
v_add_f32 v13, v13, v179
v_mfma_f32_16x16x32_bf16 a[92:95], a[188:191], v[196:199], a[92:95]
v_exp_f32 v180, v180
v_mfma_f32_16x16x32_bf16 v[184:187], a[224:227], v[64:67], -4.0
v_add_f32 v13, v13, v180
v_xor_b32 v1, 0x4000, v1
v_mfma_f32_16x16x32_bf16 v[184:187], a[228:231], v[68:71], v[184:187]
v_exp_f32 v181, v181
v_mfma_f32_16x16x32_bf16 v[184:187], a[232:235], v[72:75], v[184:187]
v_cvt_pk_bf16_f32 v194, v180, v181
v_add_f32 v13, v13, v181
v_mfma_f32_16x16x32_bf16 v[184:187], a[236:239], v[76:79], v[184:187]
v_exp_f32 v182, v182
v_mfma_f32_16x16x32_bf16 v[188:191], a[240:243], v[64:67], -4.0
v_add_f32 v13, v13, v182
v_add_u32 v2, s30, v2
v_mfma_f32_16x16x32_bf16 v[188:191], a[244:247], v[68:71], v[188:191]
s_sub_u32 s30, 0, s30
v_exp_f32 v183, v183
v_mfma_f32_16x16x32_bf16 v[188:191], a[248:251], v[72:75], v[188:191]
v_cvt_pk_bf16_f32 v195, v182, v183
v_add_f32 v13, v13, v183
v_mfma_f32_16x16x32_bf16 v[188:191], a[252:255], v[76:79], v[188:191]
v_exp_f32 v184, v184
v_mfma_f32_16x16x32_bf16 v[112:115], a[128:131], v[192:195], 0
v_add_f32 v13, v13, v184
v_mfma_f32_16x16x32_bf16 v[116:119], a[132:135], v[192:195], 0
v_exp_f32 v185, v185
v_mfma_f32_16x16x32_bf16 v[120:123], a[136:139], v[192:195], 0
v_cvt_pk_bf16_f32 v196, v184, v185
v_add_f32 v13, v13, v185
v_mfma_f32_16x16x32_bf16 v[124:127], a[140:143], v[192:195], 0
v_exp_f32 v186, v186
v_mfma_f32_16x16x32_bf16 v[128:131], a[144:147], v[192:195], 0
v_add_f32 v13, v13, v186
v_mfma_f32_16x16x32_bf16 v[132:135], a[148:151], v[192:195], 0
v_exp_f32 v187, v187
v_mfma_f32_16x16x32_bf16 v[136:139], a[152:155], v[192:195], 0
v_cvt_pk_bf16_f32 v197, v186, v187
v_add_f32 v13, v13, v187
v_mfma_f32_16x16x32_bf16 v[140:143], a[156:159], v[192:195], 0
v_exp_f32 v188, v188
s_waitcnt vmcnt(4)
ds_read_b128 v[80:83], v8 offset:16384
ds_read_b128 v[84:87], v8 offset:16640
ds_read_b128 v[88:91], v8 offset:16896
ds_read_b128 v[92:95], v8 offset:17152
s_mov_b32 m0, s22
s_nop 0
buffer_load_dwordx4 v232, s[8:11], s21 offen nt lds
buffer_load_dwordx4 v232, s[8:11], s21 offen offset:1024 nt lds
s_mov_b32 m0, s23
s_nop 0
buffer_load_dwordx4 v3, s[12:15], s21 offen nt lds
s_add_u32 m0, s23, 8
s_nop 0
buffer_load_dwordx4 v3, s[12:15], s21 offen offset:1024 nt lds
s_add_u32 s22, s22, 8192
s_and_b32 s22, s22, 0x7fff
s_add_u32 s21, s21, 8192
s_add_u32 s23, s23, 8256
s_cmp_eq_u32 s23, s35
s_cselect_b32 s23, s34, s23
s_lshl_b32 s32, s20, 11
s_sub_u32 s21, s21, s32
s_sub_u32 s22, s22, s32
s_mov_b32 s34, 32768
s_mov_b32 s35, 65792
s_mov_b32 s23, 32768
s_waitcnt lgkmcnt(0)
v_lshlrev_b32 v220, 16, v80
v_and_b32 v221, s31, v80
v_lshlrev_b32 v222, 16, v81
v_and_b32 v223, s31, v81
v_pk_mul_f32 v[220:221], v[220:221], s[38:39]
v_pk_mul_f32 v[222:223], v[222:223], s[38:39]
v_cvt_pk_bf16_f32 v80, v220, v221
v_cvt_pk_bf16_f32 v81, v222, v223
v_lshlrev_b32 v224, 16, v82
v_and_b32 v225, s31, v82
v_lshlrev_b32 v226, 16, v83
v_and_b32 v227, s31, v83
v_pk_mul_f32 v[224:225], v[224:225], s[38:39]
v_pk_mul_f32 v[226:227], v[226:227], s[38:39]
v_cvt_pk_bf16_f32 v82, v224, v225
v_cvt_pk_bf16_f32 v83, v226, v227
v_lshlrev_b32 v220, 16, v84
v_and_b32 v221, s31, v84
v_lshlrev_b32 v222, 16, v85
v_and_b32 v223, s31, v85
v_pk_mul_f32 v[220:221], v[220:221], s[38:39]
v_pk_mul_f32 v[222:223], v[222:223], s[38:39]
v_cvt_pk_bf16_f32 v84, v220, v221
v_cvt_pk_bf16_f32 v85, v222, v223
v_lshlrev_b32 v224, 16, v86
v_and_b32 v225, s31, v86
v_lshlrev_b32 v226, 16, v87
v_and_b32 v227, s31, v87
v_pk_mul_f32 v[224:225], v[224:225], s[38:39]
v_pk_mul_f32 v[226:227], v[226:227], s[38:39]
v_cvt_pk_bf16_f32 v86, v224, v225
v_cvt_pk_bf16_f32 v87, v226, v227
v_lshlrev_b32 v220, 16, v88
v_and_b32 v221, s31, v88
v_lshlrev_b32 v222, 16, v89
v_and_b32 v223, s31, v89
v_pk_mul_f32 v[220:221], v[220:221], s[38:39]
v_pk_mul_f32 v[222:223], v[222:223], s[38:39]
v_cvt_pk_bf16_f32 v88, v220, v221
v_cvt_pk_bf16_f32 v89, v222, v223
v_lshlrev_b32 v224, 16, v90
L_pad8:
s_cbranch_execz L_pad12
v_and_b32 v225, s31, v90
v_lshlrev_b32 v226, 16, v91
v_and_b32 v227, s31, v91
v_pk_mul_f32 v[224:225], v[224:225], s[38:39]
v_pk_mul_f32 v[226:227], v[226:227], s[38:39]
v_cvt_pk_bf16_f32 v90, v224, v225
v_cvt_pk_bf16_f32 v91, v226, v227
v_lshlrev_b32 v220, 16, v92
v_and_b32 v221, s31, v92
v_lshlrev_b32 v222, 16, v93
v_and_b32 v223, s31, v93
v_pk_mul_f32 v[220:221], v[220:221], s[38:39]
v_pk_mul_f32 v[222:223], v[222:223], s[38:39]
v_cvt_pk_bf16_f32 v92, v220, v221
v_cvt_pk_bf16_f32 v93, v222, v223
v_lshlrev_b32 v224, 16, v94
v_and_b32 v225, s31, v94
v_lshlrev_b32 v226, 16, v95
v_and_b32 v227, s31, v95
v_pk_mul_f32 v[224:225], v[224:225], s[38:39]
v_pk_mul_f32 v[226:227], v[226:227], s[38:39]
v_cvt_pk_bf16_f32 v94, v224, v225
v_cvt_pk_bf16_f32 v95, v226, v227
v_mov_b32 v14, 0
s_nop 0
s_mov_b32 m0, s22
s_add_u32 s24, s21, 4096
buffer_load_dwordx4 v3, s[8:11], s21 offen offset:0 nt lds
buffer_load_dwordx4 v3, s[8:11], s21 offen offset:1024 nt lds
buffer_load_dwordx4 v4, s[8:11], s21 offen offset:2048 nt lds
buffer_load_dwordx4 v4, s[8:11], s21 offen offset:3072 nt lds
s_add_u32 m0, s22, 4096
s_nop 0
buffer_load_dwordx4 v3, s[8:11], s24 offen offset:0 nt lds
buffer_load_dwordx4 v3, s[8:11], s24 offen offset:1024 nt lds
buffer_load_dwordx4 v4, s[8:11], s24 offen offset:2048 nt lds
buffer_load_dwordx4 v4, s[8:11], s24 offen offset:3072 nt lds
s_add_u32 m0, s23, 0
s_nop 0
buffer_load_dwordx4 v3, s[12:15], s21 offen offset:0 nt lds
s_add_u32 m0, s23, 8
s_nop 0
buffer_load_dwordx4 v3, s[12:15], s21 offen offset:1024 nt lds
s_add_u32 m0, s23, 16
s_nop 0
buffer_load_dwordx4 v3, s[12:15], s21 offen offset:2048 nt lds
s_add_u32 m0, s23, 24
s_nop 0
buffer_load_dwordx4 v3, s[12:15], s21 offen offset:3072 nt lds
s_add_u32 m0, s23, 4128
s_nop 0
buffer_load_dwordx4 v3, s[12:15], s24 offen offset:0 nt lds
s_add_u32 m0, s23, 4136
s_nop 0
buffer_load_dwordx4 v3, s[12:15], s24 offen offset:1024 nt lds
s_add_u32 m0, s23, 4144
s_nop 0
buffer_load_dwordx4 v3, s[12:15], s24 offen offset:2048 nt lds
s_add_u32 m0, s23, 4152
s_nop 0
buffer_load_dwordx4 v3, s[12:15], s24 offen offset:3072 nt lds
s_add_u32 s22, s22, 8192
s_and_b32 s22, s22, 0x7fff
s_add_u32 s21, s21, 8192
s_add_u32 s23, s23, 8256
s_cmp_eq_u32 s23, s35
s_cselect_b32 s23, s34, s23
s_mov_b32 m0, s22
s_add_u32 s24, s21, 4096
buffer_load_dwordx4 v3, s[8:11], s21 offen offset:0 nt lds
buffer_load_dwordx4 v3, s[8:11], s21 offen offset:1024 nt lds
buffer_load_dwordx4 v4, s[8:11], s21 offen offset:2048 nt lds
buffer_load_dwordx4 v4, s[8:11], s21 offen offset:3072 nt lds
s_add_u32 m0, s22, 4096
s_nop 0
buffer_load_dwordx4 v3, s[8:11], s24 offen offset:0 nt lds
buffer_load_dwordx4 v3, s[8:11], s24 offen offset:1024 nt lds
buffer_load_dwordx4 v4, s[8:11], s24 offen offset:2048 nt lds
buffer_load_dwordx4 v4, s[8:11], s24 offen offset:3072 nt lds
s_add_u32 m0, s23, 0
s_nop 0
buffer_load_dwordx4 v3, s[12:15], s21 offen offset:0 nt lds
s_add_u32 m0, s23, 8
s_nop 0
buffer_load_dwordx4 v3, s[12:15], s21 offen offset:1024 nt lds
s_add_u32 m0, s23, 16
s_nop 0
buffer_load_dwordx4 v3, s[12:15], s21 offen offset:2048 nt lds
s_add_u32 m0, s23, 24
s_nop 0
buffer_load_dwordx4 v3, s[12:15], s21 offen offset:3072 nt lds
s_add_u32 m0, s23, 4128
s_nop 0
buffer_load_dwordx4 v3, s[12:15], s24 offen offset:0 nt lds
s_add_u32 m0, s23, 4136
s_nop 0
buffer_load_dwordx4 v3, s[12:15], s24 offen offset:1024 nt lds
s_add_u32 m0, s23, 4144
s_nop 0
buffer_load_dwordx4 v3, s[12:15], s24 offen offset:2048 nt lds
s_add_u32 m0, s23, 4152
s_nop 0
buffer_load_dwordx4 v3, s[12:15], s24 offen offset:3072 nt lds
s_add_u32 s22, s22, 8192
s_and_b32 s22, s22, 0x7fff
s_add_u32 s21, s21, 8192
s_add_u32 s23, s23, 8256
s_cmp_eq_u32 s23, s35
s_cselect_b32 s23, s34, s23
v_mfma_f32_16x16x32_bf16 v[176:179], a[192:195], v[80:83], -4.0
v_add_f32 v13, v13, v188
v_mfma_f32_16x16x32_bf16 v[176:179], a[196:199], v[84:87], v[176:179]
v_exp_f32 v189, v189
v_mfma_f32_16x16x32_bf16 v[176:179], a[200:203], v[88:91], v[176:179]
v_cvt_pk_bf16_f32 v198, v188, v189
v_add_f32 v13, v13, v189
v_mfma_f32_16x16x32_bf16 v[176:179], a[204:207], v[92:95], v[176:179]
v_exp_f32 v190, v190
v_mfma_f32_16x16x32_bf16 v[180:183], a[208:211], v[80:83], -4.0
v_add_f32 v13, v13, v190
v_mfma_f32_16x16x32_bf16 v[180:183], a[212:215], v[84:87], v[180:183]
v_exp_f32 v191, v191
v_mfma_f32_16x16x32_bf16 v[180:183], a[216:219], v[88:91], v[180:183]
s_waitcnt vmcnt(36) lgkmcnt(0)
v_cvt_pk_bf16_f32 v199, v190, v191
v_add_f32 v13, v13, v191
v_mfma_f32_16x16x32_bf16 v[180:183], a[220:223], v[92:95], v[180:183]
s_barrier
v_exp_f32 v176, v176
v_mfma_f32_16x16x32_bf16 v[112:115], a[160:163], v[196:199], v[112:115]
ds_read_b128 a[192:195], v1 offset:0
v_add_f32 v14, v14, v176
v_mfma_f32_16x16x32_bf16 v[116:119], a[164:167], v[196:199], v[116:119]
v_exp_f32 v177, v177
v_mfma_f32_16x16x32_bf16 v[120:123], a[168:171], v[196:199], v[120:123]
v_cvt_pk_bf16_f32 v192, v176, v177
v_add_f32 v14, v14, v177
v_mfma_f32_16x16x32_bf16 v[124:127], a[172:175], v[196:199], v[124:127]
ds_read_b128 a[196:199], v1 offset:256
v_exp_f32 v178, v178
v_mfma_f32_16x16x32_bf16 v[128:131], a[176:179], v[196:199], v[128:131]
ds_read_b128 a[200:203], v1 offset:512
v_add_f32 v14, v14, v178
v_mfma_f32_16x16x32_bf16 v[132:135], a[180:183], v[196:199], v[132:135]
v_exp_f32 v179, v179
v_mfma_f32_16x16x32_bf16 v[136:139], a[184:187], v[196:199], v[136:139]
v_cvt_pk_bf16_f32 v193, v178, v179
v_add_f32 v14, v14, v179
v_mfma_f32_16x16x32_bf16 v[140:143], a[188:191], v[196:199], v[140:143]
v_exp_f32 v180, v180
v_mfma_f32_16x16x32_bf16 v[184:187], a[224:227], v[80:83], -4.0
ds_read_b128 a[204:207], v1 offset:768
v_add_f32 v14, v14, v180
v_mfma_f32_16x16x32_bf16 v[184:187], a[228:231], v[84:87], v[184:187]
v_exp_f32 v181, v181
v_mfma_f32_16x16x32_bf16 v[184:187], a[232:235], v[88:91], v[184:187]
ds_read_b128 a[208:211], v1 offset:4096
v_cvt_pk_bf16_f32 v194, v180, v181
v_add_f32 v14, v14, v181
v_mfma_f32_16x16x32_bf16 v[184:187], a[236:239], v[92:95], v[184:187]
v_exp_f32 v182, v182
v_mfma_f32_16x16x32_bf16 v[188:191], a[240:243], v[80:83], -4.0
ds_read_b128 a[212:215], v1 offset:4352
v_add_f32 v14, v14, v182
v_mfma_f32_16x16x32_bf16 v[188:191], a[244:247], v[84:87], v[188:191]
v_exp_f32 v183, v183
v_mfma_f32_16x16x32_bf16 v[188:191], a[248:251], v[88:91], v[188:191]
v_cvt_pk_bf16_f32 v195, v182, v183
v_add_f32 v14, v14, v183
v_mfma_f32_16x16x32_bf16 v[188:191], a[252:255], v[92:95], v[188:191]
v_exp_f32 v184, v184
v_mfma_f32_16x16x32_bf16 v[144:147], a[128:131], v[192:195], 0
ds_read_b128 a[216:219], v1 offset:4608
v_add_f32 v14, v14, v184
v_mfma_f32_16x16x32_bf16 v[148:151], a[132:135], v[192:195], 0
ds_read_b128 a[220:223], v1 offset:4864
v_exp_f32 v185, v185
v_mfma_f32_16x16x32_bf16 v[152:155], a[136:139], v[192:195], 0
v_cvt_pk_bf16_f32 v196, v184, v185
v_add_f32 v14, v14, v185
v_mfma_f32_16x16x32_bf16 v[156:159], a[140:143], v[192:195], 0
v_exp_f32 v186, v186
v_mfma_f32_16x16x32_bf16 v[160:163], a[144:147], v[192:195], 0
v_add_f32 v14, v14, v186
v_mfma_f32_16x16x32_bf16 v[164:167], a[148:151], v[192:195], 0
v_exp_f32 v187, v187
v_mfma_f32_16x16x32_bf16 v[168:171], a[152:155], v[192:195], 0
v_cvt_pk_bf16_f32 v197, v186, v187
v_add_f32 v14, v14, v187
v_mfma_f32_16x16x32_bf16 v[172:175], a[156:159], v[192:195], 0
s_waitcnt lgkmcnt(0)
v_exp_f32 v188, v188
v_mfma_f32_16x16x32_bf16 v[176:179], a[192:195], v[16:19], -4.0
ds_read_b64_tr_b16 a[128:129], v2 offset:0
v_add_f32 v14, v14, v188
v_mfma_f32_16x16x32_bf16 v[176:179], a[196:199], v[20:23], v[176:179]
ds_read_b64_tr_b16 a[130:131], v2 offset:4128
v_exp_f32 v189, v189
v_mfma_f32_16x16x32_bf16 v[176:179], a[200:203], v[24:27], v[176:179]
ds_read_b64_tr_b16 a[132:133], v2 offset:8
v_cvt_pk_bf16_f32 v198, v188, v189
v_add_f32 v14, v14, v189
v_mfma_f32_16x16x32_bf16 v[176:179], a[204:207], v[28:31], v[176:179]
ds_read_b64_tr_b16 a[134:135], v2 offset:4136
v_exp_f32 v190, v190
v_mfma_f32_16x16x32_bf16 v[180:183], a[208:211], v[16:19], -4.0
ds_read_b64_tr_b16 a[136:137], v2 offset:256
v_add_f32 v14, v14, v190
v_mfma_f32_16x16x32_bf16 v[180:183], a[212:215], v[20:23], v[180:183]
ds_read_b64_tr_b16 a[138:139], v2 offset:4384
v_exp_f32 v191, v191
v_mfma_f32_16x16x32_bf16 v[180:183], a[216:219], v[24:27], v[180:183]
ds_read_b64_tr_b16 a[140:141], v2 offset:264
v_cvt_pk_bf16_f32 v199, v190, v191
v_add_f32 v14, v14, v191
v_mfma_f32_16x16x32_bf16 v[180:183], a[220:223], v[28:31], v[180:183]
ds_read_b64_tr_b16 a[142:143], v2 offset:4392
v_exp_f32 v176, v176
v_mfma_f32_16x16x32_bf16 v[144:147], a[160:163], v[196:199], v[144:147]
ds_read_b64_tr_b16 a[144:145], v2 offset:512
v_mov_b32 v6, v176
v_mfma_f32_16x16x32_bf16 v[148:151], a[164:167], v[196:199], v[148:151]
ds_read_b64_tr_b16 a[146:147], v2 offset:4640
v_exp_f32 v177, v177
v_mfma_f32_16x16x32_bf16 v[152:155], a[168:171], v[196:199], v[152:155]
ds_read_b64_tr_b16 a[148:149], v2 offset:520
v_cvt_pk_bf16_f32 v192, v176, v177
v_add_f32 v6, v6, v177
v_mfma_f32_16x16x32_bf16 v[156:159], a[172:175], v[196:199], v[156:159]
ds_read_b64_tr_b16 a[150:151], v2 offset:4648
v_exp_f32 v178, v178
v_mfma_f32_16x16x32_bf16 v[160:163], a[176:179], v[196:199], v[160:163]
ds_read_b64_tr_b16 a[152:153], v2 offset:768
v_add_f32 v6, v6, v178
v_mfma_f32_16x16x32_bf16 v[164:167], a[180:183], v[196:199], v[164:167]
ds_read_b64_tr_b16 a[154:155], v2 offset:4896
v_exp_f32 v179, v179
v_mfma_f32_16x16x32_bf16 v[168:171], a[184:187], v[196:199], v[168:171]
ds_read_b64_tr_b16 a[156:157], v2 offset:776
v_cvt_pk_bf16_f32 v193, v178, v179
v_add_f32 v6, v6, v179
v_mfma_f32_16x16x32_bf16 v[172:175], a[188:191], v[196:199], v[172:175]
ds_read_b64_tr_b16 a[158:159], v2 offset:4904
v_exp_f32 v180, v180
s_mov_b32 s28, 0
.p2align 6
L_loopB:
v_mfma_f32_16x16x32_bf16 v[184:187], a[192:195], v[32:35], -4.0
v_add_f32 v10, v10, v180
v_add_f32 v10, v10, v6
v_mfma_f32_16x16x32_bf16 v[184:187], a[196:199], v[36:39], v[184:187]
v_exp_f32 v181, v181
v_mfma_f32_16x16x32_bf16 v[184:187], a[200:203], v[40:43], v[184:187]
v_cvt_pk_bf16_f32 v194, v180, v181
v_add_f32 v10, v10, v181
v_mfma_f32_16x16x32_bf16 v[184:187], a[204:207], v[44:47], v[184:187]
v_exp_f32 v182, v182
v_mfma_f32_16x16x32_bf16 v[188:191], a[208:211], v[32:35], -4.0
v_add_f32 v10, v10, v182
v_mfma_f32_16x16x32_bf16 v[188:191], a[212:215], v[36:39], v[188:191]
v_exp_f32 v183, v183
v_mfma_f32_16x16x32_bf16 v[188:191], a[216:219], v[40:43], v[188:191]
s_waitcnt vmcnt(32) lgkmcnt(0)
v_cvt_pk_bf16_f32 v195, v182, v183
v_add_f32 v10, v10, v183
v_mfma_f32_16x16x32_bf16 v[188:191], a[220:223], v[44:47], v[188:191]
s_barrier
v_exp_f32 v184, v184
v_mfma_f32_16x16x32_bf16 a[0:3], a[128:131], v[192:195], a[0:3]
ds_read_b128 a[224:227], v1 offset:8192
v_add_f32 v11, v11, v184
v_mfma_f32_16x16x32_bf16 a[4:7], a[132:135], v[192:195], a[4:7]
s_mov_b32 m0, s22
v_exp_f32 v185, v185
v_mfma_f32_16x16x32_bf16 a[8:11], a[136:139], v[192:195], a[8:11]
s_add_u32 s24, s21, 4096
v_cvt_pk_bf16_f32 v196, v184, v185
v_add_f32 v11, v11, v185
v_mfma_f32_16x16x32_bf16 a[12:15], a[140:143], v[192:195], a[12:15]
buffer_load_dwordx4 v3, s[8:11], s21 offen offset:0 nt lds
v_exp_f32 v186, v186
v_mfma_f32_16x16x32_bf16 a[16:19], a[144:147], v[192:195], a[16:19]
ds_read_b128 a[228:231], v1 offset:8448
v_add_f32 v11, v11, v186
v_mfma_f32_16x16x32_bf16 a[20:23], a[148:151], v[192:195], a[20:23]
buffer_load_dwordx4 v3, s[8:11], s21 offen offset:1024 nt lds
v_exp_f32 v187, v187
v_mfma_f32_16x16x32_bf16 a[24:27], a[152:155], v[192:195], a[24:27]
ds_read_b128 a[232:235], v1 offset:8704
v_cvt_pk_bf16_f32 v197, v186, v187
v_add_f32 v11, v11, v187
v_mfma_f32_16x16x32_bf16 a[28:31], a[156:159], v[192:195], a[28:31]
buffer_load_dwordx4 v4, s[8:11], s21 offen offset:2048 nt lds
v_exp_f32 v188, v188
v_mfma_f32_16x16x32_bf16 v[176:179], a[192:195], v[48:51], -4.0
ds_read_b128 a[236:239], v1 offset:8960
v_add_f32 v11, v11, v188
v_mfma_f32_16x16x32_bf16 v[176:179], a[196:199], v[52:55], v[176:179]
buffer_load_dwordx4 v4, s[8:11], s21 offen offset:3072 nt lds
v_exp_f32 v189, v189
v_mfma_f32_16x16x32_bf16 v[176:179], a[200:203], v[56:59], v[176:179]
s_add_u32 m0, s22, 4096
v_cvt_pk_bf16_f32 v198, v188, v189
v_add_f32 v11, v11, v189
v_mfma_f32_16x16x32_bf16 v[176:179], a[204:207], v[60:63], v[176:179]
buffer_load_dwordx4 v3, s[8:11], s24 offen offset:0 nt lds
v_exp_f32 v190, v190
v_mfma_f32_16x16x32_bf16 v[180:183], a[208:211], v[48:51], -4.0
ds_read_b128 a[240:243], v1 offset:12288
v_add_f32 v11, v11, v190
v_mfma_f32_16x16x32_bf16 v[180:183], a[212:215], v[52:55], v[180:183]
buffer_load_dwordx4 v3, s[8:11], s24 offen offset:1024 nt lds
v_exp_f32 v191, v191
v_mfma_f32_16x16x32_bf16 v[180:183], a[216:219], v[56:59], v[180:183]
v_cvt_pk_bf16_f32 v199, v190, v191
v_add_f32 v11, v11, v191
v_mfma_f32_16x16x32_bf16 v[180:183], a[220:223], v[60:63], v[180:183]
buffer_load_dwordx4 v4, s[8:11], s24 offen offset:2048 nt lds
v_exp_f32 v176, v176
v_mfma_f32_16x16x32_bf16 a[32:35], a[128:131], v[196:199], a[32:35]
ds_read_b128 a[244:247], v1 offset:12544
v_add_f32 v12, v12, v176
v_mfma_f32_16x16x32_bf16 a[36:39], a[132:135], v[196:199], a[36:39]
ds_read_b128 a[248:251], v1 offset:12800
v_exp_f32 v177, v177
v_mfma_f32_16x16x32_bf16 a[40:43], a[136:139], v[196:199], a[40:43]
buffer_load_dwordx4 v4, s[8:11], s24 offen offset:3072 nt lds
v_cvt_pk_bf16_f32 v192, v176, v177
v_add_f32 v12, v12, v177
v_mfma_f32_16x16x32_bf16 a[44:47], a[140:143], v[196:199], a[44:47]
s_add_u32 m0, s23, 0
v_exp_f32 v178, v178
v_mfma_f32_16x16x32_bf16 a[48:51], a[144:147], v[196:199], a[48:51]
ds_read_b128 a[252:255], v1 offset:13056
v_add_f32 v12, v12, v178
v_mfma_f32_16x16x32_bf16 a[52:55], a[148:151], v[196:199], a[52:55]
buffer_load_dwordx4 v3, s[12:15], s21 offen offset:0 nt lds
v_exp_f32 v179, v179
v_mfma_f32_16x16x32_bf16 a[56:59], a[152:155], v[196:199], a[56:59]
s_add_u32 m0, s23, 8
v_cvt_pk_bf16_f32 v193, v178, v179
v_add_f32 v12, v12, v179
v_mfma_f32_16x16x32_bf16 a[60:63], a[156:159], v[196:199], a[60:63]
buffer_load_dwordx4 v3, s[12:15], s21 offen offset:1024 nt lds
v_exp_f32 v180, v180
v_mfma_f32_16x16x32_bf16 v[184:187], a[192:195], v[64:67], -4.0
ds_read_b64_tr_b16 a[160:161], v2 offset:8256
v_add_f32 v12, v12, v180
v_mfma_f32_16x16x32_bf16 v[184:187], a[196:199], v[68:71], v[184:187]
s_add_u32 m0, s23, 16
v_exp_f32 v181, v181
v_mfma_f32_16x16x32_bf16 v[184:187], a[200:203], v[72:75], v[184:187]
buffer_load_dwordx4 v3, s[12:15], s21 offen offset:2048 nt lds
v_cvt_pk_bf16_f32 v194, v180, v181
v_add_f32 v12, v12, v181
v_mfma_f32_16x16x32_bf16 v[184:187], a[204:207], v[76:79], v[184:187]
ds_read_b64_tr_b16 a[162:163], v2 offset:12384
v_exp_f32 v182, v182
v_mfma_f32_16x16x32_bf16 v[188:191], a[208:211], v[64:67], -4.0
ds_read_b64_tr_b16 a[164:165], v2 offset:8264
v_add_f32 v12, v12, v182
v_mfma_f32_16x16x32_bf16 v[188:191], a[212:215], v[68:71], v[188:191]
s_add_u32 m0, s23, 24
v_exp_f32 v183, v183
v_mfma_f32_16x16x32_bf16 v[188:191], a[216:219], v[72:75], v[188:191]
buffer_load_dwordx4 v3, s[12:15], s21 offen offset:3072 nt lds
v_cvt_pk_bf16_f32 v195, v182, v183
v_add_f32 v12, v12, v183
v_mfma_f32_16x16x32_bf16 v[188:191], a[220:223], v[76:79], v[188:191]
s_add_u32 m0, s23, 4128
v_exp_f32 v184, v184
v_mfma_f32_16x16x32_bf16 a[64:67], a[128:131], v[192:195], a[64:67]
ds_read_b64_tr_b16 a[166:167], v2 offset:12392
v_add_f32 v13, v13, v184
v_mfma_f32_16x16x32_bf16 a[68:71], a[132:135], v[192:195], a[68:71]
buffer_load_dwordx4 v3, s[12:15], s24 offen offset:0 nt lds
v_exp_f32 v185, v185
v_mfma_f32_16x16x32_bf16 a[72:75], a[136:139], v[192:195], a[72:75]
s_add_u32 m0, s23, 4136
v_cvt_pk_bf16_f32 v196, v184, v185
v_add_f32 v13, v13, v185
v_mfma_f32_16x16x32_bf16 a[76:79], a[140:143], v[192:195], a[76:79]
buffer_load_dwordx4 v3, s[12:15], s24 offen offset:1024 nt lds
v_exp_f32 v186, v186
v_mfma_f32_16x16x32_bf16 a[80:83], a[144:147], v[192:195], a[80:83]
ds_read_b64_tr_b16 a[168:169], v2 offset:8512
v_add_f32 v13, v13, v186
v_mfma_f32_16x16x32_bf16 a[84:87], a[148:151], v[192:195], a[84:87]
s_add_u32 m0, s23, 4144
v_exp_f32 v187, v187
v_mfma_f32_16x16x32_bf16 a[88:91], a[152:155], v[192:195], a[88:91]
buffer_load_dwordx4 v3, s[12:15], s24 offen offset:2048 nt lds
v_cvt_pk_bf16_f32 v197, v186, v187
v_add_f32 v13, v13, v187
v_mfma_f32_16x16x32_bf16 a[92:95], a[156:159], v[192:195], a[92:95]
ds_read_b64_tr_b16 a[170:171], v2 offset:12640
v_exp_f32 v188, v188
v_mfma_f32_16x16x32_bf16 v[176:179], a[192:195], v[80:83], -4.0
ds_read_b64_tr_b16 a[172:173], v2 offset:8520
v_add_f32 v13, v13, v188
v_mfma_f32_16x16x32_bf16 v[176:179], a[196:199], v[84:87], v[176:179]
s_add_u32 m0, s23, 4152
v_exp_f32 v189, v189
v_mfma_f32_16x16x32_bf16 v[176:179], a[200:203], v[88:91], v[176:179]
buffer_load_dwordx4 v3, s[12:15], s24 offen offset:3072 nt lds
v_cvt_pk_bf16_f32 v198, v188, v189
v_add_f32 v13, v13, v189
s_add_u32 s22, s22, 8192
s_and_b32 s22, s22, 0x7fff
s_add_u32 s21, s21, 8192
s_add_u32 s23, s23, 8256
s_cmp_eq_u32 s23, s35
s_cselect_b32 s23, s34, s23
v_mfma_f32_16x16x32_bf16 v[176:179], a[204:207], v[92:95], v[176:179]
s_cmp_eq_u32 s28, 5
v_exp_f32 v190, v190
v_mfma_f32_16x16x32_bf16 v[180:183], a[208:211], v[80:83], -4.0
ds_read_b64_tr_b16 a[174:175], v2 offset:12648
v_add_f32 v13, v13, v190
v_mfma_f32_16x16x32_bf16 v[180:183], a[212:215], v[84:87], v[180:183]
s_cselect_b32 s25, 0x7f000000, s25
v_exp_f32 v191, v191
v_mfma_f32_16x16x32_bf16 v[180:183], a[216:219], v[88:91], v[180:183]
s_cselect_b32 s37, 0, s37
v_cvt_pk_bf16_f32 v199, v190, v191
v_add_f32 v13, v13, v191
v_mfma_f32_16x16x32_bf16 v[180:183], a[220:223], v[92:95], v[180:183]
s_mov_b32 m0, s26
v_exp_f32 v176, v176
v_mfma_f32_16x16x32_bf16 v[112:115], a[128:131], v[196:199], v[112:115]
ds_read_b64_tr_b16 a[176:177], v2 offset:8768
v_add_f32 v14, v14, v176
v_mfma_f32_16x16x32_bf16 v[116:119], a[132:135], v[196:199], v[116:119]
buffer_load_dwordx4 v3, s[4:7], s25 offen nt lds
v_exp_f32 v177, v177
v_mfma_f32_16x16x32_bf16 v[120:123], a[136:139], v[196:199], v[120:123]
ds_read_b64_tr_b16 a[178:179], v2 offset:12896
v_cvt_pk_bf16_f32 v192, v176, v177
v_add_f32 v14, v14, v177
v_mfma_f32_16x16x32_bf16 v[124:127], a[140:143], v[196:199], v[124:127]
s_add_u32 s26, s26, s37
v_exp_f32 v178, v178
v_mfma_f32_16x16x32_bf16 v[128:131], a[144:147], v[196:199], v[128:131]
ds_read_b64_tr_b16 a[180:181], v2 offset:8776
v_add_f32 v14, v14, v178
v_mfma_f32_16x16x32_bf16 v[132:135], a[148:151], v[196:199], v[132:135]
s_add_u32 s25, s25, 1024
v_exp_f32 v179, v179
v_mfma_f32_16x16x32_bf16 v[136:139], a[152:155], v[196:199], v[136:139]
s_mov_b32 m0, s26
v_cvt_pk_bf16_f32 v193, v178, v179
v_add_f32 v14, v14, v179
v_mfma_f32_16x16x32_bf16 v[140:143], a[156:159], v[196:199], v[140:143]
s_waitcnt lgkmcnt(8)
v_exp_f32 v180, v180
v_mfma_f32_16x16x32_bf16 v[184:187], a[224:227], v[16:19], -4.0
ds_read_b64_tr_b16 a[182:183], v2 offset:12904
v_add_f32 v14, v14, v180
v_mfma_f32_16x16x32_bf16 v[184:187], a[228:231], v[20:23], v[184:187]
buffer_load_dwordx4 v3, s[4:7], s25 offen nt lds
v_exp_f32 v181, v181
v_mfma_f32_16x16x32_bf16 v[184:187], a[232:235], v[24:27], v[184:187]
s_add_u32 s26, s26, s37
v_cvt_pk_bf16_f32 v194, v180, v181
v_add_f32 v14, v14, v181
v_mfma_f32_16x16x32_bf16 v[184:187], a[236:239], v[28:31], v[184:187]
s_add_u32 s25, s25, 1024
v_exp_f32 v182, v182
v_mfma_f32_16x16x32_bf16 v[188:191], a[240:243], v[16:19], -4.0
ds_read_b64_tr_b16 a[184:185], v2 offset:9024
v_add_f32 v14, v14, v182
v_mfma_f32_16x16x32_bf16 v[188:191], a[244:247], v[20:23], v[188:191]
v_exp_f32 v183, v183
v_mfma_f32_16x16x32_bf16 v[188:191], a[248:251], v[24:27], v[188:191]
ds_read_b64_tr_b16 a[186:187], v2 offset:13152
v_cvt_pk_bf16_f32 v195, v182, v183
v_add_f32 v14, v14, v183
v_mfma_f32_16x16x32_bf16 v[188:191], a[252:255], v[28:31], v[188:191]
v_exp_f32 v184, v184
v_mfma_f32_16x16x32_bf16 v[144:147], a[128:131], v[192:195], v[144:147]
ds_read_b64_tr_b16 a[188:189], v2 offset:9032
v_add_f32 v10, v10, v184
v_mfma_f32_16x16x32_bf16 v[148:151], a[132:135], v[192:195], v[148:151]
v_exp_f32 v185, v185
v_mfma_f32_16x16x32_bf16 v[152:155], a[136:139], v[192:195], v[152:155]
v_cvt_pk_bf16_f32 v196, v184, v185
v_add_f32 v10, v10, v185
v_mfma_f32_16x16x32_bf16 v[156:159], a[140:143], v[192:195], v[156:159]
v_exp_f32 v186, v186
v_mfma_f32_16x16x32_bf16 v[160:163], a[144:147], v[192:195], v[160:163]
ds_read_b64_tr_b16 a[190:191], v2 offset:13160
v_add_f32 v10, v10, v186
v_mfma_f32_16x16x32_bf16 v[164:167], a[148:151], v[192:195], v[164:167]
v_exp_f32 v187, v187
v_mfma_f32_16x16x32_bf16 v[168:171], a[152:155], v[192:195], v[168:171]
v_cvt_pk_bf16_f32 v197, v186, v187
v_add_f32 v10, v10, v187
v_mfma_f32_16x16x32_bf16 v[172:175], a[156:159], v[192:195], v[172:175]
v_exp_f32 v188, v188
v_mfma_f32_16x16x32_bf16 v[176:179], a[224:227], v[32:35], -4.0
v_add_f32 v10, v10, v188
v_xor_b32 v1, 0x4000, v1
v_mfma_f32_16x16x32_bf16 v[176:179], a[228:231], v[36:39], v[176:179]
v_exp_f32 v189, v189
v_mfma_f32_16x16x32_bf16 v[176:179], a[232:235], v[40:43], v[176:179]
v_cvt_pk_bf16_f32 v198, v188, v189
v_add_f32 v10, v10, v189
v_mfma_f32_16x16x32_bf16 v[176:179], a[236:239], v[44:47], v[176:179]
v_exp_f32 v190, v190
v_mfma_f32_16x16x32_bf16 v[180:183], a[240:243], v[32:35], -4.0
v_add_f32 v10, v10, v190
v_add_u32 v2, s30, v2
v_mfma_f32_16x16x32_bf16 v[180:183], a[244:247], v[36:39], v[180:183]
s_sub_u32 s30, 0, s30
v_exp_f32 v191, v191
v_mfma_f32_16x16x32_bf16 v[180:183], a[248:251], v[40:43], v[180:183]
s_waitcnt vmcnt(34) lgkmcnt(0)
v_cvt_pk_bf16_f32 v199, v190, v191
v_add_f32 v10, v10, v191
v_mfma_f32_16x16x32_bf16 v[180:183], a[252:255], v[44:47], v[180:183]
s_barrier
v_exp_f32 v176, v176
v_mfma_f32_16x16x32_bf16 a[0:3], a[160:163], v[196:199], a[0:3]
ds_read_b128 a[192:195], v1 offset:0
v_add_f32 v11, v11, v176
v_mfma_f32_16x16x32_bf16 a[4:7], a[164:167], v[196:199], a[4:7]
s_mov_b32 m0, s22
v_exp_f32 v177, v177
v_mfma_f32_16x16x32_bf16 a[8:11], a[168:171], v[196:199], a[8:11]
s_add_u32 s24, s21, 4096
v_cvt_pk_bf16_f32 v192, v176, v177
v_add_f32 v11, v11, v177
v_mfma_f32_16x16x32_bf16 a[12:15], a[172:175], v[196:199], a[12:15]
buffer_load_dwordx4 v3, s[8:11], s21 offen offset:0 nt lds
v_exp_f32 v178, v178
v_mfma_f32_16x16x32_bf16 a[16:19], a[176:179], v[196:199], a[16:19]
ds_read_b128 a[196:199], v1 offset:256
v_add_f32 v11, v11, v178
v_mfma_f32_16x16x32_bf16 a[20:23], a[180:183], v[196:199], a[20:23]
buffer_load_dwordx4 v3, s[8:11], s21 offen offset:1024 nt lds
v_exp_f32 v179, v179
v_mfma_f32_16x16x32_bf16 a[24:27], a[184:187], v[196:199], a[24:27]
ds_read_b128 a[200:203], v1 offset:512
v_cvt_pk_bf16_f32 v193, v178, v179
v_add_f32 v11, v11, v179
v_mfma_f32_16x16x32_bf16 a[28:31], a[188:191], v[196:199], a[28:31]
buffer_load_dwordx4 v4, s[8:11], s21 offen offset:2048 nt lds
v_exp_f32 v180, v180
v_mfma_f32_16x16x32_bf16 v[184:187], a[224:227], v[48:51], -4.0
ds_read_b128 a[204:207], v1 offset:768
v_add_f32 v11, v11, v180
v_mfma_f32_16x16x32_bf16 v[184:187], a[228:231], v[52:55], v[184:187]
buffer_load_dwordx4 v4, s[8:11], s21 offen offset:3072 nt lds
v_exp_f32 v181, v181
v_mfma_f32_16x16x32_bf16 v[184:187], a[232:235], v[56:59], v[184:187]
s_add_u32 m0, s22, 4096
v_cvt_pk_bf16_f32 v194, v180, v181
v_add_f32 v11, v11, v181
v_mfma_f32_16x16x32_bf16 v[184:187], a[236:239], v[60:63], v[184:187]
buffer_load_dwordx4 v3, s[8:11], s24 offen offset:0 nt lds
v_exp_f32 v182, v182
v_mfma_f32_16x16x32_bf16 v[188:191], a[240:243], v[48:51], -4.0
ds_read_b128 a[208:211], v1 offset:4096
v_add_f32 v11, v11, v182
v_mfma_f32_16x16x32_bf16 v[188:191], a[244:247], v[52:55], v[188:191]
buffer_load_dwordx4 v3, s[8:11], s24 offen offset:1024 nt lds
v_exp_f32 v183, v183
v_mfma_f32_16x16x32_bf16 v[188:191], a[248:251], v[56:59], v[188:191]
v_cvt_pk_bf16_f32 v195, v182, v183
v_add_f32 v11, v11, v183
v_mfma_f32_16x16x32_bf16 v[188:191], a[252:255], v[60:63], v[188:191]
buffer_load_dwordx4 v4, s[8:11], s24 offen offset:2048 nt lds
v_exp_f32 v184, v184
v_mfma_f32_16x16x32_bf16 a[32:35], a[160:163], v[192:195], a[32:35]
ds_read_b128 a[212:215], v1 offset:4352
v_add_f32 v12, v12, v184
v_mfma_f32_16x16x32_bf16 a[36:39], a[164:167], v[192:195], a[36:39]
ds_read_b128 a[216:219], v1 offset:4608
v_exp_f32 v185, v185
v_mfma_f32_16x16x32_bf16 a[40:43], a[168:171], v[192:195], a[40:43]
buffer_load_dwordx4 v4, s[8:11], s24 offen offset:3072 nt lds
v_cvt_pk_bf16_f32 v196, v184, v185
v_add_f32 v12, v12, v185
v_mfma_f32_16x16x32_bf16 a[44:47], a[172:175], v[192:195], a[44:47]
s_add_u32 m0, s23, 0
v_exp_f32 v186, v186
v_mfma_f32_16x16x32_bf16 a[48:51], a[176:179], v[192:195], a[48:51]
ds_read_b128 a[220:223], v1 offset:4864
v_add_f32 v12, v12, v186
v_mfma_f32_16x16x32_bf16 a[52:55], a[180:183], v[192:195], a[52:55]
buffer_load_dwordx4 v3, s[12:15], s21 offen offset:0 nt lds
v_exp_f32 v187, v187
v_mfma_f32_16x16x32_bf16 a[56:59], a[184:187], v[192:195], a[56:59]
s_add_u32 m0, s23, 8
v_cvt_pk_bf16_f32 v197, v186, v187
v_add_f32 v12, v12, v187
v_mfma_f32_16x16x32_bf16 a[60:63], a[188:191], v[192:195], a[60:63]
buffer_load_dwordx4 v3, s[12:15], s21 offen offset:1024 nt lds
v_exp_f32 v188, v188
v_mfma_f32_16x16x32_bf16 v[176:179], a[224:227], v[64:67], -4.0
ds_read_b64_tr_b16 a[128:129], v2 offset:0
v_add_f32 v12, v12, v188
v_mfma_f32_16x16x32_bf16 v[176:179], a[228:231], v[68:71], v[176:179]
s_add_u32 m0, s23, 16
v_exp_f32 v189, v189
v_mfma_f32_16x16x32_bf16 v[176:179], a[232:235], v[72:75], v[176:179]
buffer_load_dwordx4 v3, s[12:15], s21 offen offset:2048 nt lds
v_cvt_pk_bf16_f32 v198, v188, v189
v_add_f32 v12, v12, v189
v_mfma_f32_16x16x32_bf16 v[176:179], a[236:239], v[76:79], v[176:179]
ds_read_b64_tr_b16 a[130:131], v2 offset:4128
v_exp_f32 v190, v190
v_mfma_f32_16x16x32_bf16 v[180:183], a[240:243], v[64:67], -4.0
ds_read_b64_tr_b16 a[132:133], v2 offset:8
v_add_f32 v12, v12, v190
v_mfma_f32_16x16x32_bf16 v[180:183], a[244:247], v[68:71], v[180:183]
s_add_u32 m0, s23, 24
v_exp_f32 v191, v191
v_mfma_f32_16x16x32_bf16 v[180:183], a[248:251], v[72:75], v[180:183]
buffer_load_dwordx4 v3, s[12:15], s21 offen offset:3072 nt lds
v_cvt_pk_bf16_f32 v199, v190, v191
v_add_f32 v12, v12, v191
v_mfma_f32_16x16x32_bf16 v[180:183], a[252:255], v[76:79], v[180:183]
s_add_u32 m0, s23, 4128
v_exp_f32 v176, v176
v_mfma_f32_16x16x32_bf16 a[64:67], a[160:163], v[196:199], a[64:67]
ds_read_b64_tr_b16 a[134:135], v2 offset:4136
v_add_f32 v13, v13, v176
v_mfma_f32_16x16x32_bf16 a[68:71], a[164:167], v[196:199], a[68:71]
buffer_load_dwordx4 v3, s[12:15], s24 offen offset:0 nt lds
v_exp_f32 v177, v177
v_mfma_f32_16x16x32_bf16 a[72:75], a[168:171], v[196:199], a[72:75]
s_add_u32 m0, s23, 4136
L_pad9:
s_cbranch_execz L_pad13
v_cvt_pk_bf16_f32 v192, v176, v177
v_add_f32 v13, v13, v177
v_mfma_f32_16x16x32_bf16 a[76:79], a[172:175], v[196:199], a[76:79]
buffer_load_dwordx4 v3, s[12:15], s24 offen offset:1024 nt lds
v_exp_f32 v178, v178
v_mfma_f32_16x16x32_bf16 a[80:83], a[176:179], v[196:199], a[80:83]
ds_read_b64_tr_b16 a[136:137], v2 offset:256
v_add_f32 v13, v13, v178
v_mfma_f32_16x16x32_bf16 a[84:87], a[180:183], v[196:199], a[84:87]
s_add_u32 m0, s23, 4144
v_exp_f32 v179, v179
v_mfma_f32_16x16x32_bf16 a[88:91], a[184:187], v[196:199], a[88:91]
buffer_load_dwordx4 v3, s[12:15], s24 offen offset:2048 nt lds
v_cvt_pk_bf16_f32 v193, v178, v179
v_add_f32 v13, v13, v179
v_mfma_f32_16x16x32_bf16 a[92:95], a[188:191], v[196:199], a[92:95]
ds_read_b64_tr_b16 a[138:139], v2 offset:4384
v_exp_f32 v180, v180
v_mfma_f32_16x16x32_bf16 v[184:187], a[224:227], v[80:83], -4.0
ds_read_b64_tr_b16 a[140:141], v2 offset:264
v_add_f32 v13, v13, v180
v_mfma_f32_16x16x32_bf16 v[184:187], a[228:231], v[84:87], v[184:187]
s_add_u32 m0, s23, 4152
v_exp_f32 v181, v181
v_mfma_f32_16x16x32_bf16 v[184:187], a[232:235], v[88:91], v[184:187]
buffer_load_dwordx4 v3, s[12:15], s24 offen offset:3072 nt lds
v_cvt_pk_bf16_f32 v194, v180, v181
v_add_f32 v13, v13, v181
s_add_u32 s22, s22, 8192
s_and_b32 s22, s22, 0x7fff
s_add_u32 s21, s21, 8192
s_add_u32 s23, s23, 8256
s_cmp_eq_u32 s23, s35
s_cselect_b32 s23, s34, s23
v_mfma_f32_16x16x32_bf16 v[184:187], a[236:239], v[92:95], v[184:187]
s_mov_b32 m0, s26
v_exp_f32 v182, v182
v_mfma_f32_16x16x32_bf16 v[188:191], a[240:243], v[80:83], -4.0
ds_read_b64_tr_b16 a[142:143], v2 offset:4392
v_add_f32 v13, v13, v182
v_mfma_f32_16x16x32_bf16 v[188:191], a[244:247], v[84:87], v[188:191]
buffer_load_dwordx4 v4, s[4:7], s25 offen nt lds
v_exp_f32 v183, v183
v_mfma_f32_16x16x32_bf16 v[188:191], a[248:251], v[88:91], v[188:191]
s_add_u32 s26, s26, s37
v_cvt_pk_bf16_f32 v195, v182, v183
v_add_f32 v13, v13, v183
v_mfma_f32_16x16x32_bf16 v[188:191], a[252:255], v[92:95], v[188:191]
s_add_u32 s25, s25, 1024
v_exp_f32 v184, v184
v_mfma_f32_16x16x32_bf16 v[112:115], a[160:163], v[192:195], v[112:115]
ds_read_b64_tr_b16 a[144:145], v2 offset:512
v_add_f32 v14, v14, v184
v_mfma_f32_16x16x32_bf16 v[116:119], a[164:167], v[192:195], v[116:119]
s_mov_b32 m0, s26
v_exp_f32 v185, v185
v_mfma_f32_16x16x32_bf16 v[120:123], a[168:171], v[192:195], v[120:123]
ds_read_b64_tr_b16 a[146:147], v2 offset:4640
v_cvt_pk_bf16_f32 v196, v184, v185
v_add_f32 v14, v14, v185
v_mfma_f32_16x16x32_bf16 v[124:127], a[172:175], v[192:195], v[124:127]
buffer_load_dwordx4 v4, s[4:7], s25 offen nt lds
v_exp_f32 v186, v186
v_mfma_f32_16x16x32_bf16 v[128:131], a[176:179], v[192:195], v[128:131]
ds_read_b64_tr_b16 a[148:149], v2 offset:520
v_add_f32 v14, v14, v186
v_mfma_f32_16x16x32_bf16 v[132:135], a[180:183], v[192:195], v[132:135]
s_add_u32 s26, s26, s37
v_exp_f32 v187, v187
v_mfma_f32_16x16x32_bf16 v[136:139], a[184:187], v[192:195], v[136:139]
s_add_u32 s25, s25, 1024
v_cvt_pk_bf16_f32 v197, v186, v187
v_add_f32 v14, v14, v187
v_mfma_f32_16x16x32_bf16 v[140:143], a[188:191], v[192:195], v[140:143]
s_waitcnt lgkmcnt(8)
v_exp_f32 v188, v188
v_mfma_f32_16x16x32_bf16 v[176:179], a[192:195], v[16:19], -4.0
ds_read_b64_tr_b16 a[150:151], v2 offset:4648
v_add_f32 v14, v14, v188
v_mfma_f32_16x16x32_bf16 v[176:179], a[196:199], v[20:23], v[176:179]
v_exp_f32 v189, v189
v_mfma_f32_16x16x32_bf16 v[176:179], a[200:203], v[24:27], v[176:179]
v_cvt_pk_bf16_f32 v198, v188, v189
v_add_f32 v14, v14, v189
v_mfma_f32_16x16x32_bf16 v[176:179], a[204:207], v[28:31], v[176:179]
v_exp_f32 v190, v190
v_mfma_f32_16x16x32_bf16 v[180:183], a[208:211], v[16:19], -4.0
ds_read_b64_tr_b16 a[152:153], v2 offset:768
v_add_f32 v14, v14, v190
v_mfma_f32_16x16x32_bf16 v[180:183], a[212:215], v[20:23], v[180:183]
v_exp_f32 v191, v191
v_mfma_f32_16x16x32_bf16 v[180:183], a[216:219], v[24:27], v[180:183]
ds_read_b64_tr_b16 a[154:155], v2 offset:4896
v_cvt_pk_bf16_f32 v199, v190, v191
v_add_f32 v14, v14, v191
v_mfma_f32_16x16x32_bf16 v[180:183], a[220:223], v[28:31], v[180:183]
v_exp_f32 v176, v176
v_mfma_f32_16x16x32_bf16 v[144:147], a[160:163], v[196:199], v[144:147]
ds_read_b64_tr_b16 a[156:157], v2 offset:776
v_mov_b32 v6, v176
v_mfma_f32_16x16x32_bf16 v[148:151], a[164:167], v[196:199], v[148:151]
v_exp_f32 v177, v177
v_mfma_f32_16x16x32_bf16 v[152:155], a[168:171], v[196:199], v[152:155]
v_cvt_pk_bf16_f32 v192, v176, v177
v_add_f32 v6, v6, v177
v_mfma_f32_16x16x32_bf16 v[156:159], a[172:175], v[196:199], v[156:159]
v_exp_f32 v178, v178
v_mfma_f32_16x16x32_bf16 v[160:163], a[176:179], v[196:199], v[160:163]
ds_read_b64_tr_b16 a[158:159], v2 offset:4904
v_add_f32 v6, v6, v178
v_exp_f32 v180, v180
v_mfma_f32_16x16x32_bf16 v[164:167], a[180:183], v[196:199], v[164:167]
s_add_u32 s28, s28, 1
v_exp_f32 v179, v179
v_mfma_f32_16x16x32_bf16 v[168:171], a[184:187], v[196:199], v[168:171]
s_cmp_lt_u32 s28, s36
v_cvt_pk_bf16_f32 v193, v178, v179
v_add_f32 v6, v6, v179
v_mfma_f32_16x16x32_bf16 v[172:175], a[188:191], v[196:199], v[172:175]
s_cbranch_scc1 L_loopB
L_endB:
v_mfma_f32_16x16x32_bf16 v[184:187], a[192:195], v[32:35], -4.0
v_add_f32 v10, v10, v180
v_add_f32 v10, v10, v6
v_mfma_f32_16x16x32_bf16 v[184:187], a[196:199], v[36:39], v[184:187]
v_exp_f32 v181, v181
v_mfma_f32_16x16x32_bf16 v[184:187], a[200:203], v[40:43], v[184:187]
v_cvt_pk_bf16_f32 v194, v180, v181
v_add_f32 v10, v10, v181
v_mfma_f32_16x16x32_bf16 v[184:187], a[204:207], v[44:47], v[184:187]
v_exp_f32 v182, v182
v_mfma_f32_16x16x32_bf16 v[188:191], a[208:211], v[32:35], -4.0
v_add_f32 v10, v10, v182
v_mfma_f32_16x16x32_bf16 v[188:191], a[212:215], v[36:39], v[188:191]
v_exp_f32 v183, v183
v_mfma_f32_16x16x32_bf16 v[188:191], a[216:219], v[40:43], v[188:191]
s_waitcnt vmcnt(38) lgkmcnt(0)
v_cvt_pk_bf16_f32 v195, v182, v183
v_add_f32 v10, v10, v183
v_mfma_f32_16x16x32_bf16 v[188:191], a[220:223], v[44:47], v[188:191]
s_barrier
v_exp_f32 v184, v184
v_mfma_f32_16x16x32_bf16 a[0:3], a[128:131], v[192:195], a[0:3]
ds_read_b128 a[224:227], v1 offset:8192
v_add_f32 v11, v11, v184
v_mfma_f32_16x16x32_bf16 a[4:7], a[132:135], v[192:195], a[4:7]
s_mov_b32 m0, s22
v_exp_f32 v185, v185
v_mfma_f32_16x16x32_bf16 a[8:11], a[136:139], v[192:195], a[8:11]
s_add_u32 s24, s21, 4096
v_cvt_pk_bf16_f32 v196, v184, v185
v_add_f32 v11, v11, v185
v_mfma_f32_16x16x32_bf16 a[12:15], a[140:143], v[192:195], a[12:15]
buffer_load_dwordx4 v3, s[8:11], s21 offen offset:0 nt lds
v_exp_f32 v186, v186
v_mfma_f32_16x16x32_bf16 a[16:19], a[144:147], v[192:195], a[16:19]
ds_read_b128 a[228:231], v1 offset:8448
v_add_f32 v11, v11, v186
v_mfma_f32_16x16x32_bf16 a[20:23], a[148:151], v[192:195], a[20:23]
buffer_load_dwordx4 v3, s[8:11], s21 offen offset:1024 nt lds
v_exp_f32 v187, v187
v_mfma_f32_16x16x32_bf16 a[24:27], a[152:155], v[192:195], a[24:27]
ds_read_b128 a[232:235], v1 offset:8704
v_cvt_pk_bf16_f32 v197, v186, v187
v_add_f32 v11, v11, v187
v_mfma_f32_16x16x32_bf16 a[28:31], a[156:159], v[192:195], a[28:31]
buffer_load_dwordx4 v4, s[8:11], s21 offen offset:2048 nt lds
v_exp_f32 v188, v188
v_mfma_f32_16x16x32_bf16 v[176:179], a[192:195], v[48:51], -4.0
ds_read_b128 a[236:239], v1 offset:8960
v_add_f32 v11, v11, v188
v_mfma_f32_16x16x32_bf16 v[176:179], a[196:199], v[52:55], v[176:179]
buffer_load_dwordx4 v4, s[8:11], s21 offen offset:3072 nt lds
v_exp_f32 v189, v189
v_mfma_f32_16x16x32_bf16 v[176:179], a[200:203], v[56:59], v[176:179]
s_add_u32 m0, s22, 4096
v_cvt_pk_bf16_f32 v198, v188, v189
v_add_f32 v11, v11, v189
v_mfma_f32_16x16x32_bf16 v[176:179], a[204:207], v[60:63], v[176:179]
buffer_load_dwordx4 v3, s[8:11], s24 offen offset:0 nt lds
v_exp_f32 v190, v190
v_mfma_f32_16x16x32_bf16 v[180:183], a[208:211], v[48:51], -4.0
ds_read_b128 a[240:243], v1 offset:12288
v_add_f32 v11, v11, v190
v_mfma_f32_16x16x32_bf16 v[180:183], a[212:215], v[52:55], v[180:183]
buffer_load_dwordx4 v3, s[8:11], s24 offen offset:1024 nt lds
v_exp_f32 v191, v191
v_mfma_f32_16x16x32_bf16 v[180:183], a[216:219], v[56:59], v[180:183]
v_cvt_pk_bf16_f32 v199, v190, v191
v_add_f32 v11, v11, v191
v_mfma_f32_16x16x32_bf16 v[180:183], a[220:223], v[60:63], v[180:183]
buffer_load_dwordx4 v4, s[8:11], s24 offen offset:2048 nt lds
v_exp_f32 v176, v176
v_mfma_f32_16x16x32_bf16 a[32:35], a[128:131], v[196:199], a[32:35]
ds_read_b128 a[244:247], v1 offset:12544
v_add_f32 v12, v12, v176
v_mfma_f32_16x16x32_bf16 a[36:39], a[132:135], v[196:199], a[36:39]
ds_read_b128 a[248:251], v1 offset:12800
v_exp_f32 v177, v177
v_mfma_f32_16x16x32_bf16 a[40:43], a[136:139], v[196:199], a[40:43]
buffer_load_dwordx4 v4, s[8:11], s24 offen offset:3072 nt lds
v_cvt_pk_bf16_f32 v192, v176, v177
v_add_f32 v12, v12, v177
v_mfma_f32_16x16x32_bf16 a[44:47], a[140:143], v[196:199], a[44:47]
s_add_u32 m0, s23, 0
v_exp_f32 v178, v178
v_mfma_f32_16x16x32_bf16 a[48:51], a[144:147], v[196:199], a[48:51]
ds_read_b128 a[252:255], v1 offset:13056
v_add_f32 v12, v12, v178
v_mfma_f32_16x16x32_bf16 a[52:55], a[148:151], v[196:199], a[52:55]
buffer_load_dwordx4 v3, s[12:15], s21 offen offset:0 nt lds
v_exp_f32 v179, v179
v_mfma_f32_16x16x32_bf16 a[56:59], a[152:155], v[196:199], a[56:59]
s_add_u32 m0, s23, 8
v_cvt_pk_bf16_f32 v193, v178, v179
v_add_f32 v12, v12, v179
v_mfma_f32_16x16x32_bf16 a[60:63], a[156:159], v[196:199], a[60:63]
buffer_load_dwordx4 v3, s[12:15], s21 offen offset:1024 nt lds
v_exp_f32 v180, v180
v_mfma_f32_16x16x32_bf16 v[184:187], a[192:195], v[64:67], -4.0
ds_read_b64_tr_b16 a[160:161], v2 offset:8256
v_add_f32 v12, v12, v180
v_mfma_f32_16x16x32_bf16 v[184:187], a[196:199], v[68:71], v[184:187]
s_add_u32 m0, s23, 16
v_exp_f32 v181, v181
v_mfma_f32_16x16x32_bf16 v[184:187], a[200:203], v[72:75], v[184:187]
buffer_load_dwordx4 v3, s[12:15], s21 offen offset:2048 nt lds
v_cvt_pk_bf16_f32 v194, v180, v181
v_add_f32 v12, v12, v181
v_mfma_f32_16x16x32_bf16 v[184:187], a[204:207], v[76:79], v[184:187]
ds_read_b64_tr_b16 a[162:163], v2 offset:12384
v_exp_f32 v182, v182
v_mfma_f32_16x16x32_bf16 v[188:191], a[208:211], v[64:67], -4.0
ds_read_b64_tr_b16 a[164:165], v2 offset:8264
v_add_f32 v12, v12, v182
v_mfma_f32_16x16x32_bf16 v[188:191], a[212:215], v[68:71], v[188:191]
s_add_u32 m0, s23, 24
v_exp_f32 v183, v183
v_mfma_f32_16x16x32_bf16 v[188:191], a[216:219], v[72:75], v[188:191]
buffer_load_dwordx4 v3, s[12:15], s21 offen offset:3072 nt lds
v_cvt_pk_bf16_f32 v195, v182, v183
v_add_f32 v12, v12, v183
v_mfma_f32_16x16x32_bf16 v[188:191], a[220:223], v[76:79], v[188:191]
s_add_u32 m0, s23, 4128
v_exp_f32 v184, v184
v_mfma_f32_16x16x32_bf16 a[64:67], a[128:131], v[192:195], a[64:67]
ds_read_b64_tr_b16 a[166:167], v2 offset:12392
v_add_f32 v13, v13, v184
v_mfma_f32_16x16x32_bf16 a[68:71], a[132:135], v[192:195], a[68:71]
buffer_load_dwordx4 v3, s[12:15], s24 offen offset:0 nt lds
v_exp_f32 v185, v185
v_mfma_f32_16x16x32_bf16 a[72:75], a[136:139], v[192:195], a[72:75]
s_add_u32 m0, s23, 4136
v_cvt_pk_bf16_f32 v196, v184, v185
v_add_f32 v13, v13, v185
v_mfma_f32_16x16x32_bf16 a[76:79], a[140:143], v[192:195], a[76:79]
buffer_load_dwordx4 v3, s[12:15], s24 offen offset:1024 nt lds
v_exp_f32 v186, v186
v_mfma_f32_16x16x32_bf16 a[80:83], a[144:147], v[192:195], a[80:83]
ds_read_b64_tr_b16 a[168:169], v2 offset:8512
v_add_f32 v13, v13, v186
v_mfma_f32_16x16x32_bf16 a[84:87], a[148:151], v[192:195], a[84:87]
s_add_u32 m0, s23, 4144
v_exp_f32 v187, v187
v_mfma_f32_16x16x32_bf16 a[88:91], a[152:155], v[192:195], a[88:91]
buffer_load_dwordx4 v3, s[12:15], s24 offen offset:2048 nt lds
v_cvt_pk_bf16_f32 v197, v186, v187
v_add_f32 v13, v13, v187
v_mfma_f32_16x16x32_bf16 a[92:95], a[156:159], v[192:195], a[92:95]
ds_read_b64_tr_b16 a[170:171], v2 offset:12640
v_exp_f32 v188, v188
v_mfma_f32_16x16x32_bf16 v[176:179], a[192:195], v[80:83], -4.0
ds_read_b64_tr_b16 a[172:173], v2 offset:8520
v_add_f32 v13, v13, v188
v_mfma_f32_16x16x32_bf16 v[176:179], a[196:199], v[84:87], v[176:179]
s_add_u32 m0, s23, 4152
v_exp_f32 v189, v189
v_mfma_f32_16x16x32_bf16 v[176:179], a[200:203], v[88:91], v[176:179]
buffer_load_dwordx4 v3, s[12:15], s24 offen offset:3072 nt lds
v_cvt_pk_bf16_f32 v198, v188, v189
v_add_f32 v13, v13, v189
s_add_u32 s22, s22, 8192
s_and_b32 s22, s22, 0x7fff
s_add_u32 s21, s21, 8192
s_add_u32 s23, s23, 8256
s_cmp_eq_u32 s23, s35
s_cselect_b32 s23, s34, s23
v_mfma_f32_16x16x32_bf16 v[176:179], a[204:207], v[92:95], v[176:179]
v_exp_f32 v190, v190
v_mfma_f32_16x16x32_bf16 v[180:183], a[208:211], v[80:83], -4.0
ds_read_b64_tr_b16 a[174:175], v2 offset:12648
v_add_f32 v13, v13, v190
v_mfma_f32_16x16x32_bf16 v[180:183], a[212:215], v[84:87], v[180:183]
v_exp_f32 v191, v191
v_mfma_f32_16x16x32_bf16 v[180:183], a[216:219], v[88:91], v[180:183]
v_cvt_pk_bf16_f32 v199, v190, v191
v_add_f32 v13, v13, v191
v_mfma_f32_16x16x32_bf16 v[180:183], a[220:223], v[92:95], v[180:183]
v_exp_f32 v176, v176
v_mfma_f32_16x16x32_bf16 v[112:115], a[128:131], v[196:199], v[112:115]
ds_read_b64_tr_b16 a[176:177], v2 offset:8768
v_add_f32 v14, v14, v176
v_mfma_f32_16x16x32_bf16 v[116:119], a[132:135], v[196:199], v[116:119]
v_exp_f32 v177, v177
v_mfma_f32_16x16x32_bf16 v[120:123], a[136:139], v[196:199], v[120:123]
ds_read_b64_tr_b16 a[178:179], v2 offset:12896
v_cvt_pk_bf16_f32 v192, v176, v177
v_add_f32 v14, v14, v177
v_mfma_f32_16x16x32_bf16 v[124:127], a[140:143], v[196:199], v[124:127]
v_exp_f32 v178, v178
v_mfma_f32_16x16x32_bf16 v[128:131], a[144:147], v[196:199], v[128:131]
ds_read_b64_tr_b16 a[180:181], v2 offset:8776
v_add_f32 v14, v14, v178
v_mfma_f32_16x16x32_bf16 v[132:135], a[148:151], v[196:199], v[132:135]
v_exp_f32 v179, v179
v_mfma_f32_16x16x32_bf16 v[136:139], a[152:155], v[196:199], v[136:139]
v_cvt_pk_bf16_f32 v193, v178, v179
v_add_f32 v14, v14, v179
v_mfma_f32_16x16x32_bf16 v[140:143], a[156:159], v[196:199], v[140:143]
s_waitcnt lgkmcnt(8)
v_exp_f32 v180, v180
v_mfma_f32_16x16x32_bf16 v[184:187], a[224:227], v[16:19], -4.0
ds_read_b64_tr_b16 a[182:183], v2 offset:12904
v_add_f32 v14, v14, v180
v_mfma_f32_16x16x32_bf16 v[184:187], a[228:231], v[20:23], v[184:187]
v_exp_f32 v181, v181
v_mfma_f32_16x16x32_bf16 v[184:187], a[232:235], v[24:27], v[184:187]
v_cvt_pk_bf16_f32 v194, v180, v181
v_add_f32 v14, v14, v181
v_mfma_f32_16x16x32_bf16 v[184:187], a[236:239], v[28:31], v[184:187]
v_exp_f32 v182, v182
v_mfma_f32_16x16x32_bf16 v[188:191], a[240:243], v[16:19], -4.0
ds_read_b64_tr_b16 a[184:185], v2 offset:9024
v_add_f32 v14, v14, v182
v_mfma_f32_16x16x32_bf16 v[188:191], a[244:247], v[20:23], v[188:191]
v_exp_f32 v183, v183
v_mfma_f32_16x16x32_bf16 v[188:191], a[248:251], v[24:27], v[188:191]
ds_read_b64_tr_b16 a[186:187], v2 offset:13152
v_cvt_pk_bf16_f32 v195, v182, v183
v_add_f32 v14, v14, v183
v_mfma_f32_16x16x32_bf16 v[188:191], a[252:255], v[28:31], v[188:191]
v_exp_f32 v184, v184
v_mfma_f32_16x16x32_bf16 v[144:147], a[128:131], v[192:195], v[144:147]
ds_read_b64_tr_b16 a[188:189], v2 offset:9032
v_add_f32 v10, v10, v184
v_mfma_f32_16x16x32_bf16 v[148:151], a[132:135], v[192:195], v[148:151]
v_exp_f32 v185, v185
v_mfma_f32_16x16x32_bf16 v[152:155], a[136:139], v[192:195], v[152:155]
v_cvt_pk_bf16_f32 v196, v184, v185
v_add_f32 v10, v10, v185
v_mfma_f32_16x16x32_bf16 v[156:159], a[140:143], v[192:195], v[156:159]
v_exp_f32 v186, v186
v_mfma_f32_16x16x32_bf16 v[160:163], a[144:147], v[192:195], v[160:163]
ds_read_b64_tr_b16 a[190:191], v2 offset:13160
v_add_f32 v10, v10, v186
v_mfma_f32_16x16x32_bf16 v[164:167], a[148:151], v[192:195], v[164:167]
v_exp_f32 v187, v187
v_mfma_f32_16x16x32_bf16 v[168:171], a[152:155], v[192:195], v[168:171]
v_cvt_pk_bf16_f32 v197, v186, v187
v_add_f32 v10, v10, v187
v_mfma_f32_16x16x32_bf16 v[172:175], a[156:159], v[192:195], v[172:175]
v_exp_f32 v188, v188
v_mfma_f32_16x16x32_bf16 v[176:179], a[224:227], v[32:35], -4.0
v_add_f32 v10, v10, v188
v_xor_b32 v1, 0x4000, v1
v_mfma_f32_16x16x32_bf16 v[176:179], a[228:231], v[36:39], v[176:179]
v_exp_f32 v189, v189
v_mfma_f32_16x16x32_bf16 v[176:179], a[232:235], v[40:43], v[176:179]
v_cvt_pk_bf16_f32 v198, v188, v189
v_add_f32 v10, v10, v189
v_mfma_f32_16x16x32_bf16 v[176:179], a[236:239], v[44:47], v[176:179]
v_exp_f32 v190, v190
v_mfma_f32_16x16x32_bf16 v[180:183], a[240:243], v[32:35], -4.0
v_add_f32 v10, v10, v190
v_add_u32 v2, s30, v2
v_mfma_f32_16x16x32_bf16 v[180:183], a[244:247], v[36:39], v[180:183]
s_sub_u32 s30, 0, s30
v_exp_f32 v191, v191
v_mfma_f32_16x16x32_bf16 v[180:183], a[248:251], v[40:43], v[180:183]
s_waitcnt vmcnt(36) lgkmcnt(0)
v_cvt_pk_bf16_f32 v199, v190, v191
v_add_f32 v10, v10, v191
v_mfma_f32_16x16x32_bf16 v[180:183], a[252:255], v[44:47], v[180:183]
s_barrier
v_exp_f32 v176, v176
v_mfma_f32_16x16x32_bf16 a[0:3], a[160:163], v[196:199], a[0:3]
ds_read_b128 a[192:195], v1 offset:0
v_add_f32 v11, v11, v176
v_mfma_f32_16x16x32_bf16 a[4:7], a[164:167], v[196:199], a[4:7]
s_mov_b32 m0, s22
v_exp_f32 v177, v177
v_mfma_f32_16x16x32_bf16 a[8:11], a[168:171], v[196:199], a[8:11]
s_add_u32 s24, s21, 4096
v_cvt_pk_bf16_f32 v192, v176, v177
v_add_f32 v11, v11, v177
v_mfma_f32_16x16x32_bf16 a[12:15], a[172:175], v[196:199], a[12:15]
buffer_load_dwordx4 v3, s[8:11], s21 offen offset:0 nt lds
v_exp_f32 v178, v178
v_mfma_f32_16x16x32_bf16 a[16:19], a[176:179], v[196:199], a[16:19]
ds_read_b128 a[196:199], v1 offset:256
v_add_f32 v11, v11, v178
v_mfma_f32_16x16x32_bf16 a[20:23], a[180:183], v[196:199], a[20:23]
buffer_load_dwordx4 v3, s[8:11], s21 offen offset:1024 nt lds
v_exp_f32 v179, v179
v_mfma_f32_16x16x32_bf16 a[24:27], a[184:187], v[196:199], a[24:27]
ds_read_b128 a[200:203], v1 offset:512
v_cvt_pk_bf16_f32 v193, v178, v179
v_add_f32 v11, v11, v179
v_mfma_f32_16x16x32_bf16 a[28:31], a[188:191], v[196:199], a[28:31]
buffer_load_dwordx4 v4, s[8:11], s21 offen offset:2048 nt lds
v_exp_f32 v180, v180
v_mfma_f32_16x16x4_f32 v[200:203], v7, v10, 0
s_waitcnt vmcnt(62)
ds_read_b128 v[16:19], v8 offset:0
ds_read_b128 v[20:23], v8 offset:256
ds_read_b128 v[24:27], v8 offset:512
ds_read_b128 v[28:31], v8 offset:768
v_accvgpr_read_b32 v204, a0
v_accvgpr_read_b32 v205, a1
v_accvgpr_read_b32 v206, a2
v_accvgpr_read_b32 v207, a3
v_accvgpr_read_b32 v208, a4
v_accvgpr_read_b32 v209, a5
v_accvgpr_read_b32 v210, a6
v_accvgpr_read_b32 v211, a7
v_rcp_f32 v200, v200
v_subrev_u32 v202, s47, v201
v_max_u32 v9, v9, v202
v_accvgpr_read_b32 v212, a8
v_accvgpr_read_b32 v213, a9
v_accvgpr_read_b32 v214, a10
v_accvgpr_read_b32 v215, a11
v_accvgpr_read_b32 v216, a12
v_accvgpr_read_b32 v217, a13
v_accvgpr_read_b32 v218, a14
v_accvgpr_read_b32 v219, a15
v_pk_mul_f32 v[204:205], v[204:205], v[200:201] op_sel_hi:[1,0]
v_pk_mul_f32 v[206:207], v[206:207], v[200:201] op_sel_hi:[1,0]
v_pk_mul_f32 v[208:209], v[208:209], v[200:201] op_sel_hi:[1,0]
v_pk_mul_f32 v[210:211], v[210:211], v[200:201] op_sel_hi:[1,0]
v_cvt_pk_bf16_f32 v220, v204, v205
v_cvt_pk_bf16_f32 v221, v206, v207
v_cvt_pk_bf16_f32 v222, v208, v209
v_cvt_pk_bf16_f32 v223, v210, v211
ds_write_b128 v233, v[220:223] offset:0
v_accvgpr_read_b32 v204, a16
v_accvgpr_read_b32 v205, a17
v_accvgpr_read_b32 v206, a18
v_accvgpr_read_b32 v207, a19
v_accvgpr_read_b32 v208, a20
v_accvgpr_read_b32 v209, a21
v_accvgpr_read_b32 v210, a22
v_accvgpr_read_b32 v211, a23
v_pk_mul_f32 v[212:213], v[212:213], v[200:201] op_sel_hi:[1,0]
v_pk_mul_f32 v[214:215], v[214:215], v[200:201] op_sel_hi:[1,0]
v_pk_mul_f32 v[216:217], v[216:217], v[200:201] op_sel_hi:[1,0]
v_pk_mul_f32 v[218:219], v[218:219], v[200:201] op_sel_hi:[1,0]
v_mfma_f32_32x32x16_bf16 a[0:15], v[228:231], v[228:231], 0
v_cvt_pk_bf16_f32 v224, v212, v213
v_cvt_pk_bf16_f32 v225, v214, v215
v_cvt_pk_bf16_f32 v226, v216, v217
v_cvt_pk_bf16_f32 v227, v218, v219
ds_write_b128 v234, v[224:227] offset:0
v_accvgpr_read_b32 v212, a24
v_accvgpr_read_b32 v213, a25
v_accvgpr_read_b32 v214, a26
v_accvgpr_read_b32 v215, a27
v_accvgpr_read_b32 v216, a28
v_accvgpr_read_b32 v217, a29
v_accvgpr_read_b32 v218, a30
v_accvgpr_read_b32 v219, a31
v_pk_mul_f32 v[204:205], v[204:205], v[200:201] op_sel_hi:[1,0]
v_pk_mul_f32 v[206:207], v[206:207], v[200:201] op_sel_hi:[1,0]
v_pk_mul_f32 v[208:209], v[208:209], v[200:201] op_sel_hi:[1,0]
v_pk_mul_f32 v[210:211], v[210:211], v[200:201] op_sel_hi:[1,0]
v_cvt_pk_bf16_f32 v220, v204, v205
v_cvt_pk_bf16_f32 v221, v206, v207
v_cvt_pk_bf16_f32 v222, v208, v209
v_cvt_pk_bf16_f32 v223, v210, v211
ds_write_b128 v233, v[220:223] offset:128
v_pk_mul_f32 v[212:213], v[212:213], v[200:201] op_sel_hi:[1,0]
v_pk_mul_f32 v[214:215], v[214:215], v[200:201] op_sel_hi:[1,0]
v_pk_mul_f32 v[216:217], v[216:217], v[200:201] op_sel_hi:[1,0]
v_pk_mul_f32 v[218:219], v[218:219], v[200:201] op_sel_hi:[1,0]
v_mfma_f32_32x32x16_bf16 a[16:31], v[228:231], v[228:231], 0
v_cvt_pk_bf16_f32 v224, v212, v213
v_cvt_pk_bf16_f32 v225, v214, v215
v_cvt_pk_bf16_f32 v226, v216, v217
v_cvt_pk_bf16_f32 v227, v218, v219
ds_write_b128 v234, v[224:227] offset:128
s_waitcnt lgkmcnt(4)
v_lshlrev_b32 v220, 16, v16
v_and_b32 v221, s31, v16
v_lshlrev_b32 v222, 16, v17
v_and_b32 v223, s31, v17
v_pk_mul_f32 v[220:221], v[220:221], s[38:39]
v_pk_mul_f32 v[222:223], v[222:223], s[38:39]
v_cvt_pk_bf16_f32 v16, v220, v221
v_cvt_pk_bf16_f32 v17, v222, v223
v_lshlrev_b32 v224, 16, v18
v_and_b32 v225, s31, v18
v_lshlrev_b32 v226, 16, v19
v_and_b32 v227, s31, v19
v_pk_mul_f32 v[224:225], v[224:225], s[38:39]
v_pk_mul_f32 v[226:227], v[226:227], s[38:39]
v_cvt_pk_bf16_f32 v18, v224, v225
v_cvt_pk_bf16_f32 v19, v226, v227
v_lshlrev_b32 v220, 16, v20
v_and_b32 v221, s31, v20
v_lshlrev_b32 v222, 16, v21
v_and_b32 v223, s31, v21
v_pk_mul_f32 v[220:221], v[220:221], s[38:39]
v_pk_mul_f32 v[222:223], v[222:223], s[38:39]
v_cvt_pk_bf16_f32 v20, v220, v221
v_cvt_pk_bf16_f32 v21, v222, v223
v_lshlrev_b32 v224, 16, v22
v_and_b32 v225, s31, v22
v_lshlrev_b32 v226, 16, v23
v_and_b32 v227, s31, v23
v_pk_mul_f32 v[224:225], v[224:225], s[38:39]
v_pk_mul_f32 v[226:227], v[226:227], s[38:39]
v_cvt_pk_bf16_f32 v22, v224, v225
v_cvt_pk_bf16_f32 v23, v226, v227
v_lshlrev_b32 v220, 16, v24
v_and_b32 v221, s31, v24
v_lshlrev_b32 v222, 16, v25
v_and_b32 v223, s31, v25
v_pk_mul_f32 v[220:221], v[220:221], s[38:39]
v_pk_mul_f32 v[222:223], v[222:223], s[38:39]
v_cvt_pk_bf16_f32 v24, v220, v221
v_cvt_pk_bf16_f32 v25, v222, v223
v_lshlrev_b32 v224, 16, v26
v_and_b32 v225, s31, v26
v_lshlrev_b32 v226, 16, v27
v_and_b32 v227, s31, v27
v_pk_mul_f32 v[224:225], v[224:225], s[38:39]
v_pk_mul_f32 v[226:227], v[226:227], s[38:39]
v_cvt_pk_bf16_f32 v26, v224, v225
v_cvt_pk_bf16_f32 v27, v226, v227
v_lshlrev_b32 v220, 16, v28
v_and_b32 v221, s31, v28
v_lshlrev_b32 v222, 16, v29
v_and_b32 v223, s31, v29
v_pk_mul_f32 v[220:221], v[220:221], s[38:39]
v_pk_mul_f32 v[222:223], v[222:223], s[38:39]
v_cvt_pk_bf16_f32 v28, v220, v221
v_cvt_pk_bf16_f32 v29, v222, v223
v_lshlrev_b32 v224, 16, v30
v_and_b32 v225, s31, v30
v_lshlrev_b32 v226, 16, v31
v_and_b32 v227, s31, v31
v_pk_mul_f32 v[224:225], v[224:225], s[38:39]
v_pk_mul_f32 v[226:227], v[226:227], s[38:39]
v_cvt_pk_bf16_f32 v30, v224, v225
v_cvt_pk_bf16_f32 v31, v226, v227
v_mov_b32 v10, 0
v_mfma_f32_16x16x32_bf16 v[184:187], a[224:227], v[48:51], -4.0
ds_read_b128 a[204:207], v1 offset:768
v_add_f32 v11, v11, v180
v_mfma_f32_16x16x32_bf16 v[184:187], a[228:231], v[52:55], v[184:187]
buffer_load_dwordx4 v4, s[8:11], s21 offen offset:3072 nt lds
v_exp_f32 v181, v181
v_mfma_f32_16x16x32_bf16 v[184:187], a[232:235], v[56:59], v[184:187]
s_add_u32 m0, s22, 4096
v_cvt_pk_bf16_f32 v194, v180, v181
v_add_f32 v11, v11, v181
v_mfma_f32_16x16x32_bf16 v[184:187], a[236:239], v[60:63], v[184:187]
buffer_load_dwordx4 v3, s[8:11], s24 offen offset:0 nt lds
v_exp_f32 v182, v182
v_mfma_f32_16x16x32_bf16 v[188:191], a[240:243], v[48:51], -4.0
ds_read_b128 a[208:211], v1 offset:4096
v_add_f32 v11, v11, v182
v_mfma_f32_16x16x32_bf16 v[188:191], a[244:247], v[52:55], v[188:191]
buffer_load_dwordx4 v3, s[8:11], s24 offen offset:1024 nt lds
v_exp_f32 v183, v183
v_mfma_f32_16x16x32_bf16 v[188:191], a[248:251], v[56:59], v[188:191]
v_cvt_pk_bf16_f32 v195, v182, v183
v_add_f32 v11, v11, v183
v_mfma_f32_16x16x32_bf16 v[188:191], a[252:255], v[60:63], v[188:191]
buffer_load_dwordx4 v4, s[8:11], s24 offen offset:2048 nt lds
v_exp_f32 v184, v184
v_mfma_f32_16x16x32_bf16 a[32:35], a[160:163], v[192:195], a[32:35]
ds_read_b128 a[212:215], v1 offset:4352
v_add_f32 v12, v12, v184
v_mfma_f32_16x16x32_bf16 a[36:39], a[164:167], v[192:195], a[36:39]
ds_read_b128 a[216:219], v1 offset:4608
v_exp_f32 v185, v185
v_mfma_f32_16x16x32_bf16 a[40:43], a[168:171], v[192:195], a[40:43]
buffer_load_dwordx4 v4, s[8:11], s24 offen offset:3072 nt lds
v_cvt_pk_bf16_f32 v196, v184, v185
v_add_f32 v12, v12, v185
v_mfma_f32_16x16x32_bf16 a[44:47], a[172:175], v[192:195], a[44:47]
s_add_u32 m0, s23, 0
v_exp_f32 v186, v186
v_mfma_f32_16x16x32_bf16 a[48:51], a[176:179], v[192:195], a[48:51]
ds_read_b128 a[220:223], v1 offset:4864
v_add_f32 v12, v12, v186
v_mfma_f32_16x16x32_bf16 a[52:55], a[180:183], v[192:195], a[52:55]
buffer_load_dwordx4 v3, s[12:15], s21 offen offset:0 nt lds
v_exp_f32 v187, v187
v_mfma_f32_16x16x32_bf16 a[56:59], a[184:187], v[192:195], a[56:59]
s_add_u32 m0, s23, 8
v_cvt_pk_bf16_f32 v197, v186, v187
v_add_f32 v12, v12, v187
v_mfma_f32_16x16x32_bf16 a[60:63], a[188:191], v[192:195], a[60:63]
buffer_load_dwordx4 v3, s[12:15], s21 offen offset:1024 nt lds
v_exp_f32 v188, v188
v_mfma_f32_16x16x4_f32 v[200:203], v7, v11, 0
s_waitcnt vmcnt(62)
ds_read_b128 v[32:35], v8 offset:4096
ds_read_b128 v[36:39], v8 offset:4352
ds_read_b128 v[40:43], v8 offset:4608
ds_read_b128 v[44:47], v8 offset:4864
v_accvgpr_read_b32 v204, a32
v_accvgpr_read_b32 v205, a33
v_accvgpr_read_b32 v206, a34
v_accvgpr_read_b32 v207, a35
v_accvgpr_read_b32 v208, a36
v_accvgpr_read_b32 v209, a37
v_accvgpr_read_b32 v210, a38
v_accvgpr_read_b32 v211, a39
L_pad10:
s_cbranch_execz L_pad14
v_rcp_f32 v200, v200
v_subrev_u32 v202, s47, v201
v_max_u32 v9, v9, v202
v_accvgpr_read_b32 v212, a40
v_accvgpr_read_b32 v213, a41
v_accvgpr_read_b32 v214, a42
v_accvgpr_read_b32 v215, a43
v_accvgpr_read_b32 v216, a44
v_accvgpr_read_b32 v217, a45
v_accvgpr_read_b32 v218, a46
v_accvgpr_read_b32 v219, a47
v_pk_mul_f32 v[204:205], v[204:205], v[200:201] op_sel_hi:[1,0]
v_pk_mul_f32 v[206:207], v[206:207], v[200:201] op_sel_hi:[1,0]
v_pk_mul_f32 v[208:209], v[208:209], v[200:201] op_sel_hi:[1,0]
v_pk_mul_f32 v[210:211], v[210:211], v[200:201] op_sel_hi:[1,0]
v_cvt_pk_bf16_f32 v220, v204, v205
v_cvt_pk_bf16_f32 v221, v206, v207
v_cvt_pk_bf16_f32 v222, v208, v209
v_cvt_pk_bf16_f32 v223, v210, v211
ds_write_b128 v233, v[220:223] offset:4096
v_accvgpr_read_b32 v204, a48
v_accvgpr_read_b32 v205, a49
v_accvgpr_read_b32 v206, a50
v_accvgpr_read_b32 v207, a51
v_accvgpr_read_b32 v208, a52
v_accvgpr_read_b32 v209, a53
v_accvgpr_read_b32 v210, a54
v_accvgpr_read_b32 v211, a55
v_pk_mul_f32 v[212:213], v[212:213], v[200:201] op_sel_hi:[1,0]
v_pk_mul_f32 v[214:215], v[214:215], v[200:201] op_sel_hi:[1,0]
v_pk_mul_f32 v[216:217], v[216:217], v[200:201] op_sel_hi:[1,0]
v_pk_mul_f32 v[218:219], v[218:219], v[200:201] op_sel_hi:[1,0]
v_mfma_f32_32x32x16_bf16 a[32:47], v[228:231], v[228:231], 0
v_cvt_pk_bf16_f32 v224, v212, v213
v_cvt_pk_bf16_f32 v225, v214, v215
v_cvt_pk_bf16_f32 v226, v216, v217
v_cvt_pk_bf16_f32 v227, v218, v219
ds_write_b128 v234, v[224:227] offset:4096
v_accvgpr_read_b32 v212, a56
v_accvgpr_read_b32 v213, a57
v_accvgpr_read_b32 v214, a58
v_accvgpr_read_b32 v215, a59
v_accvgpr_read_b32 v216, a60
v_accvgpr_read_b32 v217, a61
v_accvgpr_read_b32 v218, a62
v_accvgpr_read_b32 v219, a63
v_pk_mul_f32 v[204:205], v[204:205], v[200:201] op_sel_hi:[1,0]
v_pk_mul_f32 v[206:207], v[206:207], v[200:201] op_sel_hi:[1,0]
v_pk_mul_f32 v[208:209], v[208:209], v[200:201] op_sel_hi:[1,0]
v_pk_mul_f32 v[210:211], v[210:211], v[200:201] op_sel_hi:[1,0]
v_cvt_pk_bf16_f32 v220, v204, v205
v_cvt_pk_bf16_f32 v221, v206, v207
v_cvt_pk_bf16_f32 v222, v208, v209
v_cvt_pk_bf16_f32 v223, v210, v211
ds_write_b128 v233, v[220:223] offset:4224
v_pk_mul_f32 v[212:213], v[212:213], v[200:201] op_sel_hi:[1,0]
v_pk_mul_f32 v[214:215], v[214:215], v[200:201] op_sel_hi:[1,0]
v_pk_mul_f32 v[216:217], v[216:217], v[200:201] op_sel_hi:[1,0]
v_pk_mul_f32 v[218:219], v[218:219], v[200:201] op_sel_hi:[1,0]
v_mfma_f32_32x32x16_bf16 a[48:63], v[228:231], v[228:231], 0
v_cvt_pk_bf16_f32 v224, v212, v213
v_cvt_pk_bf16_f32 v225, v214, v215
v_cvt_pk_bf16_f32 v226, v216, v217
v_cvt_pk_bf16_f32 v227, v218, v219
ds_write_b128 v234, v[224:227] offset:4224
s_waitcnt lgkmcnt(4)
v_lshlrev_b32 v220, 16, v32
v_and_b32 v221, s31, v32
v_lshlrev_b32 v222, 16, v33
v_and_b32 v223, s31, v33
v_pk_mul_f32 v[220:221], v[220:221], s[38:39]
v_pk_mul_f32 v[222:223], v[222:223], s[38:39]
v_cvt_pk_bf16_f32 v32, v220, v221
v_cvt_pk_bf16_f32 v33, v222, v223
v_lshlrev_b32 v224, 16, v34
v_and_b32 v225, s31, v34
v_lshlrev_b32 v226, 16, v35
v_and_b32 v227, s31, v35
v_pk_mul_f32 v[224:225], v[224:225], s[38:39]
v_pk_mul_f32 v[226:227], v[226:227], s[38:39]
v_cvt_pk_bf16_f32 v34, v224, v225
v_cvt_pk_bf16_f32 v35, v226, v227
v_lshlrev_b32 v220, 16, v36
v_and_b32 v221, s31, v36
v_lshlrev_b32 v222, 16, v37
v_and_b32 v223, s31, v37
v_pk_mul_f32 v[220:221], v[220:221], s[38:39]
v_pk_mul_f32 v[222:223], v[222:223], s[38:39]
v_cvt_pk_bf16_f32 v36, v220, v221
v_cvt_pk_bf16_f32 v37, v222, v223
v_lshlrev_b32 v224, 16, v38
v_and_b32 v225, s31, v38
v_lshlrev_b32 v226, 16, v39
v_and_b32 v227, s31, v39
v_pk_mul_f32 v[224:225], v[224:225], s[38:39]
v_pk_mul_f32 v[226:227], v[226:227], s[38:39]
v_cvt_pk_bf16_f32 v38, v224, v225
v_cvt_pk_bf16_f32 v39, v226, v227
v_lshlrev_b32 v220, 16, v40
v_and_b32 v221, s31, v40
v_lshlrev_b32 v222, 16, v41
v_and_b32 v223, s31, v41
v_pk_mul_f32 v[220:221], v[220:221], s[38:39]
v_pk_mul_f32 v[222:223], v[222:223], s[38:39]
v_cvt_pk_bf16_f32 v40, v220, v221
v_cvt_pk_bf16_f32 v41, v222, v223
v_lshlrev_b32 v224, 16, v42
v_and_b32 v225, s31, v42
v_lshlrev_b32 v226, 16, v43
v_and_b32 v227, s31, v43
v_pk_mul_f32 v[224:225], v[224:225], s[38:39]
v_pk_mul_f32 v[226:227], v[226:227], s[38:39]
v_cvt_pk_bf16_f32 v42, v224, v225
v_cvt_pk_bf16_f32 v43, v226, v227
v_lshlrev_b32 v220, 16, v44
v_and_b32 v221, s31, v44
v_lshlrev_b32 v222, 16, v45
v_and_b32 v223, s31, v45
v_pk_mul_f32 v[220:221], v[220:221], s[38:39]
v_pk_mul_f32 v[222:223], v[222:223], s[38:39]
v_cvt_pk_bf16_f32 v44, v220, v221
v_cvt_pk_bf16_f32 v45, v222, v223
v_lshlrev_b32 v224, 16, v46
v_and_b32 v225, s31, v46
v_lshlrev_b32 v226, 16, v47
v_and_b32 v227, s31, v47
v_pk_mul_f32 v[224:225], v[224:225], s[38:39]
v_pk_mul_f32 v[226:227], v[226:227], s[38:39]
v_cvt_pk_bf16_f32 v46, v224, v225
v_cvt_pk_bf16_f32 v47, v226, v227
v_mov_b32 v11, 0
v_mfma_f32_16x16x32_bf16 v[176:179], a[224:227], v[64:67], -4.0
ds_read_b64_tr_b16 a[128:129], v2 offset:0
v_add_f32 v12, v12, v188
v_mfma_f32_16x16x32_bf16 v[176:179], a[228:231], v[68:71], v[176:179]
s_add_u32 m0, s23, 16
v_exp_f32 v189, v189
v_mfma_f32_16x16x32_bf16 v[176:179], a[232:235], v[72:75], v[176:179]
buffer_load_dwordx4 v3, s[12:15], s21 offen offset:2048 nt lds
v_cvt_pk_bf16_f32 v198, v188, v189
v_add_f32 v12, v12, v189
v_mfma_f32_16x16x32_bf16 v[176:179], a[236:239], v[76:79], v[176:179]
ds_read_b64_tr_b16 a[130:131], v2 offset:4128
v_exp_f32 v190, v190
v_mfma_f32_16x16x32_bf16 v[180:183], a[240:243], v[64:67], -4.0
ds_read_b64_tr_b16 a[132:133], v2 offset:8
v_add_f32 v12, v12, v190
v_mfma_f32_16x16x32_bf16 v[180:183], a[244:247], v[68:71], v[180:183]
s_add_u32 m0, s23, 24
v_exp_f32 v191, v191
v_mfma_f32_16x16x32_bf16 v[180:183], a[248:251], v[72:75], v[180:183]
buffer_load_dwordx4 v3, s[12:15], s21 offen offset:3072 nt lds
v_cvt_pk_bf16_f32 v199, v190, v191
v_add_f32 v12, v12, v191
v_mfma_f32_16x16x32_bf16 v[180:183], a[252:255], v[76:79], v[180:183]
s_add_u32 m0, s23, 4128
v_exp_f32 v176, v176
v_mfma_f32_16x16x32_bf16 a[64:67], a[160:163], v[196:199], a[64:67]
ds_read_b64_tr_b16 a[134:135], v2 offset:4136
v_add_f32 v13, v13, v176
v_mfma_f32_16x16x32_bf16 a[68:71], a[164:167], v[196:199], a[68:71]
buffer_load_dwordx4 v3, s[12:15], s24 offen offset:0 nt lds
v_exp_f32 v177, v177
v_mfma_f32_16x16x32_bf16 a[72:75], a[168:171], v[196:199], a[72:75]
s_add_u32 m0, s23, 4136
v_cvt_pk_bf16_f32 v192, v176, v177
v_add_f32 v13, v13, v177
v_mfma_f32_16x16x32_bf16 a[76:79], a[172:175], v[196:199], a[76:79]
buffer_load_dwordx4 v3, s[12:15], s24 offen offset:1024 nt lds
v_exp_f32 v178, v178
v_mfma_f32_16x16x32_bf16 a[80:83], a[176:179], v[196:199], a[80:83]
ds_read_b64_tr_b16 a[136:137], v2 offset:256
v_add_f32 v13, v13, v178
v_mfma_f32_16x16x32_bf16 a[84:87], a[180:183], v[196:199], a[84:87]
s_add_u32 m0, s23, 4144
v_exp_f32 v179, v179
v_mfma_f32_16x16x32_bf16 a[88:91], a[184:187], v[196:199], a[88:91]
buffer_load_dwordx4 v3, s[12:15], s24 offen offset:2048 nt lds
v_cvt_pk_bf16_f32 v193, v178, v179
v_add_f32 v13, v13, v179
v_mfma_f32_16x16x32_bf16 a[92:95], a[188:191], v[196:199], a[92:95]
ds_read_b64_tr_b16 a[138:139], v2 offset:4384
v_exp_f32 v180, v180
v_mfma_f32_16x16x4_f32 v[200:203], v7, v12, 0
s_waitcnt vmcnt(62)
ds_read_b128 v[48:51], v8 offset:8192
ds_read_b128 v[52:55], v8 offset:8448
ds_read_b128 v[56:59], v8 offset:8704
ds_read_b128 v[60:63], v8 offset:8960
v_accvgpr_read_b32 v204, a64
v_accvgpr_read_b32 v205, a65
v_accvgpr_read_b32 v206, a66
v_accvgpr_read_b32 v207, a67
v_accvgpr_read_b32 v208, a68
v_accvgpr_read_b32 v209, a69
v_accvgpr_read_b32 v210, a70
v_accvgpr_read_b32 v211, a71
v_rcp_f32 v200, v200
v_subrev_u32 v202, s47, v201
v_max_u32 v9, v9, v202
v_accvgpr_read_b32 v212, a72
v_accvgpr_read_b32 v213, a73
v_accvgpr_read_b32 v214, a74
v_accvgpr_read_b32 v215, a75
v_accvgpr_read_b32 v216, a76
v_accvgpr_read_b32 v217, a77
v_accvgpr_read_b32 v218, a78
v_accvgpr_read_b32 v219, a79
v_pk_mul_f32 v[204:205], v[204:205], v[200:201] op_sel_hi:[1,0]
v_pk_mul_f32 v[206:207], v[206:207], v[200:201] op_sel_hi:[1,0]
v_pk_mul_f32 v[208:209], v[208:209], v[200:201] op_sel_hi:[1,0]
v_pk_mul_f32 v[210:211], v[210:211], v[200:201] op_sel_hi:[1,0]
v_cvt_pk_bf16_f32 v220, v204, v205
v_cvt_pk_bf16_f32 v221, v206, v207
v_cvt_pk_bf16_f32 v222, v208, v209
v_cvt_pk_bf16_f32 v223, v210, v211
ds_write_b128 v233, v[220:223] offset:8192
v_accvgpr_read_b32 v204, a80
v_accvgpr_read_b32 v205, a81
v_accvgpr_read_b32 v206, a82
v_accvgpr_read_b32 v207, a83
v_accvgpr_read_b32 v208, a84
v_accvgpr_read_b32 v209, a85
v_accvgpr_read_b32 v210, a86
v_accvgpr_read_b32 v211, a87
v_pk_mul_f32 v[212:213], v[212:213], v[200:201] op_sel_hi:[1,0]
v_pk_mul_f32 v[214:215], v[214:215], v[200:201] op_sel_hi:[1,0]
v_pk_mul_f32 v[216:217], v[216:217], v[200:201] op_sel_hi:[1,0]
v_pk_mul_f32 v[218:219], v[218:219], v[200:201] op_sel_hi:[1,0]
v_mfma_f32_32x32x16_bf16 a[64:79], v[228:231], v[228:231], 0
v_cvt_pk_bf16_f32 v224, v212, v213
v_cvt_pk_bf16_f32 v225, v214, v215
v_cvt_pk_bf16_f32 v226, v216, v217
v_cvt_pk_bf16_f32 v227, v218, v219
ds_write_b128 v234, v[224:227] offset:8192
v_accvgpr_read_b32 v212, a88
v_accvgpr_read_b32 v213, a89
v_accvgpr_read_b32 v214, a90
v_accvgpr_read_b32 v215, a91
v_accvgpr_read_b32 v216, a92
v_accvgpr_read_b32 v217, a93
v_accvgpr_read_b32 v218, a94
v_accvgpr_read_b32 v219, a95
v_pk_mul_f32 v[204:205], v[204:205], v[200:201] op_sel_hi:[1,0]
v_pk_mul_f32 v[206:207], v[206:207], v[200:201] op_sel_hi:[1,0]
v_pk_mul_f32 v[208:209], v[208:209], v[200:201] op_sel_hi:[1,0]
v_pk_mul_f32 v[210:211], v[210:211], v[200:201] op_sel_hi:[1,0]
v_cvt_pk_bf16_f32 v220, v204, v205
v_cvt_pk_bf16_f32 v221, v206, v207
v_cvt_pk_bf16_f32 v222, v208, v209
v_cvt_pk_bf16_f32 v223, v210, v211
ds_write_b128 v233, v[220:223] offset:8320
v_pk_mul_f32 v[212:213], v[212:213], v[200:201] op_sel_hi:[1,0]
v_pk_mul_f32 v[214:215], v[214:215], v[200:201] op_sel_hi:[1,0]
v_pk_mul_f32 v[216:217], v[216:217], v[200:201] op_sel_hi:[1,0]
v_pk_mul_f32 v[218:219], v[218:219], v[200:201] op_sel_hi:[1,0]
v_mfma_f32_32x32x16_bf16 a[80:95], v[228:231], v[228:231], 0
v_cvt_pk_bf16_f32 v224, v212, v213
v_cvt_pk_bf16_f32 v225, v214, v215
v_cvt_pk_bf16_f32 v226, v216, v217
v_cvt_pk_bf16_f32 v227, v218, v219
ds_write_b128 v234, v[224:227] offset:8320
s_waitcnt lgkmcnt(4)
v_lshlrev_b32 v220, 16, v48
v_and_b32 v221, s31, v48
v_lshlrev_b32 v222, 16, v49
v_and_b32 v223, s31, v49
v_pk_mul_f32 v[220:221], v[220:221], s[38:39]
v_pk_mul_f32 v[222:223], v[222:223], s[38:39]
v_cvt_pk_bf16_f32 v48, v220, v221
v_cvt_pk_bf16_f32 v49, v222, v223
v_lshlrev_b32 v224, 16, v50
v_and_b32 v225, s31, v50
v_lshlrev_b32 v226, 16, v51
v_and_b32 v227, s31, v51
v_pk_mul_f32 v[224:225], v[224:225], s[38:39]
v_pk_mul_f32 v[226:227], v[226:227], s[38:39]
v_cvt_pk_bf16_f32 v50, v224, v225
v_cvt_pk_bf16_f32 v51, v226, v227
v_lshlrev_b32 v220, 16, v52
v_and_b32 v221, s31, v52
v_lshlrev_b32 v222, 16, v53
v_and_b32 v223, s31, v53
v_pk_mul_f32 v[220:221], v[220:221], s[38:39]
v_pk_mul_f32 v[222:223], v[222:223], s[38:39]
v_cvt_pk_bf16_f32 v52, v220, v221
v_cvt_pk_bf16_f32 v53, v222, v223
v_lshlrev_b32 v224, 16, v54
v_and_b32 v225, s31, v54
v_lshlrev_b32 v226, 16, v55
v_and_b32 v227, s31, v55
v_pk_mul_f32 v[224:225], v[224:225], s[38:39]
v_pk_mul_f32 v[226:227], v[226:227], s[38:39]
v_cvt_pk_bf16_f32 v54, v224, v225
v_cvt_pk_bf16_f32 v55, v226, v227
v_lshlrev_b32 v220, 16, v56
v_and_b32 v221, s31, v56
v_lshlrev_b32 v222, 16, v57
v_and_b32 v223, s31, v57
v_pk_mul_f32 v[220:221], v[220:221], s[38:39]
v_pk_mul_f32 v[222:223], v[222:223], s[38:39]
v_cvt_pk_bf16_f32 v56, v220, v221
v_cvt_pk_bf16_f32 v57, v222, v223
v_lshlrev_b32 v224, 16, v58
v_and_b32 v225, s31, v58
v_lshlrev_b32 v226, 16, v59
v_and_b32 v227, s31, v59
v_pk_mul_f32 v[224:225], v[224:225], s[38:39]
v_pk_mul_f32 v[226:227], v[226:227], s[38:39]
v_cvt_pk_bf16_f32 v58, v224, v225
v_cvt_pk_bf16_f32 v59, v226, v227
v_lshlrev_b32 v220, 16, v60
v_and_b32 v221, s31, v60
v_lshlrev_b32 v222, 16, v61
v_and_b32 v223, s31, v61
v_pk_mul_f32 v[220:221], v[220:221], s[38:39]
v_pk_mul_f32 v[222:223], v[222:223], s[38:39]
v_cvt_pk_bf16_f32 v60, v220, v221
v_cvt_pk_bf16_f32 v61, v222, v223
v_lshlrev_b32 v224, 16, v62
v_and_b32 v225, s31, v62
v_lshlrev_b32 v226, 16, v63
v_and_b32 v227, s31, v63
v_pk_mul_f32 v[224:225], v[224:225], s[38:39]
v_pk_mul_f32 v[226:227], v[226:227], s[38:39]
v_cvt_pk_bf16_f32 v62, v224, v225
v_cvt_pk_bf16_f32 v63, v226, v227
v_mov_b32 v12, 0
v_mfma_f32_16x16x32_bf16 v[184:187], a[224:227], v[80:83], -4.0
ds_read_b64_tr_b16 a[140:141], v2 offset:264
v_add_f32 v13, v13, v180
v_mfma_f32_16x16x32_bf16 v[184:187], a[228:231], v[84:87], v[184:187]
s_add_u32 m0, s23, 4152
v_exp_f32 v181, v181
v_mfma_f32_16x16x32_bf16 v[184:187], a[232:235], v[88:91], v[184:187]
buffer_load_dwordx4 v3, s[12:15], s24 offen offset:3072 nt lds
v_cvt_pk_bf16_f32 v194, v180, v181
v_add_f32 v13, v13, v181
s_add_u32 s22, s22, 8192
s_and_b32 s22, s22, 0x7fff
s_add_u32 s21, s21, 8192
s_add_u32 s23, s23, 8256
s_cmp_eq_u32 s23, s35
s_cselect_b32 s23, s34, s23
v_mfma_f32_16x16x32_bf16 v[184:187], a[236:239], v[92:95], v[184:187]
v_exp_f32 v182, v182
v_mfma_f32_16x16x32_bf16 v[188:191], a[240:243], v[80:83], -4.0
ds_read_b64_tr_b16 a[142:143], v2 offset:4392
v_add_f32 v13, v13, v182
v_mfma_f32_16x16x32_bf16 v[188:191], a[244:247], v[84:87], v[188:191]
v_exp_f32 v183, v183
v_mfma_f32_16x16x32_bf16 v[188:191], a[248:251], v[88:91], v[188:191]
v_cvt_pk_bf16_f32 v195, v182, v183
v_add_f32 v13, v13, v183
v_mfma_f32_16x16x32_bf16 v[188:191], a[252:255], v[92:95], v[188:191]
v_exp_f32 v184, v184
v_mfma_f32_16x16x32_bf16 v[112:115], a[160:163], v[192:195], v[112:115]
ds_read_b64_tr_b16 a[144:145], v2 offset:512
v_add_f32 v14, v14, v184
v_mfma_f32_16x16x32_bf16 v[116:119], a[164:167], v[192:195], v[116:119]
v_exp_f32 v185, v185
v_mfma_f32_16x16x32_bf16 v[120:123], a[168:171], v[192:195], v[120:123]
ds_read_b64_tr_b16 a[146:147], v2 offset:4640
v_cvt_pk_bf16_f32 v196, v184, v185
v_add_f32 v14, v14, v185
v_mfma_f32_16x16x32_bf16 v[124:127], a[172:175], v[192:195], v[124:127]
v_exp_f32 v186, v186
v_mfma_f32_16x16x32_bf16 v[128:131], a[176:179], v[192:195], v[128:131]
ds_read_b64_tr_b16 a[148:149], v2 offset:520
v_add_f32 v14, v14, v186
v_mfma_f32_16x16x32_bf16 v[132:135], a[180:183], v[192:195], v[132:135]
v_exp_f32 v187, v187
v_mfma_f32_16x16x32_bf16 v[136:139], a[184:187], v[192:195], v[136:139]
v_cvt_pk_bf16_f32 v197, v186, v187
v_add_f32 v14, v14, v187
v_mfma_f32_16x16x32_bf16 v[140:143], a[188:191], v[192:195], v[140:143]
s_waitcnt lgkmcnt(8)
v_exp_f32 v188, v188
v_mfma_f32_16x16x4_f32 v[200:203], v7, v13, 0
s_waitcnt vmcnt(62)
ds_read_b128 v[64:67], v8 offset:12288
ds_read_b128 v[68:71], v8 offset:12544
ds_read_b128 v[72:75], v8 offset:12800
ds_read_b128 v[76:79], v8 offset:13056
s_nop 4
v_rcp_f32 v200, v200
v_subrev_u32 v202, s47, v201
v_max_u32 v9, v9, v202
v_pk_mul_f32 v[112:113], v[112:113], v[200:201] op_sel_hi:[1,0]
v_pk_mul_f32 v[114:115], v[114:115], v[200:201] op_sel_hi:[1,0]
v_pk_mul_f32 v[116:117], v[116:117], v[200:201] op_sel_hi:[1,0]
v_pk_mul_f32 v[118:119], v[118:119], v[200:201] op_sel_hi:[1,0]
v_cvt_pk_bf16_f32 v220, v112, v113
v_cvt_pk_bf16_f32 v221, v114, v115
v_cvt_pk_bf16_f32 v222, v116, v117
v_cvt_pk_bf16_f32 v223, v118, v119
ds_write_b128 v233, v[220:223] offset:12288
v_pk_mul_f32 v[120:121], v[120:121], v[200:201] op_sel_hi:[1,0]
v_pk_mul_f32 v[122:123], v[122:123], v[200:201] op_sel_hi:[1,0]
v_pk_mul_f32 v[124:125], v[124:125], v[200:201] op_sel_hi:[1,0]
v_pk_mul_f32 v[126:127], v[126:127], v[200:201] op_sel_hi:[1,0]
v_cvt_pk_bf16_f32 v224, v120, v121
v_cvt_pk_bf16_f32 v225, v122, v123
v_cvt_pk_bf16_f32 v226, v124, v125
v_cvt_pk_bf16_f32 v227, v126, v127
ds_write_b128 v234, v[224:227] offset:12288
v_pk_mul_f32 v[128:129], v[128:129], v[200:201] op_sel_hi:[1,0]
v_pk_mul_f32 v[130:131], v[130:131], v[200:201] op_sel_hi:[1,0]
v_pk_mul_f32 v[132:133], v[132:133], v[200:201] op_sel_hi:[1,0]
v_pk_mul_f32 v[134:135], v[134:135], v[200:201] op_sel_hi:[1,0]
v_cvt_pk_bf16_f32 v220, v128, v129
v_cvt_pk_bf16_f32 v221, v130, v131
v_cvt_pk_bf16_f32 v222, v132, v133
v_cvt_pk_bf16_f32 v223, v134, v135
ds_write_b128 v233, v[220:223] offset:12416
v_pk_mul_f32 v[136:137], v[136:137], v[200:201] op_sel_hi:[1,0]
v_pk_mul_f32 v[138:139], v[138:139], v[200:201] op_sel_hi:[1,0]
v_pk_mul_f32 v[140:141], v[140:141], v[200:201] op_sel_hi:[1,0]
v_pk_mul_f32 v[142:143], v[142:143], v[200:201] op_sel_hi:[1,0]
v_cvt_pk_bf16_f32 v224, v136, v137
v_cvt_pk_bf16_f32 v225, v138, v139
v_cvt_pk_bf16_f32 v226, v140, v141
v_cvt_pk_bf16_f32 v227, v142, v143
v_mfma_f32_32x32x16_bf16 v[112:127], v[228:231], v[228:231], 0
ds_write_b128 v234, v[224:227] offset:12416
s_waitcnt lgkmcnt(4)
v_lshlrev_b32 v220, 16, v64
v_and_b32 v221, s31, v64
v_lshlrev_b32 v222, 16, v65
v_and_b32 v223, s31, v65
v_pk_mul_f32 v[220:221], v[220:221], s[38:39]
v_pk_mul_f32 v[222:223], v[222:223], s[38:39]
v_cvt_pk_bf16_f32 v64, v220, v221
v_cvt_pk_bf16_f32 v65, v222, v223
v_lshlrev_b32 v224, 16, v66
v_and_b32 v225, s31, v66
v_lshlrev_b32 v226, 16, v67
v_and_b32 v227, s31, v67
v_pk_mul_f32 v[224:225], v[224:225], s[38:39]
v_pk_mul_f32 v[226:227], v[226:227], s[38:39]
v_cvt_pk_bf16_f32 v66, v224, v225
v_cvt_pk_bf16_f32 v67, v226, v227
v_lshlrev_b32 v220, 16, v68
v_and_b32 v221, s31, v68
v_lshlrev_b32 v222, 16, v69
v_and_b32 v223, s31, v69
v_pk_mul_f32 v[220:221], v[220:221], s[38:39]
v_pk_mul_f32 v[222:223], v[222:223], s[38:39]
v_cvt_pk_bf16_f32 v68, v220, v221
v_cvt_pk_bf16_f32 v69, v222, v223
v_lshlrev_b32 v224, 16, v70
v_and_b32 v225, s31, v70
v_lshlrev_b32 v226, 16, v71
v_and_b32 v227, s31, v71
v_pk_mul_f32 v[224:225], v[224:225], s[38:39]
v_pk_mul_f32 v[226:227], v[226:227], s[38:39]
v_cvt_pk_bf16_f32 v70, v224, v225
v_cvt_pk_bf16_f32 v71, v226, v227
v_lshlrev_b32 v220, 16, v72
v_and_b32 v221, s31, v72
v_lshlrev_b32 v222, 16, v73
v_and_b32 v223, s31, v73
v_pk_mul_f32 v[220:221], v[220:221], s[38:39]
v_pk_mul_f32 v[222:223], v[222:223], s[38:39]
v_cvt_pk_bf16_f32 v72, v220, v221
v_cvt_pk_bf16_f32 v73, v222, v223
v_lshlrev_b32 v224, 16, v74
v_and_b32 v225, s31, v74
v_lshlrev_b32 v226, 16, v75
v_and_b32 v227, s31, v75
v_pk_mul_f32 v[224:225], v[224:225], s[38:39]
v_pk_mul_f32 v[226:227], v[226:227], s[38:39]
v_cvt_pk_bf16_f32 v74, v224, v225
v_cvt_pk_bf16_f32 v75, v226, v227
v_lshlrev_b32 v220, 16, v76
v_and_b32 v221, s31, v76
v_lshlrev_b32 v222, 16, v77
v_and_b32 v223, s31, v77
v_pk_mul_f32 v[220:221], v[220:221], s[38:39]
v_pk_mul_f32 v[222:223], v[222:223], s[38:39]
v_cvt_pk_bf16_f32 v76, v220, v221
v_cvt_pk_bf16_f32 v77, v222, v223
v_lshlrev_b32 v224, 16, v78
v_and_b32 v225, s31, v78
v_lshlrev_b32 v226, 16, v79
v_and_b32 v227, s31, v79
v_pk_mul_f32 v[224:225], v[224:225], s[38:39]
v_pk_mul_f32 v[226:227], v[226:227], s[38:39]
v_cvt_pk_bf16_f32 v78, v224, v225
v_cvt_pk_bf16_f32 v79, v226, v227
v_mov_b32 v13, 0
v_mfma_f32_32x32x16_bf16 v[128:143], v[228:231], v[228:231], 0
v_mfma_f32_16x16x32_bf16 v[176:179], a[192:195], v[16:19], -4.0
ds_read_b64_tr_b16 a[150:151], v2 offset:4648
v_add_f32 v14, v14, v188
v_mfma_f32_16x16x32_bf16 v[176:179], a[196:199], v[20:23], v[176:179]
v_exp_f32 v189, v189
v_mfma_f32_16x16x32_bf16 v[176:179], a[200:203], v[24:27], v[176:179]
v_cvt_pk_bf16_f32 v198, v188, v189
v_add_f32 v14, v14, v189
v_mfma_f32_16x16x32_bf16 v[176:179], a[204:207], v[28:31], v[176:179]
v_exp_f32 v190, v190
v_mfma_f32_16x16x32_bf16 v[180:183], a[208:211], v[16:19], -4.0
ds_read_b64_tr_b16 a[152:153], v2 offset:768
v_add_f32 v14, v14, v190
v_mfma_f32_16x16x32_bf16 v[180:183], a[212:215], v[20:23], v[180:183]
v_exp_f32 v191, v191
v_mfma_f32_16x16x32_bf16 v[180:183], a[216:219], v[24:27], v[180:183]
ds_read_b64_tr_b16 a[154:155], v2 offset:4896
v_cvt_pk_bf16_f32 v199, v190, v191
v_add_f32 v14, v14, v191
v_mfma_f32_16x16x32_bf16 v[180:183], a[220:223], v[28:31], v[180:183]
v_exp_f32 v176, v176
v_mfma_f32_16x16x32_bf16 v[144:147], a[160:163], v[196:199], v[144:147]
ds_read_b64_tr_b16 a[156:157], v2 offset:776
v_mov_b32 v6, v176
v_mfma_f32_16x16x32_bf16 v[148:151], a[164:167], v[196:199], v[148:151]
v_exp_f32 v177, v177
v_mfma_f32_16x16x32_bf16 v[152:155], a[168:171], v[196:199], v[152:155]
v_cvt_pk_bf16_f32 v192, v176, v177
v_add_f32 v6, v6, v177
v_mfma_f32_16x16x32_bf16 v[156:159], a[172:175], v[196:199], v[156:159]
v_exp_f32 v178, v178
v_mfma_f32_16x16x32_bf16 v[160:163], a[176:179], v[196:199], v[160:163]
ds_read_b64_tr_b16 a[158:159], v2 offset:4904
v_add_f32 v6, v6, v178
v_mfma_f32_16x16x32_bf16 v[164:167], a[180:183], v[196:199], v[164:167]
v_exp_f32 v179, v179
v_mfma_f32_16x16x32_bf16 v[168:171], a[184:187], v[196:199], v[168:171]
v_cvt_pk_bf16_f32 v193, v178, v179
v_add_f32 v6, v6, v179
v_mfma_f32_16x16x32_bf16 v[172:175], a[188:191], v[196:199], v[172:175]
v_exp_f32 v180, v180
v_mfma_f32_16x16x4_f32 v[200:203], v7, v14, 0
s_waitcnt vmcnt(62)
ds_read_b128 v[80:83], v8 offset:16384
ds_read_b128 v[84:87], v8 offset:16640
ds_read_b128 v[88:91], v8 offset:16896
ds_read_b128 v[92:95], v8 offset:17152
s_nop 4
v_rcp_f32 v200, v200
v_subrev_u32 v202, s47, v201
v_max_u32 v9, v9, v202
v_pk_mul_f32 v[144:145], v[144:145], v[200:201] op_sel_hi:[1,0]
v_pk_mul_f32 v[146:147], v[146:147], v[200:201] op_sel_hi:[1,0]
v_pk_mul_f32 v[148:149], v[148:149], v[200:201] op_sel_hi:[1,0]
v_pk_mul_f32 v[150:151], v[150:151], v[200:201] op_sel_hi:[1,0]
v_cvt_pk_bf16_f32 v220, v144, v145
v_cvt_pk_bf16_f32 v221, v146, v147
v_cvt_pk_bf16_f32 v222, v148, v149
v_cvt_pk_bf16_f32 v223, v150, v151
ds_write_b128 v233, v[220:223] offset:16384
v_pk_mul_f32 v[152:153], v[152:153], v[200:201] op_sel_hi:[1,0]
v_pk_mul_f32 v[154:155], v[154:155], v[200:201] op_sel_hi:[1,0]
v_pk_mul_f32 v[156:157], v[156:157], v[200:201] op_sel_hi:[1,0]
v_pk_mul_f32 v[158:159], v[158:159], v[200:201] op_sel_hi:[1,0]
v_cvt_pk_bf16_f32 v224, v152, v153
v_cvt_pk_bf16_f32 v225, v154, v155
v_cvt_pk_bf16_f32 v226, v156, v157
v_cvt_pk_bf16_f32 v227, v158, v159
ds_write_b128 v234, v[224:227] offset:16384
v_pk_mul_f32 v[160:161], v[160:161], v[200:201] op_sel_hi:[1,0]
v_pk_mul_f32 v[162:163], v[162:163], v[200:201] op_sel_hi:[1,0]
v_pk_mul_f32 v[164:165], v[164:165], v[200:201] op_sel_hi:[1,0]
v_pk_mul_f32 v[166:167], v[166:167], v[200:201] op_sel_hi:[1,0]
v_cvt_pk_bf16_f32 v220, v160, v161
v_cvt_pk_bf16_f32 v221, v162, v163
v_cvt_pk_bf16_f32 v222, v164, v165
v_cvt_pk_bf16_f32 v223, v166, v167
ds_write_b128 v233, v[220:223] offset:16512
v_pk_mul_f32 v[168:169], v[168:169], v[200:201] op_sel_hi:[1,0]
v_pk_mul_f32 v[170:171], v[170:171], v[200:201] op_sel_hi:[1,0]
v_pk_mul_f32 v[172:173], v[172:173], v[200:201] op_sel_hi:[1,0]
v_pk_mul_f32 v[174:175], v[174:175], v[200:201] op_sel_hi:[1,0]
v_cvt_pk_bf16_f32 v224, v168, v169
v_cvt_pk_bf16_f32 v225, v170, v171
v_cvt_pk_bf16_f32 v226, v172, v173
v_cvt_pk_bf16_f32 v227, v174, v175
v_mfma_f32_32x32x16_bf16 v[144:159], v[228:231], v[228:231], 0
ds_write_b128 v234, v[224:227] offset:16512
s_waitcnt lgkmcnt(4)
v_lshlrev_b32 v220, 16, v80
v_and_b32 v221, s31, v80
v_lshlrev_b32 v222, 16, v81
v_and_b32 v223, s31, v81
v_pk_mul_f32 v[220:221], v[220:221], s[38:39]
v_pk_mul_f32 v[222:223], v[222:223], s[38:39]
v_cvt_pk_bf16_f32 v80, v220, v221
v_cvt_pk_bf16_f32 v81, v222, v223
v_lshlrev_b32 v224, 16, v82
v_and_b32 v225, s31, v82
v_lshlrev_b32 v226, 16, v83
v_and_b32 v227, s31, v83
v_pk_mul_f32 v[224:225], v[224:225], s[38:39]
v_pk_mul_f32 v[226:227], v[226:227], s[38:39]
v_cvt_pk_bf16_f32 v82, v224, v225
v_cvt_pk_bf16_f32 v83, v226, v227
v_lshlrev_b32 v220, 16, v84
v_and_b32 v221, s31, v84
v_lshlrev_b32 v222, 16, v85
v_and_b32 v223, s31, v85
v_pk_mul_f32 v[220:221], v[220:221], s[38:39]
v_pk_mul_f32 v[222:223], v[222:223], s[38:39]
v_cvt_pk_bf16_f32 v84, v220, v221
L_pad11:
s_cbranch_execz L_padret
v_cvt_pk_bf16_f32 v85, v222, v223
v_lshlrev_b32 v224, 16, v86
v_and_b32 v225, s31, v86
v_lshlrev_b32 v226, 16, v87
v_and_b32 v227, s31, v87
v_pk_mul_f32 v[224:225], v[224:225], s[38:39]
v_pk_mul_f32 v[226:227], v[226:227], s[38:39]
v_cvt_pk_bf16_f32 v86, v224, v225
v_cvt_pk_bf16_f32 v87, v226, v227
v_lshlrev_b32 v220, 16, v88
v_and_b32 v221, s31, v88
v_lshlrev_b32 v222, 16, v89
v_and_b32 v223, s31, v89
v_pk_mul_f32 v[220:221], v[220:221], s[38:39]
v_pk_mul_f32 v[222:223], v[222:223], s[38:39]
v_cvt_pk_bf16_f32 v88, v220, v221
v_cvt_pk_bf16_f32 v89, v222, v223
v_lshlrev_b32 v224, 16, v90
v_and_b32 v225, s31, v90
v_lshlrev_b32 v226, 16, v91
v_and_b32 v227, s31, v91
v_pk_mul_f32 v[224:225], v[224:225], s[38:39]
v_pk_mul_f32 v[226:227], v[226:227], s[38:39]
v_cvt_pk_bf16_f32 v90, v224, v225
v_cvt_pk_bf16_f32 v91, v226, v227
v_lshlrev_b32 v220, 16, v92
v_and_b32 v221, s31, v92
v_lshlrev_b32 v222, 16, v93
v_and_b32 v223, s31, v93
v_pk_mul_f32 v[220:221], v[220:221], s[38:39]
v_pk_mul_f32 v[222:223], v[222:223], s[38:39]
v_cvt_pk_bf16_f32 v92, v220, v221
v_cvt_pk_bf16_f32 v93, v222, v223
v_lshlrev_b32 v224, 16, v94
v_and_b32 v225, s31, v94
v_lshlrev_b32 v226, 16, v95
v_and_b32 v227, s31, v95
v_pk_mul_f32 v[224:225], v[224:225], s[38:39]
v_pk_mul_f32 v[226:227], v[226:227], s[38:39]
v_cvt_pk_bf16_f32 v94, v224, v225
v_cvt_pk_bf16_f32 v95, v226, v227
v_mov_b32 v14, 0
v_mfma_f32_32x32x16_bf16 v[160:175], v[228:231], v[228:231], 0
s_mov_b32 s29, 1
s_add_u32 s27, s27, 188416
s_mov_b32 s25, 0x7f000000
s_mov_b32 s37, 0
s_mov_b32 s26, 160000
s_mov_b32 s36, 6
s_mov_b32 s28, 0
s_mov_b32 s91, 1
s_sub_u32 s3, s27, 188416
.p2align 6
L_loop1B:
v_mfma_f32_16x16x32_bf16 v[184:187], a[192:195], v[32:35], -4.0
v_add_f32 v10, v10, v180
v_add_f32 v10, v10, v6
v_mfma_f32_16x16x32_bf16 v[184:187], a[196:199], v[36:39], v[184:187]
v_exp_f32 v181, v181
v_mfma_f32_16x16x32_bf16 v[184:187], a[200:203], v[40:43], v[184:187]
v_cvt_pk_bf16_f32 v194, v180, v181
v_add_f32 v10, v10, v181
v_mfma_f32_16x16x32_bf16 v[184:187], a[204:207], v[44:47], v[184:187]
v_exp_f32 v182, v182
v_mfma_f32_16x16x32_bf16 v[188:191], a[208:211], v[32:35], -4.0
v_add_f32 v10, v10, v182
v_mfma_f32_16x16x32_bf16 v[188:191], a[212:215], v[36:39], v[188:191]
v_exp_f32 v183, v183
v_mfma_f32_16x16x32_bf16 v[188:191], a[216:219], v[40:43], v[188:191]
s_waitcnt vmcnt(34) lgkmcnt(0)
v_cvt_pk_bf16_f32 v195, v182, v183
v_add_f32 v10, v10, v183
v_mfma_f32_16x16x32_bf16 v[188:191], a[220:223], v[44:47], v[188:191]
s_barrier
v_exp_f32 v184, v184
v_mfma_f32_16x16x32_bf16 a[0:3], a[128:131], v[192:195], a[0:3]
ds_read_b128 a[224:227], v1 offset:8192
v_add_f32 v11, v11, v184
v_mfma_f32_16x16x32_bf16 a[4:7], a[132:135], v[192:195], a[4:7]
s_mov_b32 m0, s22
v_exp_f32 v185, v185
v_mfma_f32_16x16x32_bf16 a[8:11], a[136:139], v[192:195], a[8:11]
s_add_u32 s24, s21, 4096
v_cvt_pk_bf16_f32 v196, v184, v185
v_add_f32 v11, v11, v185
v_mfma_f32_16x16x32_bf16 a[12:15], a[140:143], v[192:195], a[12:15]
buffer_load_dwordx4 v3, s[8:11], s21 offen offset:0 nt lds
v_exp_f32 v186, v186
v_mfma_f32_16x16x32_bf16 a[16:19], a[144:147], v[192:195], a[16:19]
ds_read_b128 a[228:231], v1 offset:8448
v_add_f32 v11, v11, v186
v_mfma_f32_16x16x32_bf16 a[20:23], a[148:151], v[192:195], a[20:23]
buffer_load_dwordx4 v3, s[8:11], s21 offen offset:1024 nt lds
v_exp_f32 v187, v187
v_mfma_f32_16x16x32_bf16 a[24:27], a[152:155], v[192:195], a[24:27]
ds_read_b128 a[232:235], v1 offset:8704
v_cvt_pk_bf16_f32 v197, v186, v187
v_add_f32 v11, v11, v187
v_mfma_f32_16x16x32_bf16 a[28:31], a[156:159], v[192:195], a[28:31]
buffer_load_dwordx4 v4, s[8:11], s21 offen offset:2048 nt lds
v_exp_f32 v188, v188
v_mfma_f32_16x16x32_bf16 v[176:179], a[192:195], v[48:51], -4.0
ds_read_b128 a[236:239], v1 offset:8960
v_add_f32 v11, v11, v188
v_mfma_f32_16x16x32_bf16 v[176:179], a[196:199], v[52:55], v[176:179]
buffer_load_dwordx4 v4, s[8:11], s21 offen offset:3072 nt lds
v_exp_f32 v189, v189
v_mfma_f32_16x16x32_bf16 v[176:179], a[200:203], v[56:59], v[176:179]
s_add_u32 m0, s22, 4096
v_cvt_pk_bf16_f32 v198, v188, v189
v_add_f32 v11, v11, v189
v_mfma_f32_16x16x32_bf16 v[176:179], a[204:207], v[60:63], v[176:179]
buffer_load_dwordx4 v3, s[8:11], s24 offen offset:0 nt lds
v_exp_f32 v190, v190
v_mfma_f32_16x16x32_bf16 v[180:183], a[208:211], v[48:51], -4.0
ds_read_b128 a[240:243], v1 offset:12288
v_add_f32 v11, v11, v190
v_mfma_f32_16x16x32_bf16 v[180:183], a[212:215], v[52:55], v[180:183]
buffer_load_dwordx4 v3, s[8:11], s24 offen offset:1024 nt lds
v_exp_f32 v191, v191
v_mfma_f32_16x16x32_bf16 v[180:183], a[216:219], v[56:59], v[180:183]
v_cvt_pk_bf16_f32 v199, v190, v191
v_add_f32 v11, v11, v191
v_mfma_f32_16x16x32_bf16 v[180:183], a[220:223], v[60:63], v[180:183]
buffer_load_dwordx4 v4, s[8:11], s24 offen offset:2048 nt lds
v_exp_f32 v176, v176
v_mfma_f32_16x16x32_bf16 a[32:35], a[128:131], v[196:199], a[32:35]
ds_read_b128 a[244:247], v1 offset:12544
v_add_f32 v12, v12, v176
v_mfma_f32_16x16x32_bf16 a[36:39], a[132:135], v[196:199], a[36:39]
ds_read_b128 a[248:251], v1 offset:12800
v_exp_f32 v177, v177
v_mfma_f32_16x16x32_bf16 a[40:43], a[136:139], v[196:199], a[40:43]
buffer_load_dwordx4 v4, s[8:11], s24 offen offset:3072 nt lds
v_cvt_pk_bf16_f32 v192, v176, v177
v_add_f32 v12, v12, v177
v_mfma_f32_16x16x32_bf16 a[44:47], a[140:143], v[196:199], a[44:47]
s_add_u32 m0, s23, 0
v_exp_f32 v178, v178
v_mfma_f32_16x16x32_bf16 a[48:51], a[144:147], v[196:199], a[48:51]
ds_read_b128 a[252:255], v1 offset:13056
v_add_f32 v12, v12, v178
v_mfma_f32_16x16x32_bf16 a[52:55], a[148:151], v[196:199], a[52:55]
buffer_load_dwordx4 v3, s[12:15], s21 offen offset:0 nt lds
v_exp_f32 v179, v179
v_mfma_f32_16x16x32_bf16 a[56:59], a[152:155], v[196:199], a[56:59]
s_add_u32 m0, s23, 8
v_cvt_pk_bf16_f32 v193, v178, v179
v_add_f32 v12, v12, v179
v_mfma_f32_16x16x32_bf16 a[60:63], a[156:159], v[196:199], a[60:63]
buffer_load_dwordx4 v3, s[12:15], s21 offen offset:1024 nt lds
v_exp_f32 v180, v180
v_mfma_f32_16x16x32_bf16 v[184:187], a[192:195], v[64:67], -4.0
ds_read_b64_tr_b16 a[160:161], v2 offset:8256
v_add_f32 v12, v12, v180
v_mfma_f32_16x16x32_bf16 v[184:187], a[196:199], v[68:71], v[184:187]
s_add_u32 m0, s23, 16
v_exp_f32 v181, v181
v_mfma_f32_16x16x32_bf16 v[184:187], a[200:203], v[72:75], v[184:187]
buffer_load_dwordx4 v3, s[12:15], s21 offen offset:2048 nt lds
v_cvt_pk_bf16_f32 v194, v180, v181
v_add_f32 v12, v12, v181
v_mfma_f32_16x16x32_bf16 v[184:187], a[204:207], v[76:79], v[184:187]
ds_read_b64_tr_b16 a[162:163], v2 offset:12384
v_exp_f32 v182, v182
v_mfma_f32_16x16x32_bf16 v[188:191], a[208:211], v[64:67], -4.0
ds_read_b64_tr_b16 a[164:165], v2 offset:8264
v_add_f32 v12, v12, v182
v_mfma_f32_16x16x32_bf16 v[188:191], a[212:215], v[68:71], v[188:191]
s_add_u32 m0, s23, 24
v_exp_f32 v183, v183
v_mfma_f32_16x16x32_bf16 v[188:191], a[216:219], v[72:75], v[188:191]
buffer_load_dwordx4 v3, s[12:15], s21 offen offset:3072 nt lds
v_cvt_pk_bf16_f32 v195, v182, v183
v_add_f32 v12, v12, v183
v_mfma_f32_16x16x32_bf16 v[188:191], a[220:223], v[76:79], v[188:191]
s_add_u32 m0, s23, 4128
v_exp_f32 v184, v184
v_mfma_f32_16x16x32_bf16 a[64:67], a[128:131], v[192:195], a[64:67]
ds_read_b64_tr_b16 a[166:167], v2 offset:12392
v_add_f32 v13, v13, v184
v_mfma_f32_16x16x32_bf16 a[68:71], a[132:135], v[192:195], a[68:71]
buffer_load_dwordx4 v3, s[12:15], s24 offen offset:0 nt lds
v_exp_f32 v185, v185
v_mfma_f32_16x16x32_bf16 a[72:75], a[136:139], v[192:195], a[72:75]
s_add_u32 m0, s23, 4136
v_cvt_pk_bf16_f32 v196, v184, v185
v_add_f32 v13, v13, v185
v_mfma_f32_16x16x32_bf16 a[76:79], a[140:143], v[192:195], a[76:79]
buffer_load_dwordx4 v3, s[12:15], s24 offen offset:1024 nt lds
v_exp_f32 v186, v186
v_mfma_f32_16x16x32_bf16 a[80:83], a[144:147], v[192:195], a[80:83]
ds_read_b64_tr_b16 a[168:169], v2 offset:8512
v_add_f32 v13, v13, v186
v_mfma_f32_16x16x32_bf16 a[84:87], a[148:151], v[192:195], a[84:87]
s_add_u32 m0, s23, 4144
v_exp_f32 v187, v187
v_mfma_f32_16x16x32_bf16 a[88:91], a[152:155], v[192:195], a[88:91]
buffer_load_dwordx4 v3, s[12:15], s24 offen offset:2048 nt lds
v_cvt_pk_bf16_f32 v197, v186, v187
v_add_f32 v13, v13, v187
v_mfma_f32_16x16x32_bf16 a[92:95], a[156:159], v[192:195], a[92:95]
ds_read_b64_tr_b16 a[170:171], v2 offset:12640
v_exp_f32 v188, v188
v_mfma_f32_16x16x32_bf16 v[176:179], a[192:195], v[80:83], -4.0
ds_read_b64_tr_b16 a[172:173], v2 offset:8520
v_add_f32 v13, v13, v188
v_mfma_f32_16x16x32_bf16 v[176:179], a[196:199], v[84:87], v[176:179]
s_add_u32 m0, s23, 4152
v_exp_f32 v189, v189
v_mfma_f32_16x16x32_bf16 v[176:179], a[200:203], v[88:91], v[176:179]
buffer_load_dwordx4 v3, s[12:15], s24 offen offset:3072 nt lds
v_cvt_pk_bf16_f32 v198, v188, v189
v_add_f32 v13, v13, v189
s_add_u32 s22, s22, 8192
s_and_b32 s22, s22, 0x7fff
s_add_u32 s21, s21, 8192
s_add_u32 s23, s23, 8256
s_cmp_eq_u32 s23, s35
s_cselect_b32 s23, s34, s23
s_cmp_eq_u32 s28, 5
s_cbranch_scc1 L_side
L_sideback:
v_mfma_f32_16x16x32_bf16 v[176:179], a[204:207], v[92:95], v[176:179]
s_cmp_ge_u32 s28, 5
v_exp_f32 v190, v190
v_mfma_f32_16x16x32_bf16 v[180:183], a[208:211], v[80:83], -4.0
ds_read_b64_tr_b16 a[174:175], v2 offset:12648
v_add_f32 v13, v13, v190
v_mfma_f32_16x16x32_bf16 v[180:183], a[212:215], v[84:87], v[180:183]
s_cselect_b32 s3, 0x7f000000, s3
v_exp_f32 v191, v191
v_mfma_f32_16x16x32_bf16 v[180:183], a[216:219], v[88:91], v[180:183]
s_cmp_ge_u32 s28, 4
v_cvt_pk_bf16_f32 v199, v190, v191
v_add_f32 v13, v13, v191
v_mfma_f32_16x16x32_bf16 v[180:183], a[220:223], v[92:95], v[180:183]
s_cselect_b32 s37, 0, 4096
v_exp_f32 v176, v176
v_mfma_f32_16x16x32_bf16 v[112:115], a[128:131], v[196:199], v[112:115]
ds_read_b64_tr_b16 a[176:177], v2 offset:8768
v_add_f32 v14, v14, v176
v_mfma_f32_16x16x32_bf16 v[116:119], a[132:135], v[196:199], v[116:119]
ds_read_b128 v[240:243], v235 offset:0
v_exp_f32 v177, v177
v_mfma_f32_16x16x32_bf16 v[120:123], a[136:139], v[196:199], v[120:123]
ds_read_b64_tr_b16 a[178:179], v2 offset:12896
v_cvt_pk_bf16_f32 v192, v176, v177
v_add_f32 v14, v14, v177
v_mfma_f32_16x16x32_bf16 v[124:127], a[140:143], v[196:199], v[124:127]
v_exp_f32 v178, v178
v_mfma_f32_16x16x32_bf16 v[128:131], a[144:147], v[196:199], v[128:131]
ds_read_b64_tr_b16 a[180:181], v2 offset:8776
v_add_f32 v14, v14, v178
v_mfma_f32_16x16x32_bf16 v[132:135], a[148:151], v[196:199], v[132:135]
ds_read_b128 v[244:247], v236 offset:1024
v_exp_f32 v179, v179
s_waitcnt lgkmcnt(3)
v_mfma_f32_16x16x32_bf16 v[136:139], a[152:155], v[196:199], v[136:139]
v_cvt_pk_bf16_f32 v193, v178, v179
v_add_f32 v14, v14, v179
v_mfma_f32_16x16x32_bf16 v[140:143], a[156:159], v[196:199], v[140:143]
s_waitcnt lgkmcnt(8)
v_exp_f32 v180, v180
v_mfma_f32_16x16x32_bf16 v[184:187], a[224:227], v[16:19], -4.0
ds_read_b64_tr_b16 a[182:183], v2 offset:12904
v_add_f32 v14, v14, v180
v_mfma_f32_16x16x32_bf16 v[184:187], a[228:231], v[20:23], v[184:187]
buffer_store_dwordx4 v[240:243], v237, s[16:19], s3 offen offset:0 sc1
v_exp_f32 v181, v181
s_waitcnt lgkmcnt(1)
v_mfma_f32_16x16x32_bf16 v[184:187], a[232:235], v[24:27], v[184:187]
v_cvt_pk_bf16_f32 v194, v180, v181
v_add_f32 v14, v14, v181
v_mfma_f32_16x16x32_bf16 v[184:187], a[236:239], v[28:31], v[184:187]
v_exp_f32 v182, v182
v_mfma_f32_16x16x32_bf16 v[188:191], a[240:243], v[16:19], -4.0
ds_read_b64_tr_b16 a[184:185], v2 offset:9024
v_add_f32 v14, v14, v182
v_mfma_f32_16x16x32_bf16 v[188:191], a[244:247], v[20:23], v[188:191]
buffer_store_dwordx4 v[244:247], v237, s[16:19], s3 offen offset:1024 sc1
v_exp_f32 v183, v183
v_mfma_f32_16x16x32_bf16 v[188:191], a[248:251], v[24:27], v[188:191]
ds_read_b64_tr_b16 a[186:187], v2 offset:13152
v_cvt_pk_bf16_f32 v195, v182, v183
v_add_f32 v14, v14, v183
v_mfma_f32_16x16x32_bf16 v[188:191], a[252:255], v[28:31], v[188:191]
v_exp_f32 v184, v184
v_mfma_f32_16x16x32_bf16 v[144:147], a[128:131], v[192:195], v[144:147]
ds_read_b64_tr_b16 a[188:189], v2 offset:9032
v_add_f32 v10, v10, v184
v_mfma_f32_16x16x32_bf16 v[148:151], a[132:135], v[192:195], v[148:151]
v_exp_f32 v185, v185
v_mfma_f32_16x16x32_bf16 v[152:155], a[136:139], v[192:195], v[152:155]
v_cvt_pk_bf16_f32 v196, v184, v185
v_add_f32 v10, v10, v185
v_mfma_f32_16x16x32_bf16 v[156:159], a[140:143], v[192:195], v[156:159]
v_exp_f32 v186, v186
v_mfma_f32_16x16x32_bf16 v[160:163], a[144:147], v[192:195], v[160:163]
ds_read_b64_tr_b16 a[190:191], v2 offset:13160
v_add_f32 v10, v10, v186
v_mfma_f32_16x16x32_bf16 v[164:167], a[148:151], v[192:195], v[164:167]
v_exp_f32 v187, v187
v_mfma_f32_16x16x32_bf16 v[168:171], a[152:155], v[192:195], v[168:171]
v_cvt_pk_bf16_f32 v197, v186, v187
v_add_f32 v10, v10, v187
v_mfma_f32_16x16x32_bf16 v[172:175], a[156:159], v[192:195], v[172:175]
v_exp_f32 v188, v188
v_mfma_f32_16x16x32_bf16 v[176:179], a[224:227], v[32:35], -4.0
v_add_f32 v10, v10, v188
v_xor_b32 v1, 0x4000, v1
v_mfma_f32_16x16x32_bf16 v[176:179], a[228:231], v[36:39], v[176:179]
v_exp_f32 v189, v189
v_mfma_f32_16x16x32_bf16 v[176:179], a[232:235], v[40:43], v[176:179]
v_cvt_pk_bf16_f32 v198, v188, v189
v_add_f32 v10, v10, v189
v_mfma_f32_16x16x32_bf16 v[176:179], a[236:239], v[44:47], v[176:179]
v_exp_f32 v190, v190
v_mfma_f32_16x16x32_bf16 v[180:183], a[240:243], v[32:35], -4.0
v_add_f32 v10, v10, v190
v_add_u32 v2, s30, v2
v_mfma_f32_16x16x32_bf16 v[180:183], a[244:247], v[36:39], v[180:183]
s_sub_u32 s30, 0, s30
v_exp_f32 v191, v191
v_mfma_f32_16x16x32_bf16 v[180:183], a[248:251], v[40:43], v[180:183]
s_waitcnt vmcnt(34) lgkmcnt(0)
v_cvt_pk_bf16_f32 v199, v190, v191
v_add_f32 v10, v10, v191
v_mfma_f32_16x16x32_bf16 v[180:183], a[252:255], v[44:47], v[180:183]
s_barrier
v_exp_f32 v176, v176
v_mfma_f32_16x16x32_bf16 a[0:3], a[160:163], v[196:199], a[0:3]
ds_read_b128 a[192:195], v1 offset:0
v_add_f32 v11, v11, v176
v_mfma_f32_16x16x32_bf16 a[4:7], a[164:167], v[196:199], a[4:7]
s_mov_b32 m0, s22
v_exp_f32 v177, v177
v_mfma_f32_16x16x32_bf16 a[8:11], a[168:171], v[196:199], a[8:11]
s_add_u32 s24, s21, 4096
v_cvt_pk_bf16_f32 v192, v176, v177
v_add_f32 v11, v11, v177
v_mfma_f32_16x16x32_bf16 a[12:15], a[172:175], v[196:199], a[12:15]
buffer_load_dwordx4 v3, s[8:11], s21 offen offset:0 nt lds
v_exp_f32 v178, v178
v_mfma_f32_16x16x32_bf16 a[16:19], a[176:179], v[196:199], a[16:19]
ds_read_b128 a[196:199], v1 offset:256
v_add_f32 v11, v11, v178
v_mfma_f32_16x16x32_bf16 a[20:23], a[180:183], v[196:199], a[20:23]
buffer_load_dwordx4 v3, s[8:11], s21 offen offset:1024 nt lds
v_exp_f32 v179, v179
v_mfma_f32_16x16x32_bf16 a[24:27], a[184:187], v[196:199], a[24:27]
ds_read_b128 a[200:203], v1 offset:512
v_cvt_pk_bf16_f32 v193, v178, v179
v_add_f32 v11, v11, v179
v_mfma_f32_16x16x32_bf16 a[28:31], a[188:191], v[196:199], a[28:31]
buffer_load_dwordx4 v4, s[8:11], s21 offen offset:2048 nt lds
v_exp_f32 v180, v180
v_mfma_f32_16x16x32_bf16 v[184:187], a[224:227], v[48:51], -4.0
ds_read_b128 a[204:207], v1 offset:768
v_add_f32 v11, v11, v180
v_mfma_f32_16x16x32_bf16 v[184:187], a[228:231], v[52:55], v[184:187]
buffer_load_dwordx4 v4, s[8:11], s21 offen offset:3072 nt lds
v_exp_f32 v181, v181
v_mfma_f32_16x16x32_bf16 v[184:187], a[232:235], v[56:59], v[184:187]
s_add_u32 m0, s22, 4096
v_cvt_pk_bf16_f32 v194, v180, v181
v_add_f32 v11, v11, v181
v_mfma_f32_16x16x32_bf16 v[184:187], a[236:239], v[60:63], v[184:187]
buffer_load_dwordx4 v3, s[8:11], s24 offen offset:0 nt lds
v_exp_f32 v182, v182
v_mfma_f32_16x16x32_bf16 v[188:191], a[240:243], v[48:51], -4.0
ds_read_b128 a[208:211], v1 offset:4096
v_add_f32 v11, v11, v182
v_mfma_f32_16x16x32_bf16 v[188:191], a[244:247], v[52:55], v[188:191]
buffer_load_dwordx4 v3, s[8:11], s24 offen offset:1024 nt lds
v_exp_f32 v183, v183
v_mfma_f32_16x16x32_bf16 v[188:191], a[248:251], v[56:59], v[188:191]
v_cvt_pk_bf16_f32 v195, v182, v183
v_add_f32 v11, v11, v183
v_mfma_f32_16x16x32_bf16 v[188:191], a[252:255], v[60:63], v[188:191]
buffer_load_dwordx4 v4, s[8:11], s24 offen offset:2048 nt lds
v_exp_f32 v184, v184
v_mfma_f32_16x16x32_bf16 a[32:35], a[160:163], v[192:195], a[32:35]
ds_read_b128 a[212:215], v1 offset:4352
v_add_f32 v12, v12, v184
v_mfma_f32_16x16x32_bf16 a[36:39], a[164:167], v[192:195], a[36:39]
ds_read_b128 a[216:219], v1 offset:4608
v_exp_f32 v185, v185
v_mfma_f32_16x16x32_bf16 a[40:43], a[168:171], v[192:195], a[40:43]
buffer_load_dwordx4 v4, s[8:11], s24 offen offset:3072 nt lds
v_cvt_pk_bf16_f32 v196, v184, v185
v_add_f32 v12, v12, v185
v_mfma_f32_16x16x32_bf16 a[44:47], a[172:175], v[192:195], a[44:47]
s_add_u32 m0, s23, 0
v_exp_f32 v186, v186
v_mfma_f32_16x16x32_bf16 a[48:51], a[176:179], v[192:195], a[48:51]
ds_read_b128 a[220:223], v1 offset:4864
v_add_f32 v12, v12, v186
v_mfma_f32_16x16x32_bf16 a[52:55], a[180:183], v[192:195], a[52:55]
buffer_load_dwordx4 v3, s[12:15], s21 offen offset:0 nt lds
v_exp_f32 v187, v187
v_mfma_f32_16x16x32_bf16 a[56:59], a[184:187], v[192:195], a[56:59]
s_add_u32 m0, s23, 8
v_cvt_pk_bf16_f32 v197, v186, v187
v_add_f32 v12, v12, v187
v_mfma_f32_16x16x32_bf16 a[60:63], a[188:191], v[192:195], a[60:63]
buffer_load_dwordx4 v3, s[12:15], s21 offen offset:1024 nt lds
v_exp_f32 v188, v188
v_mfma_f32_16x16x32_bf16 v[176:179], a[224:227], v[64:67], -4.0
ds_read_b64_tr_b16 a[128:129], v2 offset:0
v_add_f32 v12, v12, v188
v_mfma_f32_16x16x32_bf16 v[176:179], a[228:231], v[68:71], v[176:179]
s_add_u32 m0, s23, 16
v_exp_f32 v189, v189
v_mfma_f32_16x16x32_bf16 v[176:179], a[232:235], v[72:75], v[176:179]
buffer_load_dwordx4 v3, s[12:15], s21 offen offset:2048 nt lds
v_cvt_pk_bf16_f32 v198, v188, v189
v_add_f32 v12, v12, v189
v_mfma_f32_16x16x32_bf16 v[176:179], a[236:239], v[76:79], v[176:179]
ds_read_b64_tr_b16 a[130:131], v2 offset:4128
v_exp_f32 v190, v190
v_mfma_f32_16x16x32_bf16 v[180:183], a[240:243], v[64:67], -4.0
ds_read_b64_tr_b16 a[132:133], v2 offset:8
v_add_f32 v12, v12, v190
v_mfma_f32_16x16x32_bf16 v[180:183], a[244:247], v[68:71], v[180:183]
s_add_u32 m0, s23, 24
v_exp_f32 v191, v191
v_mfma_f32_16x16x32_bf16 v[180:183], a[248:251], v[72:75], v[180:183]
buffer_load_dwordx4 v3, s[12:15], s21 offen offset:3072 nt lds
v_cvt_pk_bf16_f32 v199, v190, v191
v_add_f32 v12, v12, v191
v_mfma_f32_16x16x32_bf16 v[180:183], a[252:255], v[76:79], v[180:183]
s_add_u32 m0, s23, 4128
v_exp_f32 v176, v176
v_mfma_f32_16x16x32_bf16 a[64:67], a[160:163], v[196:199], a[64:67]
ds_read_b64_tr_b16 a[134:135], v2 offset:4136
v_add_f32 v13, v13, v176
v_mfma_f32_16x16x32_bf16 a[68:71], a[164:167], v[196:199], a[68:71]
buffer_load_dwordx4 v3, s[12:15], s24 offen offset:0 nt lds
v_exp_f32 v177, v177
v_mfma_f32_16x16x32_bf16 a[72:75], a[168:171], v[196:199], a[72:75]
s_add_u32 m0, s23, 4136
v_cvt_pk_bf16_f32 v192, v176, v177
v_add_f32 v13, v13, v177
v_mfma_f32_16x16x32_bf16 a[76:79], a[172:175], v[196:199], a[76:79]
buffer_load_dwordx4 v3, s[12:15], s24 offen offset:1024 nt lds
v_exp_f32 v178, v178
v_mfma_f32_16x16x32_bf16 a[80:83], a[176:179], v[196:199], a[80:83]
ds_read_b64_tr_b16 a[136:137], v2 offset:256
v_add_f32 v13, v13, v178
v_mfma_f32_16x16x32_bf16 a[84:87], a[180:183], v[196:199], a[84:87]
s_add_u32 m0, s23, 4144
v_exp_f32 v179, v179
v_mfma_f32_16x16x32_bf16 a[88:91], a[184:187], v[196:199], a[88:91]
buffer_load_dwordx4 v3, s[12:15], s24 offen offset:2048 nt lds
v_cvt_pk_bf16_f32 v193, v178, v179
v_add_f32 v13, v13, v179
v_mfma_f32_16x16x32_bf16 a[92:95], a[188:191], v[196:199], a[92:95]
ds_read_b64_tr_b16 a[138:139], v2 offset:4384
v_exp_f32 v180, v180
v_mfma_f32_16x16x32_bf16 v[184:187], a[224:227], v[80:83], -4.0
ds_read_b64_tr_b16 a[140:141], v2 offset:264
v_add_f32 v13, v13, v180
v_mfma_f32_16x16x32_bf16 v[184:187], a[228:231], v[84:87], v[184:187]
s_add_u32 m0, s23, 4152
v_exp_f32 v181, v181
v_mfma_f32_16x16x32_bf16 v[184:187], a[232:235], v[88:91], v[184:187]
buffer_load_dwordx4 v3, s[12:15], s24 offen offset:3072 nt lds
v_cvt_pk_bf16_f32 v194, v180, v181
v_add_f32 v13, v13, v181
s_add_u32 s22, s22, 8192
s_and_b32 s22, s22, 0x7fff
s_add_u32 s21, s21, 8192
s_add_u32 s23, s23, 8256
s_cmp_eq_u32 s23, s35
s_cselect_b32 s23, s34, s23
v_mfma_f32_16x16x32_bf16 v[184:187], a[236:239], v[92:95], v[184:187]
ds_read_b128 v[248:251], v235 offset:2048
v_exp_f32 v182, v182
v_mfma_f32_16x16x32_bf16 v[188:191], a[240:243], v[80:83], -4.0
ds_read_b64_tr_b16 a[142:143], v2 offset:4392
v_add_f32 v13, v13, v182
v_mfma_f32_16x16x32_bf16 v[188:191], a[244:247], v[84:87], v[188:191]
v_exp_f32 v183, v183
v_mfma_f32_16x16x32_bf16 v[188:191], a[248:251], v[88:91], v[188:191]
ds_read_b128 v[252:255], v236 offset:3072
v_cvt_pk_bf16_f32 v195, v182, v183
v_add_f32 v13, v13, v183
s_waitcnt lgkmcnt(2)
v_mfma_f32_16x16x32_bf16 v[188:191], a[252:255], v[92:95], v[188:191]
v_exp_f32 v184, v184
v_mfma_f32_16x16x32_bf16 v[112:115], a[160:163], v[192:195], v[112:115]
ds_read_b64_tr_b16 a[144:145], v2 offset:512
v_add_f32 v14, v14, v184
v_mfma_f32_16x16x32_bf16 v[116:119], a[164:167], v[192:195], v[116:119]
buffer_store_dwordx4 v[248:251], v237, s[16:19], s3 offen offset:2048 sc1
v_exp_f32 v185, v185
s_waitcnt lgkmcnt(1)
v_mfma_f32_16x16x32_bf16 v[120:123], a[168:171], v[192:195], v[120:123]
ds_read_b64_tr_b16 a[146:147], v2 offset:4640
v_cvt_pk_bf16_f32 v196, v184, v185
v_add_f32 v14, v14, v185
v_mfma_f32_16x16x32_bf16 v[124:127], a[172:175], v[192:195], v[124:127]
v_exp_f32 v186, v186
v_mfma_f32_16x16x32_bf16 v[128:131], a[176:179], v[192:195], v[128:131]
ds_read_b64_tr_b16 a[148:149], v2 offset:520
v_add_f32 v14, v14, v186
v_mfma_f32_16x16x32_bf16 v[132:135], a[180:183], v[192:195], v[132:135]
buffer_store_dwordx4 v[252:255], v237, s[16:19], s3 offen offset:3072 sc1
v_exp_f32 v187, v187
s_add_u32 s3, s3, 4096
v_add_u32 v235, s37, v235
v_add_u32 v236, s37, v236
v_mfma_f32_16x16x32_bf16 v[136:139], a[184:187], v[192:195], v[136:139]
v_cvt_pk_bf16_f32 v197, v186, v187
v_add_f32 v14, v14, v187
v_mfma_f32_16x16x32_bf16 v[140:143], a[188:191], v[192:195], v[140:143]
s_waitcnt lgkmcnt(8)
v_exp_f32 v188, v188
v_mfma_f32_16x16x32_bf16 v[176:179], a[192:195], v[16:19], -4.0
ds_read_b64_tr_b16 a[150:151], v2 offset:4648
v_add_f32 v14, v14, v188
v_mfma_f32_16x16x32_bf16 v[176:179], a[196:199], v[20:23], v[176:179]
v_exp_f32 v189, v189
v_mfma_f32_16x16x32_bf16 v[176:179], a[200:203], v[24:27], v[176:179]
v_cvt_pk_bf16_f32 v198, v188, v189
v_add_f32 v14, v14, v189
v_mfma_f32_16x16x32_bf16 v[176:179], a[204:207], v[28:31], v[176:179]
v_exp_f32 v190, v190
v_mfma_f32_16x16x32_bf16 v[180:183], a[208:211], v[16:19], -4.0
ds_read_b64_tr_b16 a[152:153], v2 offset:768
v_add_f32 v14, v14, v190
v_mfma_f32_16x16x32_bf16 v[180:183], a[212:215], v[20:23], v[180:183]
v_exp_f32 v191, v191
v_mfma_f32_16x16x32_bf16 v[180:183], a[216:219], v[24:27], v[180:183]
ds_read_b64_tr_b16 a[154:155], v2 offset:4896
v_cvt_pk_bf16_f32 v199, v190, v191
v_add_f32 v14, v14, v191
v_mfma_f32_16x16x32_bf16 v[180:183], a[220:223], v[28:31], v[180:183]
v_exp_f32 v176, v176
v_mfma_f32_16x16x32_bf16 v[144:147], a[160:163], v[196:199], v[144:147]
ds_read_b64_tr_b16 a[156:157], v2 offset:776
v_mov_b32 v6, v176
v_mfma_f32_16x16x32_bf16 v[148:151], a[164:167], v[196:199], v[148:151]
v_exp_f32 v177, v177
v_mfma_f32_16x16x32_bf16 v[152:155], a[168:171], v[196:199], v[152:155]
v_cvt_pk_bf16_f32 v192, v176, v177
v_add_f32 v6, v6, v177
v_mfma_f32_16x16x32_bf16 v[156:159], a[172:175], v[196:199], v[156:159]
v_exp_f32 v178, v178
v_mfma_f32_16x16x32_bf16 v[160:163], a[176:179], v[196:199], v[160:163]
ds_read_b64_tr_b16 a[158:159], v2 offset:4904
v_add_f32 v6, v6, v178
v_exp_f32 v180, v180
v_mfma_f32_16x16x32_bf16 v[164:167], a[180:183], v[196:199], v[164:167]
s_add_u32 s28, s28, 1
v_exp_f32 v179, v179
v_mfma_f32_16x16x32_bf16 v[168:171], a[184:187], v[196:199], v[168:171]
s_cmp_lt_u32 s28, s36
v_cvt_pk_bf16_f32 v193, v178, v179
v_add_f32 v6, v6, v179
v_mfma_f32_16x16x32_bf16 v[172:175], a[188:191], v[196:199], v[172:175]
s_cbranch_scc1 L_loop1B
v_and_b32 v233, 0x7ff, v5
v_lshrrev_b32 v234, 11, v5
v_lshl_add_u32 v233, v234, 6, v233
s_mov_b32 vcc_lo, 0xff00ff00
s_mov_b32 vcc_hi, 0xff00ff00
v_add_u32 v8, 65792, v1
v_add_u32 v232, 57600, v2
v_mfma_f32_16x16x32_bf16 v[184:187], a[192:195], v[32:35], -4.0
v_add_f32 v10, v10, v180
v_add_f32 v10, v10, v6
v_mfma_f32_16x16x32_bf16 v[184:187], a[196:199], v[36:39], v[184:187]
v_exp_f32 v181, v181
v_mfma_f32_16x16x32_bf16 v[184:187], a[200:203], v[40:43], v[184:187]
v_cvt_pk_bf16_f32 v194, v180, v181
v_add_f32 v10, v10, v181
v_mfma_f32_16x16x32_bf16 v[184:187], a[204:207], v[44:47], v[184:187]
v_exp_f32 v182, v182
v_mfma_f32_16x16x32_bf16 v[188:191], a[208:211], v[32:35], -4.0
v_add_f32 v10, v10, v182
v_mfma_f32_16x16x32_bf16 v[188:191], a[212:215], v[36:39], v[188:191]
s_waitcnt lgkmcnt(0)
v_exp_f32 v183, v183
v_mfma_f32_16x16x32_bf16 v[188:191], a[216:219], v[40:43], v[188:191]
s_waitcnt vmcnt(54)
v_cvt_pk_bf16_f32 v195, v182, v183
v_add_f32 v10, v10, v183
v_mfma_f32_16x16x32_bf16 v[188:191], a[220:223], v[44:47], v[188:191]
s_barrier
v_exp_f32 v184, v184
v_mfma_f32_16x16x32_bf16 a[0:3], a[128:131], v[192:195], a[0:3]
ds_read_b128 a[224:227], v1 offset:8192
v_add_f32 v11, v11, v184
v_mfma_f32_16x16x32_bf16 a[4:7], a[132:135], v[192:195], a[4:7]
v_exp_f32 v185, v185
v_mfma_f32_16x16x32_bf16 a[8:11], a[136:139], v[192:195], a[8:11]
ds_read_b128 a[228:231], v1 offset:8448
v_cvt_pk_bf16_f32 v196, v184, v185
v_add_f32 v11, v11, v185
v_mfma_f32_16x16x32_bf16 a[12:15], a[140:143], v[192:195], a[12:15]
ds_read_b64_tr_b16 a[160:161], v2 offset:8256
v_exp_f32 v186, v186
v_mfma_f32_16x16x32_bf16 a[16:19], a[144:147], v[192:195], a[16:19]
ds_read_b128 a[232:235], v1 offset:8704
v_add_f32 v11, v11, v186
v_mfma_f32_16x16x32_bf16 a[20:23], a[148:151], v[192:195], a[20:23]
v_exp_f32 v187, v187
v_mfma_f32_16x16x32_bf16 a[24:27], a[152:155], v[192:195], a[24:27]
ds_read_b128 a[236:239], v1 offset:8960
v_cvt_pk_bf16_f32 v197, v186, v187
v_add_f32 v11, v11, v187
v_mfma_f32_16x16x32_bf16 a[28:31], a[156:159], v[192:195], a[28:31]
ds_read_b64_tr_b16 a[162:163], v2 offset:12384
v_exp_f32 v188, v188
v_mfma_f32_16x16x32_bf16 v[176:179], a[192:195], v[48:51], -4.0
ds_read_b128 a[240:243], v1 offset:12288
v_add_f32 v11, v11, v188
v_mfma_f32_16x16x32_bf16 v[176:179], a[196:199], v[52:55], v[176:179]
v_exp_f32 v189, v189
v_mfma_f32_16x16x32_bf16 v[176:179], a[200:203], v[56:59], v[176:179]
ds_read_b128 a[244:247], v1 offset:12544
v_cvt_pk_bf16_f32 v198, v188, v189
v_add_f32 v11, v11, v189
v_mfma_f32_16x16x32_bf16 v[176:179], a[204:207], v[60:63], v[176:179]
v_exp_f32 v190, v190
v_mfma_f32_16x16x32_bf16 v[180:183], a[208:211], v[48:51], -4.0
ds_read_b128 a[248:251], v1 offset:12800
v_add_f32 v11, v11, v190
v_mfma_f32_16x16x32_bf16 v[180:183], a[212:215], v[52:55], v[180:183]
ds_read_b64_tr_b16 a[164:165], v2 offset:8264
v_exp_f32 v191, v191
v_mfma_f32_16x16x32_bf16 v[180:183], a[216:219], v[56:59], v[180:183]
ds_read_b128 a[252:255], v1 offset:13056
v_cvt_pk_bf16_f32 v199, v190, v191
v_add_f32 v11, v11, v191
v_mfma_f32_16x16x32_bf16 v[180:183], a[220:223], v[60:63], v[180:183]
v_exp_f32 v176, v176
v_mfma_f32_16x16x32_bf16 a[32:35], a[128:131], v[196:199], a[32:35]
ds_read_b64_tr_b16 a[166:167], v2 offset:12392
v_add_f32 v12, v12, v176
v_mfma_f32_16x16x32_bf16 a[36:39], a[132:135], v[196:199], a[36:39]
ds_read_b64_tr_b16 a[168:169], v2 offset:8512
v_exp_f32 v177, v177
v_mfma_f32_16x16x32_bf16 a[40:43], a[136:139], v[196:199], a[40:43]
L_pad12:
s_cbranch_execz L_padret
v_cvt_pk_bf16_f32 v192, v176, v177
v_add_f32 v12, v12, v177
v_mfma_f32_16x16x32_bf16 a[44:47], a[140:143], v[196:199], a[44:47]
v_exp_f32 v178, v178
v_mfma_f32_16x16x32_bf16 a[48:51], a[144:147], v[196:199], a[48:51]
ds_read_b64_tr_b16 a[170:171], v2 offset:12640
v_add_f32 v12, v12, v178
v_mfma_f32_16x16x32_bf16 a[52:55], a[148:151], v[196:199], a[52:55]
ds_read_b64_tr_b16 a[172:173], v2 offset:8520
v_exp_f32 v179, v179
v_mfma_f32_16x16x32_bf16 a[56:59], a[152:155], v[196:199], a[56:59]
v_cvt_pk_bf16_f32 v193, v178, v179
v_add_f32 v12, v12, v179
v_mfma_f32_16x16x32_bf16 a[60:63], a[156:159], v[196:199], a[60:63]
s_waitcnt lgkmcnt(4)
v_exp_f32 v180, v180
v_mfma_f32_16x16x32_bf16 v[184:187], a[224:227], v[16:19], -4.0
ds_read_b64_tr_b16 a[174:175], v2 offset:12648
v_add_f32 v12, v12, v180
v_mfma_f32_16x16x32_bf16 v[184:187], a[228:231], v[20:23], v[184:187]
ds_read_b64_tr_b16 a[176:177], v2 offset:8768
v_exp_f32 v181, v181
v_mfma_f32_16x16x32_bf16 v[184:187], a[232:235], v[24:27], v[184:187]
v_cvt_pk_bf16_f32 v194, v180, v181
v_add_f32 v12, v12, v181
v_mfma_f32_16x16x32_bf16 v[184:187], a[236:239], v[28:31], v[184:187]
v_exp_f32 v182, v182
v_mfma_f32_16x16x32_bf16 v[188:191], a[240:243], v[16:19], -4.0
ds_read_b64_tr_b16 a[178:179], v2 offset:12896
v_add_f32 v12, v12, v182
v_mfma_f32_16x16x32_bf16 v[188:191], a[244:247], v[20:23], v[188:191]
ds_read_b64_tr_b16 a[180:181], v2 offset:8776
v_exp_f32 v183, v183
v_mfma_f32_16x16x32_bf16 v[188:191], a[248:251], v[24:27], v[188:191]
v_cvt_pk_bf16_f32 v195, v182, v183
v_add_f32 v12, v12, v183
v_mfma_f32_16x16x32_bf16 v[188:191], a[252:255], v[28:31], v[188:191]
ds_read_b64_tr_b16 a[182:183], v2 offset:12904
v_exp_f32 v184, v184
v_mfma_f32_16x16x32_bf16 a[64:67], a[128:131], v[192:195], a[64:67]
ds_read_b64_tr_b16 a[184:185], v2 offset:9024
v_add_f32 v10, v10, v184
v_mfma_f32_16x16x32_bf16 a[68:71], a[132:135], v[192:195], a[68:71]
v_exp_f32 v185, v185
v_mfma_f32_16x16x32_bf16 a[72:75], a[136:139], v[192:195], a[72:75]
v_cvt_pk_bf16_f32 v196, v184, v185
v_add_f32 v10, v10, v185
v_mfma_f32_16x16x32_bf16 a[76:79], a[140:143], v[192:195], a[76:79]
ds_read_b64_tr_b16 a[186:187], v2 offset:13152
v_exp_f32 v186, v186
v_mfma_f32_16x16x32_bf16 a[80:83], a[144:147], v[192:195], a[80:83]
ds_read_b64_tr_b16 a[188:189], v2 offset:9032
v_add_f32 v10, v10, v186
v_mfma_f32_16x16x32_bf16 a[84:87], a[148:151], v[192:195], a[84:87]
v_exp_f32 v187, v187
v_mfma_f32_16x16x32_bf16 a[88:91], a[152:155], v[192:195], a[88:91]
ds_read_b64_tr_b16 a[190:191], v2 offset:13160
v_cvt_pk_bf16_f32 v197, v186, v187
v_add_f32 v10, v10, v187
v_mfma_f32_16x16x32_bf16 a[92:95], a[156:159], v[192:195], a[92:95]
v_exp_f32 v188, v188
v_mfma_f32_16x16x32_bf16 v[176:179], a[224:227], v[32:35], -4.0
v_add_f32 v10, v10, v188
v_mfma_f32_16x16x32_bf16 v[176:179], a[228:231], v[36:39], v[176:179]
v_exp_f32 v189, v189
v_mfma_f32_16x16x32_bf16 v[176:179], a[232:235], v[40:43], v[176:179]
v_cvt_pk_bf16_f32 v198, v188, v189
v_add_f32 v10, v10, v189
v_mfma_f32_16x16x32_bf16 v[176:179], a[236:239], v[44:47], v[176:179]
v_exp_f32 v190, v190
v_mfma_f32_16x16x32_bf16 v[180:183], a[240:243], v[32:35], -4.0
v_add_f32 v10, v10, v190
v_mfma_f32_16x16x32_bf16 v[180:183], a[244:247], v[36:39], v[180:183]
v_exp_f32 v191, v191
v_mfma_f32_16x16x32_bf16 v[180:183], a[248:251], v[40:43], v[180:183]
v_cvt_pk_bf16_f32 v199, v190, v191
v_add_f32 v10, v10, v191
v_mfma_f32_16x16x32_bf16 v[180:183], a[252:255], v[44:47], v[180:183]
s_waitcnt lgkmcnt(0)
v_exp_f32 v176, v176
v_mfma_f32_16x16x32_bf16 a[0:3], a[160:163], v[196:199], a[0:3]
s_waitcnt vmcnt(36)
v_add_f32 v11, v11, v176
v_mfma_f32_16x16x32_bf16 a[4:7], a[164:167], v[196:199], a[4:7]
s_barrier
v_exp_f32 v177, v177
v_mfma_f32_16x16x32_bf16 a[8:11], a[168:171], v[196:199], a[8:11]
v_cvt_pk_bf16_f32 v192, v176, v177
v_add_f32 v11, v11, v177
v_mfma_f32_16x16x32_bf16 a[12:15], a[172:175], v[196:199], a[12:15]
ds_read_b128 a[192:195], v1 offset:16384
v_exp_f32 v178, v178
v_mfma_f32_16x16x32_bf16 a[16:19], a[176:179], v[196:199], a[16:19]
ds_read_b128 a[196:199], v1 offset:16640
v_add_f32 v11, v11, v178
v_mfma_f32_16x16x32_bf16 a[20:23], a[180:183], v[196:199], a[20:23]
ds_read_b64_tr_b16 a[128:129], v2 offset:16512
v_exp_f32 v179, v179
v_mfma_f32_16x16x32_bf16 a[24:27], a[184:187], v[196:199], a[24:27]
ds_read_b128 a[200:203], v1 offset:16896
v_cvt_pk_bf16_f32 v193, v178, v179
v_add_f32 v11, v11, v179
v_mfma_f32_16x16x32_bf16 a[28:31], a[188:191], v[196:199], a[28:31]
v_exp_f32 v180, v180
v_mfma_f32_16x16x32_bf16 v[184:187], a[224:227], v[48:51], -4.0
ds_read_b128 a[204:207], v1 offset:17152
v_add_f32 v11, v11, v180
v_mfma_f32_16x16x32_bf16 v[184:187], a[228:231], v[52:55], v[184:187]
ds_read_b128 a[208:211], v1 offset:20480
v_exp_f32 v181, v181
v_mfma_f32_16x16x32_bf16 v[184:187], a[232:235], v[56:59], v[184:187]
ds_read_b64_tr_b16 a[130:131], v2 offset:20640
v_cvt_pk_bf16_f32 v194, v180, v181
v_add_f32 v11, v11, v181
v_mfma_f32_16x16x32_bf16 v[184:187], a[236:239], v[60:63], v[184:187]
ds_read_b128 a[212:215], v1 offset:20736
v_exp_f32 v182, v182
v_mfma_f32_16x16x32_bf16 v[188:191], a[240:243], v[48:51], -4.0
ds_read_b128 a[216:219], v1 offset:20992
v_add_f32 v11, v11, v182
v_mfma_f32_16x16x32_bf16 v[188:191], a[244:247], v[52:55], v[188:191]
v_exp_f32 v183, v183
v_mfma_f32_16x16x32_bf16 v[188:191], a[248:251], v[56:59], v[188:191]
ds_read_b128 a[220:223], v1 offset:21248
v_cvt_pk_bf16_f32 v195, v182, v183
v_add_f32 v11, v11, v183
v_mfma_f32_16x16x32_bf16 v[188:191], a[252:255], v[60:63], v[188:191]
ds_read_b64_tr_b16 a[132:133], v2 offset:16520
v_exp_f32 v184, v184
v_mfma_f32_16x16x32_bf16 a[32:35], a[160:163], v[192:195], a[32:35]
ds_read_b64_tr_b16 a[134:135], v2 offset:20648
v_add_f32 v12, v12, v184
v_mfma_f32_16x16x32_bf16 a[36:39], a[164:167], v[192:195], a[36:39]
v_exp_f32 v185, v185
v_mfma_f32_16x16x32_bf16 a[40:43], a[168:171], v[192:195], a[40:43]
ds_read_b64_tr_b16 a[136:137], v2 offset:16768
v_cvt_pk_bf16_f32 v196, v184, v185
v_add_f32 v12, v12, v185
v_mfma_f32_16x16x32_bf16 a[44:47], a[172:175], v[192:195], a[44:47]
v_exp_f32 v186, v186
v_mfma_f32_16x16x32_bf16 a[48:51], a[176:179], v[192:195], a[48:51]
ds_read_b64_tr_b16 a[138:139], v2 offset:20896
v_add_f32 v12, v12, v186
v_mfma_f32_16x16x32_bf16 a[52:55], a[180:183], v[192:195], a[52:55]
ds_read_b64_tr_b16 a[140:141], v2 offset:16776
v_exp_f32 v187, v187
v_mfma_f32_16x16x32_bf16 a[56:59], a[184:187], v[192:195], a[56:59]
v_cvt_pk_bf16_f32 v197, v186, v187
v_add_f32 v12, v12, v187
v_mfma_f32_16x16x32_bf16 a[60:63], a[188:191], v[192:195], a[60:63]
s_waitcnt lgkmcnt(5)
v_exp_f32 v188, v188
v_mfma_f32_16x16x32_bf16 v[176:179], a[192:195], v[16:19], -4.0
ds_read_b64_tr_b16 a[142:143], v2 offset:20904
v_add_f32 v12, v12, v188
v_mfma_f32_16x16x32_bf16 v[176:179], a[196:199], v[20:23], v[176:179]
ds_read_b64_tr_b16 a[144:145], v2 offset:17024
v_exp_f32 v189, v189
v_mfma_f32_16x16x32_bf16 v[176:179], a[200:203], v[24:27], v[176:179]
v_cvt_pk_bf16_f32 v198, v188, v189
v_add_f32 v12, v12, v189
v_mfma_f32_16x16x32_bf16 v[176:179], a[204:207], v[28:31], v[176:179]
ds_read_b64_tr_b16 a[146:147], v2 offset:21152
v_exp_f32 v190, v190
v_mfma_f32_16x16x32_bf16 v[180:183], a[208:211], v[16:19], -4.0
ds_read_b64_tr_b16 a[148:149], v2 offset:17032
v_add_f32 v12, v12, v190
v_mfma_f32_16x16x32_bf16 v[180:183], a[212:215], v[20:23], v[180:183]
v_exp_f32 v191, v191
v_mfma_f32_16x16x32_bf16 v[180:183], a[216:219], v[24:27], v[180:183]
s_waitcnt vmcnt(20)
v_cvt_pk_bf16_f32 v199, v190, v191
v_add_f32 v12, v12, v191
v_mfma_f32_16x16x32_bf16 v[180:183], a[220:223], v[28:31], v[180:183]
s_barrier
v_exp_f32 v176, v176
v_mfma_f32_16x16x32_bf16 a[64:67], a[160:163], v[196:199], a[64:67]
ds_read_b64_tr_b16 a[150:151], v2 offset:21160
v_add_f32 v10, v10, v176
v_mfma_f32_16x16x32_bf16 a[68:71], a[164:167], v[196:199], a[68:71]
ds_read_b64_tr_b16 a[152:153], v2 offset:17280
v_exp_f32 v177, v177
v_mfma_f32_16x16x32_bf16 a[72:75], a[168:171], v[196:199], a[72:75]
ds_read_b128 a[224:227], v8 offset:0
v_cvt_pk_bf16_f32 v192, v176, v177
v_add_f32 v10, v10, v177
v_mfma_f32_16x16x32_bf16 a[76:79], a[172:175], v[196:199], a[76:79]
ds_read_b64_tr_b16 a[154:155], v2 offset:21408
v_exp_f32 v178, v178
v_mfma_f32_16x16x32_bf16 a[80:83], a[176:179], v[196:199], a[80:83]
ds_read_b64_tr_b16 a[156:157], v2 offset:17288
v_add_f32 v10, v10, v178
v_mfma_f32_16x16x32_bf16 a[84:87], a[180:183], v[196:199], a[84:87]
v_exp_f32 v179, v179
v_mfma_f32_16x16x32_bf16 a[88:91], a[184:187], v[196:199], a[88:91]
ds_read_b64_tr_b16 a[158:159], v2 offset:21416
v_cvt_pk_bf16_f32 v193, v178, v179
v_add_f32 v10, v10, v179
v_mfma_f32_16x16x32_bf16 a[92:95], a[188:191], v[196:199], a[92:95]
ds_read_b128 a[228:231], v8 offset:256
v_exp_f32 v180, v180
v_mfma_f32_16x16x32_bf16 v[184:187], a[192:195], v[32:35], -4.0
ds_read_b128 a[232:235], v8 offset:512
v_add_f32 v10, v10, v180
v_mfma_f32_16x16x32_bf16 v[184:187], a[196:199], v[36:39], v[184:187]
ds_read_b128 a[236:239], v8 offset:768
v_exp_f32 v181, v181
v_mfma_f32_16x16x32_bf16 v[184:187], a[200:203], v[40:43], v[184:187]
ds_read_b128 a[240:243], v8 offset:4096
v_cvt_pk_bf16_f32 v194, v180, v181
v_add_f32 v10, v10, v181
v_mfma_f32_16x16x32_bf16 v[184:187], a[204:207], v[44:47], v[184:187]
ds_read_b64_tr_b16 a[160:161], v232 offset:0
v_exp_f32 v182, v182
v_mfma_f32_16x16x32_bf16 v[188:191], a[208:211], v[32:35], -4.0
ds_read_b128 a[244:247], v8 offset:4352
v_add_f32 v10, v10, v182
v_mfma_f32_16x16x32_bf16 v[188:191], a[212:215], v[36:39], v[188:191]
ds_read_b128 a[248:251], v8 offset:4608
v_exp_f32 v183, v183
v_mfma_f32_16x16x32_bf16 v[188:191], a[216:219], v[40:43], v[188:191]
ds_read_b128 a[252:255], v8 offset:4864
v_cvt_pk_bf16_f32 v195, v182, v183
v_add_f32 v10, v10, v183
v_mfma_f32_16x16x32_bf16 v[188:191], a[220:223], v[44:47], v[188:191]
s_waitcnt lgkmcnt(8)
v_exp_f32 v184, v184
v_mfma_f32_16x16x32_bf16 a[0:3], a[128:131], v[192:195], a[0:3]
ds_read_b64_tr_b16 a[162:163], v232 offset:4128
v_add_f32 v11, v11, v184
v_mfma_f32_16x16x32_bf16 a[4:7], a[132:135], v[192:195], a[4:7]
v_exp_f32 v185, v185
v_mfma_f32_16x16x32_bf16 a[8:11], a[136:139], v[192:195], a[8:11]
ds_read_b64_tr_b16 a[164:165], v232 offset:8
v_cvt_pk_bf16_f32 v196, v184, v185
v_add_f32 v11, v11, v185
v_mfma_f32_16x16x32_bf16 a[12:15], a[140:143], v[192:195], a[12:15]
v_exp_f32 v186, v186
v_mfma_f32_16x16x32_bf16 a[16:19], a[144:147], v[192:195], a[16:19]
ds_read_b64_tr_b16 a[166:167], v232 offset:4136
v_add_f32 v11, v11, v186
v_mfma_f32_16x16x32_bf16 a[20:23], a[148:151], v[192:195], a[20:23]
ds_read_b64_tr_b16 a[168:169], v232 offset:256
v_exp_f32 v187, v187
v_mfma_f32_16x16x32_bf16 a[24:27], a[152:155], v[192:195], a[24:27]
v_cvt_pk_bf16_f32 v197, v186, v187
v_add_f32 v11, v11, v187
v_mfma_f32_16x16x32_bf16 a[28:31], a[156:159], v[192:195], a[28:31]
s_waitcnt lgkmcnt(4)
v_exp_f32 v188, v188
v_mfma_f32_16x16x32_bf16 v[176:179], a[224:227], v[16:19], -4.0
ds_read_b64_tr_b16 a[170:171], v232 offset:4384
v_add_f32 v11, v11, v188
v_mfma_f32_16x16x32_bf16 v[176:179], a[228:231], v[20:23], v[176:179]
ds_read_b64_tr_b16 a[172:173], v232 offset:264
v_exp_f32 v189, v189
v_mfma_f32_16x16x32_bf16 v[176:179], a[232:235], v[24:27], v[176:179]
v_cvt_pk_bf16_f32 v198, v188, v189
v_add_f32 v11, v11, v189
v_mfma_f32_16x16x32_bf16 v[176:179], a[236:239], v[28:31], v[176:179]
ds_read_b64_tr_b16 a[174:175], v232 offset:4392
v_exp_f32 v190, v190
v_mfma_f32_16x16x32_bf16 v[180:183], a[240:243], v[16:19], -4.0
ds_read_b64_tr_b16 a[176:177], v232 offset:512
v_add_f32 v11, v11, v190
v_mfma_f32_16x16x32_bf16 v[180:183], a[244:247], v[20:23], v[180:183]
ds_read_b64_tr_b16 a[178:179], v232 offset:4640
v_exp_f32 v191, v191
v_mfma_f32_16x16x32_bf16 v[180:183], a[248:251], v[24:27], v[180:183]
v_cvt_pk_bf16_f32 v199, v190, v191
v_add_f32 v11, v11, v191
v_mfma_f32_16x16x32_bf16 v[180:183], a[252:255], v[28:31], v[180:183]
ds_read_b64_tr_b16 a[180:181], v232 offset:520
v_exp_f32 v176, v176
v_mfma_f32_16x16x32_bf16 a[32:35], a[128:131], v[196:199], a[32:35]
ds_read_b64_tr_b16 a[182:183], v232 offset:4648
v_add_f32 v10, v10, v176
v_mfma_f32_16x16x32_bf16 a[36:39], a[132:135], v[196:199], a[36:39]
v_exp_f32 v177, v177
v_mfma_f32_16x16x32_bf16 a[40:43], a[136:139], v[196:199], a[40:43]
ds_read_b64_tr_b16 a[184:185], v232 offset:768
v_cvt_pk_bf16_f32 v192, v176, v177
v_add_f32 v10, v10, v177
v_mfma_f32_16x16x32_bf16 a[44:47], a[140:143], v[196:199], a[44:47]
v_exp_f32 v178, v178
v_mfma_f32_16x16x32_bf16 a[48:51], a[144:147], v[196:199], a[48:51]
ds_read_b64_tr_b16 a[186:187], v232 offset:4896
v_add_f32 v10, v10, v178
v_mfma_f32_16x16x32_bf16 a[52:55], a[148:151], v[196:199], a[52:55]
ds_read_b64_tr_b16 a[188:189], v232 offset:776
v_exp_f32 v179, v179
v_mfma_f32_16x16x32_bf16 a[56:59], a[152:155], v[196:199], a[56:59]
v_cvt_pk_bf16_f32 v193, v178, v179
v_add_f32 v10, v10, v179
v_mfma_f32_16x16x32_bf16 a[60:63], a[156:159], v[196:199], a[60:63]
ds_read_b64_tr_b16 a[190:191], v232 offset:4904
v_exp_f32 v180, v180
v_mfma_f32_16x16x32_bf16 v[184:187], a[192:195], v[48:51], -4.0
v_add_f32 v10, v10, v180
v_mfma_f32_16x16x32_bf16 v[184:187], a[196:199], v[52:55], v[184:187]
v_exp_f32 v181, v181
v_mfma_f32_16x16x32_bf16 v[184:187], a[200:203], v[56:59], v[184:187]
v_cvt_pk_bf16_f32 v194, v180, v181
v_add_f32 v10, v10, v181
v_mfma_f32_16x16x32_bf16 v[184:187], a[204:207], v[60:63], v[184:187]
v_exp_f32 v182, v182
v_mfma_f32_16x16x32_bf16 v[188:191], a[208:211], v[48:51], -4.0
v_add_f32 v10, v10, v182
v_mfma_f32_16x16x32_bf16 v[188:191], a[212:215], v[52:55], v[188:191]
v_exp_f32 v183, v183
v_mfma_f32_16x16x32_bf16 v[188:191], a[216:219], v[56:59], v[188:191]
v_cvt_pk_bf16_f32 v195, v182, v183
v_add_f32 v10, v10, v183
v_mfma_f32_16x16x32_bf16 v[188:191], a[220:223], v[60:63], v[188:191]
s_waitcnt lgkmcnt(0)
v_exp_f32 v184, v184
v_mfma_f32_16x16x32_bf16 a[0:3], a[160:163], v[192:195], a[0:3]
ds_read_b128 a[192:195], v1 offset:0
v_add_f32 v12, v12, v184
v_mfma_f32_16x16x32_bf16 a[4:7], a[164:167], v[192:195], a[4:7]
v_exp_f32 v185, v185
v_mfma_f32_16x16x32_bf16 a[8:11], a[168:171], v[192:195], a[8:11]
v_cvt_pk_bf16_f32 v196, v184, v185
v_add_f32 v12, v12, v185
v_mfma_f32_16x16x32_bf16 a[12:15], a[172:175], v[192:195], a[12:15]
v_exp_f32 v186, v186
v_mfma_f32_16x16x32_bf16 a[16:19], a[176:179], v[192:195], a[16:19]
ds_read_b128 a[196:199], v1 offset:256
v_add_f32 v12, v12, v186
v_mfma_f32_16x16x32_bf16 a[20:23], a[180:183], v[192:195], a[20:23]
v_exp_f32 v187, v187
v_mfma_f32_16x16x32_bf16 a[24:27], a[184:187], v[192:195], a[24:27]
v_cvt_pk_bf16_f32 v197, v186, v187
v_add_f32 v12, v12, v187
v_mfma_f32_16x16x32_bf16 a[28:31], a[188:191], v[192:195], a[28:31]
v_exp_f32 v188, v188
v_mfma_f32_16x16x4_f32 v[200:203], v7, v10, 0
s_add_u32 s3, s27, 0
v_accvgpr_read_b32 v204, a0
v_accvgpr_read_b32 v205, a1
v_accvgpr_read_b32 v206, a2
v_accvgpr_read_b32 v207, a3
v_accvgpr_read_b32 v208, a4
v_accvgpr_read_b32 v209, a5
v_accvgpr_read_b32 v210, a6
v_accvgpr_read_b32 v211, a7
v_accvgpr_read_b32 v212, a8
v_accvgpr_read_b32 v213, a9
v_accvgpr_read_b32 v214, a10
v_accvgpr_read_b32 v215, a11
v_accvgpr_read_b32 v216, a12
v_accvgpr_read_b32 v217, a13
v_accvgpr_read_b32 v218, a14
v_accvgpr_read_b32 v219, a15
v_rcp_f32 v200, v200
v_subrev_u32 v202, s47, v201
v_max_u32 v9, v9, v202
v_pk_mul_f32 v[204:205], v[204:205], v[200:201] op_sel_hi:[1,0]
v_pk_mul_f32 v[206:207], v[206:207], v[200:201] op_sel_hi:[1,0]
v_pk_mul_f32 v[208:209], v[208:209], v[200:201] op_sel_hi:[1,0]
v_pk_mul_f32 v[210:211], v[210:211], v[200:201] op_sel_hi:[1,0]
v_cvt_pk_bf16_f32 v220, v204, v205
v_cvt_pk_bf16_f32 v221, v206, v207
v_cvt_pk_bf16_f32 v222, v208, v209
v_cvt_pk_bf16_f32 v223, v210, v211
v_accvgpr_read_b32 v204, a16
v_accvgpr_read_b32 v205, a17
v_accvgpr_read_b32 v206, a18
v_accvgpr_read_b32 v207, a19
v_accvgpr_read_b32 v208, a20
v_accvgpr_read_b32 v209, a21
v_accvgpr_read_b32 v210, a22
v_accvgpr_read_b32 v211, a23
v_pk_mul_f32 v[212:213], v[212:213], v[200:201] op_sel_hi:[1,0]
v_pk_mul_f32 v[214:215], v[214:215], v[200:201] op_sel_hi:[1,0]
v_pk_mul_f32 v[216:217], v[216:217], v[200:201] op_sel_hi:[1,0]
v_pk_mul_f32 v[218:219], v[218:219], v[200:201] op_sel_hi:[1,0]
v_cvt_pk_bf16_f32 v224, v212, v213
v_cvt_pk_bf16_f32 v225, v214, v215
v_cvt_pk_bf16_f32 v226, v216, v217
v_cvt_pk_bf16_f32 v227, v218, v219
v_cndmask_b32_dpp v244, v220, v224, vcc row_ror:8 row_mask:0xf bank_mask:0xf
v_cndmask_b32_dpp v245, v221, v225, vcc row_ror:8 row_mask:0xf bank_mask:0xf
v_cndmask_b32_dpp v246, v222, v226, vcc row_ror:8 row_mask:0xf bank_mask:0xf
v_cndmask_b32_dpp v247, v223, v227, vcc row_ror:8 row_mask:0xf bank_mask:0xf
s_not_b64 vcc, vcc
v_cndmask_b32_dpp v240, v224, v220, vcc row_ror:8 row_mask:0xf bank_mask:0xf
v_cndmask_b32_dpp v241, v225, v221, vcc row_ror:8 row_mask:0xf bank_mask:0xf
v_cndmask_b32_dpp v242, v226, v222, vcc row_ror:8 row_mask:0xf bank_mask:0xf
v_cndmask_b32_dpp v243, v227, v223, vcc row_ror:8 row_mask:0xf bank_mask:0xf
s_not_b64 vcc, vcc
v_accvgpr_read_b32 v212, a24
v_accvgpr_read_b32 v213, a25
buffer_store_dwordx4 v[240:243], v233, s[16:19], s3 offen offset:0 sc1
v_accvgpr_read_b32 v214, a26
v_accvgpr_read_b32 v215, a27
v_accvgpr_read_b32 v216, a28
v_accvgpr_read_b32 v217, a29
v_accvgpr_read_b32 v218, a30
v_accvgpr_read_b32 v219, a31
v_pk_mul_f32 v[204:205], v[204:205], v[200:201] op_sel_hi:[1,0]
v_pk_mul_f32 v[206:207], v[206:207], v[200:201] op_sel_hi:[1,0]
v_pk_mul_f32 v[208:209], v[208:209], v[200:201] op_sel_hi:[1,0]
v_pk_mul_f32 v[210:211], v[210:211], v[200:201] op_sel_hi:[1,0]
v_cvt_pk_bf16_f32 v220, v204, v205
v_cvt_pk_bf16_f32 v221, v206, v207
v_cvt_pk_bf16_f32 v222, v208, v209
v_cvt_pk_bf16_f32 v223, v210, v211
v_pk_mul_f32 v[212:213], v[212:213], v[200:201] op_sel_hi:[1,0]
v_pk_mul_f32 v[214:215], v[214:215], v[200:201] op_sel_hi:[1,0]
v_pk_mul_f32 v[216:217], v[216:217], v[200:201] op_sel_hi:[1,0]
v_pk_mul_f32 v[218:219], v[218:219], v[200:201] op_sel_hi:[1,0]
v_cvt_pk_bf16_f32 v224, v212, v213
v_cvt_pk_bf16_f32 v225, v214, v215
v_cvt_pk_bf16_f32 v226, v216, v217
v_cvt_pk_bf16_f32 v227, v218, v219
v_cndmask_b32_dpp v252, v220, v224, vcc row_ror:8 row_mask:0xf bank_mask:0xf
v_cndmask_b32_dpp v253, v221, v225, vcc row_ror:8 row_mask:0xf bank_mask:0xf
v_cndmask_b32_dpp v254, v222, v226, vcc row_ror:8 row_mask:0xf bank_mask:0xf
v_cndmask_b32_dpp v255, v223, v227, vcc row_ror:8 row_mask:0xf bank_mask:0xf
s_not_b64 vcc, vcc
v_cndmask_b32_dpp v248, v224, v220, vcc row_ror:8 row_mask:0xf bank_mask:0xf
v_cndmask_b32_dpp v249, v225, v221, vcc row_ror:8 row_mask:0xf bank_mask:0xf
v_cndmask_b32_dpp v250, v226, v222, vcc row_ror:8 row_mask:0xf bank_mask:0xf
v_cndmask_b32_dpp v251, v227, v223, vcc row_ror:8 row_mask:0xf bank_mask:0xf
s_not_b64 vcc, vcc
v_mfma_f32_16x16x32_bf16 v[176:179], a[224:227], v[32:35], -4.0
ds_read_b128 a[200:203], v1 offset:512
v_add_f32 v12, v12, v188
v_mfma_f32_16x16x32_bf16 v[176:179], a[228:231], v[36:39], v[176:179]
v_exp_f32 v189, v189
v_mfma_f32_16x16x32_bf16 v[176:179], a[232:235], v[40:43], v[176:179]
v_cvt_pk_bf16_f32 v198, v188, v189
v_add_f32 v12, v12, v189
v_mfma_f32_16x16x32_bf16 v[176:179], a[236:239], v[44:47], v[176:179]
v_exp_f32 v190, v190
v_mfma_f32_16x16x32_bf16 v[180:183], a[240:243], v[32:35], -4.0
ds_read_b128 a[204:207], v1 offset:768
v_add_f32 v12, v12, v190
v_mfma_f32_16x16x32_bf16 v[180:183], a[244:247], v[36:39], v[180:183]
buffer_store_dwordx4 v[244:247], v233, s[16:19], s3 offen offset:2048 sc1
v_exp_f32 v191, v191
v_mfma_f32_16x16x32_bf16 v[180:183], a[248:251], v[40:43], v[180:183]
v_cvt_pk_bf16_f32 v199, v190, v191
v_add_f32 v12, v12, v191
v_mfma_f32_16x16x32_bf16 v[180:183], a[252:255], v[44:47], v[180:183]
v_exp_f32 v176, v176
v_mfma_f32_16x16x32_bf16 a[64:67], a[128:131], v[196:199], a[64:67]
ds_read_b128 a[208:211], v1 offset:4096
v_add_f32 v11, v11, v176
v_mfma_f32_16x16x32_bf16 a[68:71], a[132:135], v[196:199], a[68:71]
v_exp_f32 v177, v177
v_mfma_f32_16x16x32_bf16 a[72:75], a[136:139], v[196:199], a[72:75]
v_cvt_pk_bf16_f32 v192, v176, v177
v_add_f32 v11, v11, v177
v_mfma_f32_16x16x32_bf16 a[76:79], a[140:143], v[196:199], a[76:79]
v_exp_f32 v178, v178
v_mfma_f32_16x16x32_bf16 a[80:83], a[144:147], v[196:199], a[80:83]
ds_read_b128 a[212:215], v1 offset:4352
v_add_f32 v11, v11, v178
v_mfma_f32_16x16x32_bf16 a[84:87], a[148:151], v[196:199], a[84:87]
v_exp_f32 v179, v179
v_mfma_f32_16x16x32_bf16 a[88:91], a[152:155], v[196:199], a[88:91]
v_cvt_pk_bf16_f32 v193, v178, v179
v_add_f32 v11, v11, v179
v_mfma_f32_16x16x32_bf16 a[92:95], a[156:159], v[196:199], a[92:95]
v_exp_f32 v180, v180
v_mfma_f32_16x16x32_bf16 v[184:187], a[224:227], v[48:51], -4.0
ds_read_b128 a[216:219], v1 offset:4608
v_add_f32 v11, v11, v180
v_mfma_f32_16x16x32_bf16 v[184:187], a[228:231], v[52:55], v[184:187]
buffer_store_dwordx4 v[248:251], v233, s[16:19], s3 offen offset:128 sc1
v_exp_f32 v181, v181
v_mfma_f32_16x16x32_bf16 v[184:187], a[232:235], v[56:59], v[184:187]
ds_read_b64_tr_b16 a[128:129], v2 offset:0
v_cvt_pk_bf16_f32 v194, v180, v181
v_add_f32 v11, v11, v181
v_mfma_f32_16x16x32_bf16 v[184:187], a[236:239], v[60:63], v[184:187]
v_exp_f32 v182, v182
v_mfma_f32_16x16x32_bf16 v[188:191], a[240:243], v[48:51], -4.0
ds_read_b128 a[220:223], v1 offset:4864
v_add_f32 v11, v11, v182
v_mfma_f32_16x16x32_bf16 v[188:191], a[244:247], v[52:55], v[188:191]
ds_read_b64_tr_b16 a[130:131], v2 offset:4128
v_exp_f32 v183, v183
v_mfma_f32_16x16x32_bf16 v[188:191], a[248:251], v[56:59], v[188:191]
v_cvt_pk_bf16_f32 v195, v182, v183
v_add_f32 v11, v11, v183
v_mfma_f32_16x16x32_bf16 v[188:191], a[252:255], v[60:63], v[188:191]
ds_read_b64_tr_b16 a[132:133], v2 offset:8
v_exp_f32 v184, v184
v_mfma_f32_16x16x32_bf16 a[32:35], a[160:163], v[192:195], a[32:35]
ds_read_b64_tr_b16 a[134:135], v2 offset:4136
v_add_f32 v12, v12, v184
v_mfma_f32_16x16x32_bf16 a[36:39], a[164:167], v[192:195], a[36:39]
v_exp_f32 v185, v185
v_mfma_f32_16x16x32_bf16 a[40:43], a[168:171], v[192:195], a[40:43]
ds_read_b64_tr_b16 a[136:137], v2 offset:256
v_cvt_pk_bf16_f32 v196, v184, v185
v_add_f32 v12, v12, v185
v_mfma_f32_16x16x32_bf16 a[44:47], a[172:175], v[192:195], a[44:47]
ds_read_b128 a[224:227], v1 offset:8192
v_exp_f32 v186, v186
v_mfma_f32_16x16x32_bf16 a[48:51], a[176:179], v[192:195], a[48:51]
ds_read_b64_tr_b16 a[138:139], v2 offset:4384
v_add_f32 v12, v12, v186
v_mfma_f32_16x16x32_bf16 a[52:55], a[180:183], v[192:195], a[52:55]
ds_read_b64_tr_b16 a[140:141], v2 offset:264
v_exp_f32 v187, v187
v_mfma_f32_16x16x32_bf16 a[56:59], a[184:187], v[192:195], a[56:59]
v_cvt_pk_bf16_f32 v197, v186, v187
v_add_f32 v12, v12, v187
v_mfma_f32_16x16x32_bf16 a[60:63], a[188:191], v[192:195], a[60:63]
s_waitcnt lgkmcnt(7)
v_exp_f32 v188, v188
v_mfma_f32_16x16x4_f32 v[200:203], v7, v11, 0
buffer_store_dwordx4 v[252:255], v233, s[16:19], s3 offen offset:2176 sc1
s_add_u32 s3, s27, 4096
v_accvgpr_read_b32 v204, a32
v_accvgpr_read_b32 v205, a33
v_accvgpr_read_b32 v206, a34
v_accvgpr_read_b32 v207, a35
v_accvgpr_read_b32 v208, a36
v_accvgpr_read_b32 v209, a37
v_accvgpr_read_b32 v210, a38
v_accvgpr_read_b32 v211, a39
v_accvgpr_read_b32 v212, a40
v_accvgpr_read_b32 v213, a41
v_accvgpr_read_b32 v214, a42
v_accvgpr_read_b32 v215, a43
v_accvgpr_read_b32 v216, a44
v_accvgpr_read_b32 v217, a45
v_accvgpr_read_b32 v218, a46
v_accvgpr_read_b32 v219, a47
v_rcp_f32 v200, v200
v_subrev_u32 v202, s47, v201
v_max_u32 v9, v9, v202
v_pk_mul_f32 v[204:205], v[204:205], v[200:201] op_sel_hi:[1,0]
v_pk_mul_f32 v[206:207], v[206:207], v[200:201] op_sel_hi:[1,0]
v_pk_mul_f32 v[208:209], v[208:209], v[200:201] op_sel_hi:[1,0]
v_pk_mul_f32 v[210:211], v[210:211], v[200:201] op_sel_hi:[1,0]
v_cvt_pk_bf16_f32 v220, v204, v205
v_cvt_pk_bf16_f32 v221, v206, v207
v_cvt_pk_bf16_f32 v222, v208, v209
v_cvt_pk_bf16_f32 v223, v210, v211
v_accvgpr_read_b32 v204, a48
v_accvgpr_read_b32 v205, a49
v_accvgpr_read_b32 v206, a50
v_accvgpr_read_b32 v207, a51
v_accvgpr_read_b32 v208, a52
v_accvgpr_read_b32 v209, a53
v_accvgpr_read_b32 v210, a54
v_accvgpr_read_b32 v211, a55
v_pk_mul_f32 v[212:213], v[212:213], v[200:201] op_sel_hi:[1,0]
v_pk_mul_f32 v[214:215], v[214:215], v[200:201] op_sel_hi:[1,0]
v_pk_mul_f32 v[216:217], v[216:217], v[200:201] op_sel_hi:[1,0]
v_pk_mul_f32 v[218:219], v[218:219], v[200:201] op_sel_hi:[1,0]
v_cvt_pk_bf16_f32 v224, v212, v213
v_cvt_pk_bf16_f32 v225, v214, v215
v_cvt_pk_bf16_f32 v226, v216, v217
v_cvt_pk_bf16_f32 v227, v218, v219
v_cndmask_b32_dpp v244, v220, v224, vcc row_ror:8 row_mask:0xf bank_mask:0xf
v_cndmask_b32_dpp v245, v221, v225, vcc row_ror:8 row_mask:0xf bank_mask:0xf
v_cndmask_b32_dpp v246, v222, v226, vcc row_ror:8 row_mask:0xf bank_mask:0xf
v_cndmask_b32_dpp v247, v223, v227, vcc row_ror:8 row_mask:0xf bank_mask:0xf
s_not_b64 vcc, vcc
v_cndmask_b32_dpp v240, v224, v220, vcc row_ror:8 row_mask:0xf bank_mask:0xf
v_cndmask_b32_dpp v241, v225, v221, vcc row_ror:8 row_mask:0xf bank_mask:0xf
v_cndmask_b32_dpp v242, v226, v222, vcc row_ror:8 row_mask:0xf bank_mask:0xf
v_cndmask_b32_dpp v243, v227, v223, vcc row_ror:8 row_mask:0xf bank_mask:0xf
s_not_b64 vcc, vcc
v_accvgpr_read_b32 v212, a56
v_accvgpr_read_b32 v213, a57
buffer_store_dwordx4 v[240:243], v233, s[16:19], s3 offen offset:0 sc1
v_accvgpr_read_b32 v214, a58
v_accvgpr_read_b32 v215, a59
v_accvgpr_read_b32 v216, a60
v_accvgpr_read_b32 v217, a61
v_accvgpr_read_b32 v218, a62
v_accvgpr_read_b32 v219, a63
v_pk_mul_f32 v[204:205], v[204:205], v[200:201] op_sel_hi:[1,0]
v_pk_mul_f32 v[206:207], v[206:207], v[200:201] op_sel_hi:[1,0]
v_pk_mul_f32 v[208:209], v[208:209], v[200:201] op_sel_hi:[1,0]
v_pk_mul_f32 v[210:211], v[210:211], v[200:201] op_sel_hi:[1,0]
v_cvt_pk_bf16_f32 v220, v204, v205
v_cvt_pk_bf16_f32 v221, v206, v207
v_cvt_pk_bf16_f32 v222, v208, v209
v_cvt_pk_bf16_f32 v223, v210, v211
v_pk_mul_f32 v[212:213], v[212:213], v[200:201] op_sel_hi:[1,0]
v_pk_mul_f32 v[214:215], v[214:215], v[200:201] op_sel_hi:[1,0]
v_pk_mul_f32 v[216:217], v[216:217], v[200:201] op_sel_hi:[1,0]
v_pk_mul_f32 v[218:219], v[218:219], v[200:201] op_sel_hi:[1,0]
v_cvt_pk_bf16_f32 v224, v212, v213
L_pad13:
s_cbranch_execz L_padret
v_cvt_pk_bf16_f32 v225, v214, v215
v_cvt_pk_bf16_f32 v226, v216, v217
v_cvt_pk_bf16_f32 v227, v218, v219
v_cndmask_b32_dpp v252, v220, v224, vcc row_ror:8 row_mask:0xf bank_mask:0xf
v_cndmask_b32_dpp v253, v221, v225, vcc row_ror:8 row_mask:0xf bank_mask:0xf
v_cndmask_b32_dpp v254, v222, v226, vcc row_ror:8 row_mask:0xf bank_mask:0xf
v_cndmask_b32_dpp v255, v223, v227, vcc row_ror:8 row_mask:0xf bank_mask:0xf
s_not_b64 vcc, vcc
v_cndmask_b32_dpp v248, v224, v220, vcc row_ror:8 row_mask:0xf bank_mask:0xf
v_cndmask_b32_dpp v249, v225, v221, vcc row_ror:8 row_mask:0xf bank_mask:0xf
v_cndmask_b32_dpp v250, v226, v222, vcc row_ror:8 row_mask:0xf bank_mask:0xf
v_cndmask_b32_dpp v251, v227, v223, vcc row_ror:8 row_mask:0xf bank_mask:0xf
s_not_b64 vcc, vcc
v_mfma_f32_16x16x32_bf16 v[176:179], a[192:195], v[64:67], -4.0
ds_read_b64_tr_b16 a[142:143], v2 offset:4392
v_add_f32 v12, v12, v188
v_mfma_f32_16x16x32_bf16 v[176:179], a[196:199], v[68:71], v[176:179]
buffer_store_dwordx4 v[244:247], v233, s[16:19], s3 offen offset:2048 sc1
v_exp_f32 v189, v189
v_mfma_f32_16x16x32_bf16 v[176:179], a[200:203], v[72:75], v[176:179]
ds_read_b64_tr_b16 a[144:145], v2 offset:512
v_cvt_pk_bf16_f32 v198, v188, v189
v_add_f32 v12, v12, v189
v_mfma_f32_16x16x32_bf16 v[176:179], a[204:207], v[76:79], v[176:179]
ds_read_b128 a[228:231], v1 offset:8448
v_exp_f32 v190, v190
v_mfma_f32_16x16x32_bf16 v[180:183], a[208:211], v[64:67], -4.0
ds_read_b64_tr_b16 a[146:147], v2 offset:4640
v_add_f32 v12, v12, v190
v_mfma_f32_16x16x32_bf16 v[180:183], a[212:215], v[68:71], v[180:183]
ds_read_b64_tr_b16 a[148:149], v2 offset:520
v_exp_f32 v191, v191
v_mfma_f32_16x16x32_bf16 v[180:183], a[216:219], v[72:75], v[180:183]
v_cvt_pk_bf16_f32 v199, v190, v191
v_add_f32 v12, v12, v191
v_mfma_f32_16x16x32_bf16 v[180:183], a[220:223], v[76:79], v[180:183]
ds_read_b64_tr_b16 a[150:151], v2 offset:4648
v_exp_f32 v176, v176
v_mfma_f32_16x16x32_bf16 a[64:67], a[160:163], v[196:199], a[64:67]
ds_read_b64_tr_b16 a[152:153], v2 offset:768
v_add_f32 v13, v13, v176
v_mfma_f32_16x16x32_bf16 a[68:71], a[164:167], v[196:199], a[68:71]
buffer_store_dwordx4 v[248:251], v233, s[16:19], s3 offen offset:128 sc1
v_exp_f32 v177, v177
v_mfma_f32_16x16x32_bf16 a[72:75], a[168:171], v[196:199], a[72:75]
ds_read_b128 a[232:235], v1 offset:8704
v_cvt_pk_bf16_f32 v192, v176, v177
v_add_f32 v13, v13, v177
v_mfma_f32_16x16x32_bf16 a[76:79], a[172:175], v[196:199], a[76:79]
ds_read_b64_tr_b16 a[154:155], v2 offset:4896
v_exp_f32 v178, v178
v_mfma_f32_16x16x32_bf16 a[80:83], a[176:179], v[196:199], a[80:83]
ds_read_b64_tr_b16 a[156:157], v2 offset:776
v_add_f32 v13, v13, v178
v_mfma_f32_16x16x32_bf16 a[84:87], a[180:183], v[196:199], a[84:87]
v_exp_f32 v179, v179
v_mfma_f32_16x16x32_bf16 a[88:91], a[184:187], v[196:199], a[88:91]
ds_read_b64_tr_b16 a[158:159], v2 offset:4904
v_cvt_pk_bf16_f32 v193, v178, v179
v_add_f32 v13, v13, v179
v_mfma_f32_16x16x32_bf16 a[92:95], a[188:191], v[196:199], a[92:95]
ds_read_b128 a[236:239], v1 offset:8960
v_exp_f32 v180, v180
v_mfma_f32_16x16x4_f32 v[200:203], v7, v12, 0
buffer_store_dwordx4 v[252:255], v233, s[16:19], s3 offen offset:2176 sc1
s_add_u32 s3, s27, 8192
v_accvgpr_read_b32 v204, a64
v_accvgpr_read_b32 v205, a65
v_accvgpr_read_b32 v206, a66
v_accvgpr_read_b32 v207, a67
v_accvgpr_read_b32 v208, a68
v_accvgpr_read_b32 v209, a69
v_accvgpr_read_b32 v210, a70
v_accvgpr_read_b32 v211, a71
v_accvgpr_read_b32 v212, a72
v_accvgpr_read_b32 v213, a73
v_accvgpr_read_b32 v214, a74
v_accvgpr_read_b32 v215, a75
v_accvgpr_read_b32 v216, a76
v_accvgpr_read_b32 v217, a77
v_accvgpr_read_b32 v218, a78
v_accvgpr_read_b32 v219, a79
v_rcp_f32 v200, v200
v_subrev_u32 v202, s47, v201
v_max_u32 v9, v9, v202
v_pk_mul_f32 v[204:205], v[204:205], v[200:201] op_sel_hi:[1,0]
v_pk_mul_f32 v[206:207], v[206:207], v[200:201] op_sel_hi:[1,0]
v_pk_mul_f32 v[208:209], v[208:209], v[200:201] op_sel_hi:[1,0]
v_pk_mul_f32 v[210:211], v[210:211], v[200:201] op_sel_hi:[1,0]
v_cvt_pk_bf16_f32 v220, v204, v205
v_cvt_pk_bf16_f32 v221, v206, v207
v_cvt_pk_bf16_f32 v222, v208, v209
v_cvt_pk_bf16_f32 v223, v210, v211
v_accvgpr_read_b32 v204, a80
v_accvgpr_read_b32 v205, a81
v_accvgpr_read_b32 v206, a82
v_accvgpr_read_b32 v207, a83
v_accvgpr_read_b32 v208, a84
v_accvgpr_read_b32 v209, a85
v_accvgpr_read_b32 v210, a86
v_accvgpr_read_b32 v211, a87
v_pk_mul_f32 v[212:213], v[212:213], v[200:201] op_sel_hi:[1,0]
v_pk_mul_f32 v[214:215], v[214:215], v[200:201] op_sel_hi:[1,0]
v_pk_mul_f32 v[216:217], v[216:217], v[200:201] op_sel_hi:[1,0]
v_pk_mul_f32 v[218:219], v[218:219], v[200:201] op_sel_hi:[1,0]
v_cvt_pk_bf16_f32 v224, v212, v213
v_cvt_pk_bf16_f32 v225, v214, v215
v_cvt_pk_bf16_f32 v226, v216, v217
v_cvt_pk_bf16_f32 v227, v218, v219
v_cndmask_b32_dpp v244, v220, v224, vcc row_ror:8 row_mask:0xf bank_mask:0xf
v_cndmask_b32_dpp v245, v221, v225, vcc row_ror:8 row_mask:0xf bank_mask:0xf
v_cndmask_b32_dpp v246, v222, v226, vcc row_ror:8 row_mask:0xf bank_mask:0xf
v_cndmask_b32_dpp v247, v223, v227, vcc row_ror:8 row_mask:0xf bank_mask:0xf
s_not_b64 vcc, vcc
v_cndmask_b32_dpp v240, v224, v220, vcc row_ror:8 row_mask:0xf bank_mask:0xf
v_cndmask_b32_dpp v241, v225, v221, vcc row_ror:8 row_mask:0xf bank_mask:0xf
v_cndmask_b32_dpp v242, v226, v222, vcc row_ror:8 row_mask:0xf bank_mask:0xf
v_cndmask_b32_dpp v243, v227, v223, vcc row_ror:8 row_mask:0xf bank_mask:0xf
s_not_b64 vcc, vcc
v_accvgpr_read_b32 v212, a88
v_accvgpr_read_b32 v213, a89
buffer_store_dwordx4 v[240:243], v233, s[16:19], s3 offen offset:0 sc1
v_accvgpr_read_b32 v214, a90
v_accvgpr_read_b32 v215, a91
v_accvgpr_read_b32 v216, a92
v_accvgpr_read_b32 v217, a93
v_accvgpr_read_b32 v218, a94
v_accvgpr_read_b32 v219, a95
v_pk_mul_f32 v[204:205], v[204:205], v[200:201] op_sel_hi:[1,0]
v_pk_mul_f32 v[206:207], v[206:207], v[200:201] op_sel_hi:[1,0]
v_pk_mul_f32 v[208:209], v[208:209], v[200:201] op_sel_hi:[1,0]
v_pk_mul_f32 v[210:211], v[210:211], v[200:201] op_sel_hi:[1,0]
v_cvt_pk_bf16_f32 v220, v204, v205
v_cvt_pk_bf16_f32 v221, v206, v207
v_cvt_pk_bf16_f32 v222, v208, v209
v_cvt_pk_bf16_f32 v223, v210, v211
v_pk_mul_f32 v[212:213], v[212:213], v[200:201] op_sel_hi:[1,0]
v_pk_mul_f32 v[214:215], v[214:215], v[200:201] op_sel_hi:[1,0]
v_pk_mul_f32 v[216:217], v[216:217], v[200:201] op_sel_hi:[1,0]
v_pk_mul_f32 v[218:219], v[218:219], v[200:201] op_sel_hi:[1,0]
v_cvt_pk_bf16_f32 v224, v212, v213
v_cvt_pk_bf16_f32 v225, v214, v215
v_cvt_pk_bf16_f32 v226, v216, v217
v_cvt_pk_bf16_f32 v227, v218, v219
v_cndmask_b32_dpp v252, v220, v224, vcc row_ror:8 row_mask:0xf bank_mask:0xf
v_cndmask_b32_dpp v253, v221, v225, vcc row_ror:8 row_mask:0xf bank_mask:0xf
v_cndmask_b32_dpp v254, v222, v226, vcc row_ror:8 row_mask:0xf bank_mask:0xf
v_cndmask_b32_dpp v255, v223, v227, vcc row_ror:8 row_mask:0xf bank_mask:0xf
s_not_b64 vcc, vcc
v_cndmask_b32_dpp v248, v224, v220, vcc row_ror:8 row_mask:0xf bank_mask:0xf
v_cndmask_b32_dpp v249, v225, v221, vcc row_ror:8 row_mask:0xf bank_mask:0xf
v_cndmask_b32_dpp v250, v226, v222, vcc row_ror:8 row_mask:0xf bank_mask:0xf
v_cndmask_b32_dpp v251, v227, v223, vcc row_ror:8 row_mask:0xf bank_mask:0xf
s_not_b64 vcc, vcc
v_mfma_f32_16x16x32_bf16 v[184:187], a[192:195], v[80:83], -4.0
ds_read_b128 a[240:243], v1 offset:12288
v_add_f32 v13, v13, v180
v_mfma_f32_16x16x32_bf16 v[184:187], a[196:199], v[84:87], v[184:187]
ds_read_b64_tr_b16 a[160:161], v2 offset:8256
v_exp_f32 v181, v181
v_mfma_f32_16x16x32_bf16 v[184:187], a[200:203], v[88:91], v[184:187]
ds_read_b128 a[244:247], v1 offset:12544
v_cvt_pk_bf16_f32 v194, v180, v181
v_add_f32 v13, v13, v181
v_mfma_f32_16x16x32_bf16 v[184:187], a[204:207], v[92:95], v[184:187]
v_exp_f32 v182, v182
v_mfma_f32_16x16x32_bf16 v[188:191], a[208:211], v[80:83], -4.0
ds_read_b128 a[248:251], v1 offset:12800
v_add_f32 v13, v13, v182
v_mfma_f32_16x16x32_bf16 v[188:191], a[212:215], v[84:87], v[188:191]
ds_read_b128 a[252:255], v1 offset:13056
v_exp_f32 v183, v183
v_mfma_f32_16x16x32_bf16 v[188:191], a[216:219], v[88:91], v[188:191]
s_waitcnt lgkmcnt(6)
v_cvt_pk_bf16_f32 v195, v182, v183
v_add_f32 v13, v13, v183
v_mfma_f32_16x16x32_bf16 v[188:191], a[220:223], v[92:95], v[188:191]
buffer_store_dwordx4 v[244:247], v233, s[16:19], s3 offen offset:2048 sc1
v_exp_f32 v184, v184
v_mfma_f32_16x16x32_bf16 v[112:115], a[128:131], v[192:195], v[112:115]
ds_read_b64_tr_b16 a[162:163], v2 offset:12384
v_add_f32 v14, v14, v184
v_mfma_f32_16x16x32_bf16 v[116:119], a[132:135], v[192:195], v[116:119]
ds_read_b64_tr_b16 a[164:165], v2 offset:8264
v_exp_f32 v185, v185
v_mfma_f32_16x16x32_bf16 v[120:123], a[136:139], v[192:195], v[120:123]
ds_read_b128 a[192:195], v1 offset:16384
v_cvt_pk_bf16_f32 v196, v184, v185
v_add_f32 v14, v14, v185
v_mfma_f32_16x16x32_bf16 v[124:127], a[140:143], v[192:195], v[124:127]
ds_read_b64_tr_b16 a[166:167], v2 offset:12392
v_exp_f32 v186, v186
v_mfma_f32_16x16x32_bf16 v[128:131], a[144:147], v[192:195], v[128:131]
ds_read_b64_tr_b16 a[168:169], v2 offset:8512
v_add_f32 v14, v14, v186
v_mfma_f32_16x16x32_bf16 v[132:135], a[148:151], v[192:195], v[132:135]
ds_read_b64_tr_b16 a[170:171], v2 offset:12640
v_exp_f32 v187, v187
v_mfma_f32_16x16x32_bf16 v[136:139], a[152:155], v[192:195], v[136:139]
v_cvt_pk_bf16_f32 v197, v186, v187
v_add_f32 v14, v14, v187
v_mfma_f32_16x16x32_bf16 v[140:143], a[156:159], v[192:195], v[140:143]
s_waitcnt lgkmcnt(6)
v_exp_f32 v188, v188
v_mfma_f32_16x16x32_bf16 v[176:179], a[224:227], v[64:67], -4.0
ds_read_b64_tr_b16 a[172:173], v2 offset:8520
v_add_f32 v14, v14, v188
v_mfma_f32_16x16x32_bf16 v[176:179], a[228:231], v[68:71], v[176:179]
ds_read_b64_tr_b16 a[174:175], v2 offset:12648
v_exp_f32 v189, v189
v_mfma_f32_16x16x32_bf16 v[176:179], a[232:235], v[72:75], v[176:179]
ds_read_b128 a[196:199], v1 offset:16640
v_cvt_pk_bf16_f32 v198, v188, v189
v_add_f32 v14, v14, v189
v_mfma_f32_16x16x32_bf16 v[176:179], a[236:239], v[76:79], v[176:179]
ds_read_b64_tr_b16 a[176:177], v2 offset:8768
v_exp_f32 v190, v190
v_mfma_f32_16x16x32_bf16 v[180:183], a[240:243], v[64:67], -4.0
ds_read_b64_tr_b16 a[178:179], v2 offset:12896
v_add_f32 v14, v14, v190
v_mfma_f32_16x16x32_bf16 v[180:183], a[244:247], v[68:71], v[180:183]
v_exp_f32 v191, v191
v_mfma_f32_16x16x32_bf16 v[180:183], a[248:251], v[72:75], v[180:183]
ds_read_b64_tr_b16 a[180:181], v2 offset:8776
v_cvt_pk_bf16_f32 v199, v190, v191
v_add_f32 v14, v14, v191
v_mfma_f32_16x16x32_bf16 v[180:183], a[252:255], v[76:79], v[180:183]
buffer_store_dwordx4 v[248:251], v233, s[16:19], s3 offen offset:128 sc1
v_exp_f32 v176, v176
v_mfma_f32_16x16x32_bf16 v[144:147], a[128:131], v[196:199], v[144:147]
ds_read_b64_tr_b16 a[182:183], v2 offset:12904
v_add_f32 v13, v13, v176
v_mfma_f32_16x16x32_bf16 v[148:151], a[132:135], v[196:199], v[148:151]
ds_read_b64_tr_b16 a[184:185], v2 offset:9024
v_exp_f32 v177, v177
v_mfma_f32_16x16x32_bf16 v[152:155], a[136:139], v[196:199], v[152:155]
ds_read_b128 a[200:203], v1 offset:16896
v_cvt_pk_bf16_f32 v192, v176, v177
v_add_f32 v13, v13, v177
v_mfma_f32_16x16x32_bf16 v[156:159], a[140:143], v[196:199], v[156:159]
ds_read_b64_tr_b16 a[186:187], v2 offset:13152
v_exp_f32 v178, v178
v_mfma_f32_16x16x32_bf16 v[160:163], a[144:147], v[196:199], v[160:163]
ds_read_b64_tr_b16 a[188:189], v2 offset:9032
v_add_f32 v13, v13, v178
v_mfma_f32_16x16x32_bf16 v[164:167], a[148:151], v[196:199], v[164:167]
v_exp_f32 v179, v179
v_mfma_f32_16x16x32_bf16 v[168:171], a[152:155], v[196:199], v[168:171]
ds_read_b64_tr_b16 a[190:191], v2 offset:13160
v_cvt_pk_bf16_f32 v193, v178, v179
v_add_f32 v13, v13, v179
v_mfma_f32_16x16x32_bf16 v[172:175], a[156:159], v[196:199], v[172:175]
ds_read_b128 a[204:207], v1 offset:17152
v_exp_f32 v180, v180
v_mfma_f32_16x16x32_bf16 v[184:187], a[224:227], v[80:83], -4.0
ds_read_b128 a[208:211], v1 offset:20480
v_add_f32 v13, v13, v180
v_mfma_f32_16x16x32_bf16 v[184:187], a[228:231], v[84:87], v[184:187]
ds_read_b64_tr_b16 a[128:129], v2 offset:16512
v_exp_f32 v181, v181
v_mfma_f32_16x16x32_bf16 v[184:187], a[232:235], v[88:91], v[184:187]
ds_read_b128 a[212:215], v1 offset:20736
v_cvt_pk_bf16_f32 v194, v180, v181
v_add_f32 v13, v13, v181
v_mfma_f32_16x16x32_bf16 v[184:187], a[236:239], v[92:95], v[184:187]
ds_read_b64_tr_b16 a[130:131], v2 offset:20640
v_exp_f32 v182, v182
v_mfma_f32_16x16x32_bf16 v[188:191], a[240:243], v[80:83], -4.0
ds_read_b128 a[216:219], v1 offset:20992
v_add_f32 v13, v13, v182
v_mfma_f32_16x16x32_bf16 v[188:191], a[244:247], v[84:87], v[188:191]
ds_read_b128 a[220:223], v1 offset:21248
v_exp_f32 v183, v183
v_mfma_f32_16x16x32_bf16 v[188:191], a[248:251], v[88:91], v[188:191]
s_waitcnt lgkmcnt(7)
v_cvt_pk_bf16_f32 v195, v182, v183
v_add_f32 v13, v13, v183
v_mfma_f32_16x16x32_bf16 v[188:191], a[252:255], v[92:95], v[188:191]
buffer_store_dwordx4 v[252:255], v233, s[16:19], s3 offen offset:2176 sc1
v_exp_f32 v184, v184
v_mfma_f32_16x16x32_bf16 v[112:115], a[160:163], v[192:195], v[112:115]
ds_read_b128 a[224:227], v8 offset:0
v_add_f32 v14, v14, v184
v_mfma_f32_16x16x32_bf16 v[116:119], a[164:167], v[192:195], v[116:119]
ds_read_b64_tr_b16 a[132:133], v2 offset:16520
v_exp_f32 v185, v185
v_mfma_f32_16x16x32_bf16 v[120:123], a[168:171], v[192:195], v[120:123]
ds_read_b128 a[228:231], v8 offset:256
v_cvt_pk_bf16_f32 v196, v184, v185
v_add_f32 v14, v14, v185
v_mfma_f32_16x16x32_bf16 v[124:127], a[172:175], v[192:195], v[124:127]
ds_read_b64_tr_b16 a[134:135], v2 offset:20648
v_exp_f32 v186, v186
v_mfma_f32_16x16x32_bf16 v[128:131], a[176:179], v[192:195], v[128:131]
ds_read_b128 a[232:235], v8 offset:512
v_add_f32 v14, v14, v186
v_mfma_f32_16x16x32_bf16 v[132:135], a[180:183], v[192:195], v[132:135]
ds_read_b64_tr_b16 a[136:137], v2 offset:16768
v_exp_f32 v187, v187
v_mfma_f32_16x16x32_bf16 v[136:139], a[184:187], v[192:195], v[136:139]
ds_read_b128 a[236:239], v8 offset:768
v_cvt_pk_bf16_f32 v197, v186, v187
v_add_f32 v14, v14, v187
v_mfma_f32_16x16x32_bf16 v[140:143], a[188:191], v[192:195], v[140:143]
s_waitcnt lgkmcnt(7)
v_exp_f32 v188, v188
v_mfma_f32_16x16x32_bf16 v[176:179], a[192:195], v[64:67], -4.0
ds_read_b128 a[240:243], v8 offset:4096
v_add_f32 v14, v14, v188
v_mfma_f32_16x16x32_bf16 v[176:179], a[196:199], v[68:71], v[176:179]
ds_read_b64_tr_b16 a[138:139], v2 offset:20896
v_exp_f32 v189, v189
v_mfma_f32_16x16x32_bf16 v[176:179], a[200:203], v[72:75], v[176:179]
ds_read_b128 a[244:247], v8 offset:4352
v_cvt_pk_bf16_f32 v198, v188, v189
v_add_f32 v14, v14, v189
v_mfma_f32_16x16x32_bf16 v[176:179], a[204:207], v[76:79], v[176:179]
ds_read_b64_tr_b16 a[140:141], v2 offset:16776
v_exp_f32 v190, v190
v_mfma_f32_16x16x32_bf16 v[180:183], a[208:211], v[64:67], -4.0
ds_read_b128 a[248:251], v8 offset:4608
v_add_f32 v14, v14, v190
v_mfma_f32_16x16x32_bf16 v[180:183], a[212:215], v[68:71], v[180:183]
ds_read_b64_tr_b16 a[142:143], v2 offset:20904
v_exp_f32 v191, v191
v_mfma_f32_16x16x32_bf16 v[180:183], a[216:219], v[72:75], v[180:183]
ds_read_b128 a[252:255], v8 offset:4864
v_cvt_pk_bf16_f32 v199, v190, v191
v_add_f32 v14, v14, v191
v_mfma_f32_16x16x32_bf16 v[180:183], a[220:223], v[76:79], v[180:183]
ds_read_b64_tr_b16 a[144:145], v2 offset:17024
v_exp_f32 v176, v176
v_mfma_f32_16x16x32_bf16 v[144:147], a[160:163], v[196:199], v[144:147]
ds_read_b64_tr_b16 a[146:147], v2 offset:21152
v_add_f32 v13, v13, v176
v_mfma_f32_16x16x32_bf16 v[148:151], a[164:167], v[196:199], v[148:151]
ds_read_b64_tr_b16 a[148:149], v2 offset:17032
v_exp_f32 v177, v177
v_mfma_f32_16x16x32_bf16 v[152:155], a[168:171], v[196:199], v[152:155]
ds_read_b64_tr_b16 a[150:151], v2 offset:21160
v_cvt_pk_bf16_f32 v192, v176, v177
v_add_f32 v13, v13, v177
v_mfma_f32_16x16x32_bf16 v[156:159], a[172:175], v[196:199], v[156:159]
ds_read_b64_tr_b16 a[152:153], v2 offset:17280
v_exp_f32 v178, v178
v_mfma_f32_16x16x32_bf16 v[160:163], a[176:179], v[196:199], v[160:163]
ds_read_b64_tr_b16 a[154:155], v2 offset:21408
v_add_f32 v13, v13, v178
v_mfma_f32_16x16x32_bf16 v[164:167], a[180:183], v[196:199], v[164:167]
ds_read_b64_tr_b16 a[156:157], v2 offset:17288
v_exp_f32 v179, v179
v_mfma_f32_16x16x32_bf16 v[168:171], a[184:187], v[196:199], v[168:171]
ds_read_b64_tr_b16 a[158:159], v2 offset:21416
v_cvt_pk_bf16_f32 v193, v178, v179
v_add_f32 v13, v13, v179
v_mfma_f32_16x16x32_bf16 v[172:175], a[188:191], v[196:199], v[172:175]
s_waitcnt lgkmcnt(8)
v_exp_f32 v180, v180
v_mfma_f32_16x16x32_bf16 v[184:187], a[224:227], v[64:67], -4.0
ds_read_b64_tr_b16 a[160:161], v232 offset:0
v_add_f32 v13, v13, v180
v_mfma_f32_16x16x32_bf16 v[184:187], a[228:231], v[68:71], v[184:187]
ds_read_b64_tr_b16 a[162:163], v232 offset:4128
v_exp_f32 v181, v181
v_mfma_f32_16x16x32_bf16 v[184:187], a[232:235], v[72:75], v[184:187]
ds_read_b64_tr_b16 a[164:165], v232 offset:8
v_cvt_pk_bf16_f32 v194, v180, v181
v_add_f32 v13, v13, v181
v_mfma_f32_16x16x32_bf16 v[184:187], a[236:239], v[76:79], v[184:187]
ds_read_b64_tr_b16 a[166:167], v232 offset:4136
v_exp_f32 v182, v182
v_mfma_f32_16x16x32_bf16 v[188:191], a[240:243], v[64:67], -4.0
ds_read_b64_tr_b16 a[168:169], v232 offset:256
v_add_f32 v13, v13, v182
v_mfma_f32_16x16x32_bf16 v[188:191], a[244:247], v[68:71], v[188:191]
ds_read_b64_tr_b16 a[170:171], v232 offset:4384
v_exp_f32 v183, v183
v_mfma_f32_16x16x32_bf16 v[188:191], a[248:251], v[72:75], v[188:191]
ds_read_b64_tr_b16 a[172:173], v232 offset:264
v_cvt_pk_bf16_f32 v195, v182, v183
v_add_f32 v13, v13, v183
v_mfma_f32_16x16x32_bf16 v[188:191], a[252:255], v[76:79], v[188:191]
s_waitcnt lgkmcnt(7)
v_exp_f32 v184, v184
v_mfma_f32_16x16x32_bf16 v[112:115], a[128:131], v[192:195], v[112:115]
ds_read_b64_tr_b16 a[174:175], v232 offset:4392
v_add_f32 v13, v13, v184
v_mfma_f32_16x16x32_bf16 v[116:119], a[132:135], v[192:195], v[116:119]
ds_read_b64_tr_b16 a[176:177], v232 offset:512
v_exp_f32 v185, v185
v_mfma_f32_16x16x32_bf16 v[120:123], a[136:139], v[192:195], v[120:123]
ds_read_b64_tr_b16 a[178:179], v232 offset:4640
v_cvt_pk_bf16_f32 v196, v184, v185
v_add_f32 v13, v13, v185
v_mfma_f32_16x16x32_bf16 v[124:127], a[140:143], v[192:195], v[124:127]
ds_read_b64_tr_b16 a[180:181], v232 offset:520
v_exp_f32 v186, v186
v_mfma_f32_16x16x32_bf16 v[128:131], a[144:147], v[192:195], v[128:131]
ds_read_b64_tr_b16 a[182:183], v232 offset:4648
v_add_f32 v13, v13, v186
v_mfma_f32_16x16x32_bf16 v[132:135], a[148:151], v[192:195], v[132:135]
ds_read_b64_tr_b16 a[184:185], v232 offset:768
v_exp_f32 v187, v187
v_mfma_f32_16x16x32_bf16 v[136:139], a[152:155], v[192:195], v[136:139]
ds_read_b64_tr_b16 a[186:187], v232 offset:4896
v_cvt_pk_bf16_f32 v197, v186, v187
v_add_f32 v13, v13, v187
v_mfma_f32_16x16x32_bf16 v[140:143], a[156:159], v[192:195], v[140:143]
ds_read_b64_tr_b16 a[188:189], v232 offset:776
v_exp_f32 v188, v188
v_mfma_f32_16x16x32_bf16 v[176:179], a[192:195], v[80:83], -4.0
ds_read_b64_tr_b16 a[190:191], v232 offset:4904
v_add_f32 v13, v13, v188
v_mfma_f32_16x16x32_bf16 v[176:179], a[196:199], v[84:87], v[176:179]
v_exp_f32 v189, v189
v_mfma_f32_16x16x32_bf16 v[176:179], a[200:203], v[88:91], v[176:179]
v_cvt_pk_bf16_f32 v198, v188, v189
v_add_f32 v13, v13, v189
v_mfma_f32_16x16x32_bf16 v[176:179], a[204:207], v[92:95], v[176:179]
v_exp_f32 v190, v190
v_mfma_f32_16x16x32_bf16 v[180:183], a[208:211], v[80:83], -4.0
v_add_f32 v13, v13, v190
v_mfma_f32_16x16x32_bf16 v[180:183], a[212:215], v[84:87], v[180:183]
v_exp_f32 v191, v191
v_mfma_f32_16x16x32_bf16 v[180:183], a[216:219], v[88:91], v[180:183]
v_cvt_pk_bf16_f32 v199, v190, v191
v_add_f32 v13, v13, v191
v_mfma_f32_16x16x32_bf16 v[180:183], a[220:223], v[92:95], v[180:183]
s_waitcnt lgkmcnt(0)
v_exp_f32 v176, v176
v_mfma_f32_16x16x32_bf16 v[112:115], a[160:163], v[196:199], v[112:115]
v_add_f32 v14, v14, v176
v_mfma_f32_16x16x32_bf16 v[116:119], a[164:167], v[196:199], v[116:119]
v_exp_f32 v177, v177
v_mfma_f32_16x16x32_bf16 v[120:123], a[168:171], v[196:199], v[120:123]
v_cvt_pk_bf16_f32 v192, v176, v177
v_add_f32 v14, v14, v177
v_mfma_f32_16x16x32_bf16 v[124:127], a[172:175], v[196:199], v[124:127]
v_exp_f32 v178, v178
v_mfma_f32_16x16x32_bf16 v[128:131], a[176:179], v[196:199], v[128:131]
v_add_f32 v14, v14, v178
v_mfma_f32_16x16x32_bf16 v[132:135], a[180:183], v[196:199], v[132:135]
v_exp_f32 v179, v179
v_mfma_f32_16x16x32_bf16 v[136:139], a[184:187], v[196:199], v[136:139]
v_cvt_pk_bf16_f32 v193, v178, v179
v_add_f32 v14, v14, v179
v_mfma_f32_16x16x32_bf16 v[140:143], a[188:191], v[196:199], v[140:143]
v_exp_f32 v180, v180
v_mfma_f32_16x16x4_f32 v[200:203], v7, v13, 0
s_add_u32 s3, s27, 12288
s_nop 8
v_rcp_f32 v200, v200
v_subrev_u32 v202, s47, v201
v_max_u32 v9, v9, v202
v_pk_mul_f32 v[112:113], v[112:113], v[200:201] op_sel_hi:[1,0]
v_pk_mul_f32 v[114:115], v[114:115], v[200:201] op_sel_hi:[1,0]
v_pk_mul_f32 v[116:117], v[116:117], v[200:201] op_sel_hi:[1,0]
v_pk_mul_f32 v[118:119], v[118:119], v[200:201] op_sel_hi:[1,0]
v_cvt_pk_bf16_f32 v220, v112, v113
v_cvt_pk_bf16_f32 v221, v114, v115
v_cvt_pk_bf16_f32 v222, v116, v117
v_cvt_pk_bf16_f32 v223, v118, v119
v_pk_mul_f32 v[120:121], v[120:121], v[200:201] op_sel_hi:[1,0]
v_pk_mul_f32 v[122:123], v[122:123], v[200:201] op_sel_hi:[1,0]
v_pk_mul_f32 v[124:125], v[124:125], v[200:201] op_sel_hi:[1,0]
v_pk_mul_f32 v[126:127], v[126:127], v[200:201] op_sel_hi:[1,0]
v_cvt_pk_bf16_f32 v224, v120, v121
v_cvt_pk_bf16_f32 v225, v122, v123
v_cvt_pk_bf16_f32 v226, v124, v125
v_cvt_pk_bf16_f32 v227, v126, v127
v_cndmask_b32_dpp v244, v220, v224, vcc row_ror:8 row_mask:0xf bank_mask:0xf
v_cndmask_b32_dpp v245, v221, v225, vcc row_ror:8 row_mask:0xf bank_mask:0xf
v_cndmask_b32_dpp v246, v222, v226, vcc row_ror:8 row_mask:0xf bank_mask:0xf
v_cndmask_b32_dpp v247, v223, v227, vcc row_ror:8 row_mask:0xf bank_mask:0xf
s_not_b64 vcc, vcc
v_cndmask_b32_dpp v240, v224, v220, vcc row_ror:8 row_mask:0xf bank_mask:0xf
v_cndmask_b32_dpp v241, v225, v221, vcc row_ror:8 row_mask:0xf bank_mask:0xf
v_cndmask_b32_dpp v242, v226, v222, vcc row_ror:8 row_mask:0xf bank_mask:0xf
v_cndmask_b32_dpp v243, v227, v223, vcc row_ror:8 row_mask:0xf bank_mask:0xf
s_not_b64 vcc, vcc
v_pk_mul_f32 v[128:129], v[128:129], v[200:201] op_sel_hi:[1,0]
v_pk_mul_f32 v[130:131], v[130:131], v[200:201] op_sel_hi:[1,0]
buffer_store_dwordx4 v[240:243], v233, s[16:19], s3 offen offset:0 sc1
v_pk_mul_f32 v[132:133], v[132:133], v[200:201] op_sel_hi:[1,0]
v_pk_mul_f32 v[134:135], v[134:135], v[200:201] op_sel_hi:[1,0]
v_cvt_pk_bf16_f32 v220, v128, v129
v_cvt_pk_bf16_f32 v221, v130, v131
v_cvt_pk_bf16_f32 v222, v132, v133
v_cvt_pk_bf16_f32 v223, v134, v135
v_pk_mul_f32 v[136:137], v[136:137], v[200:201] op_sel_hi:[1,0]
v_pk_mul_f32 v[138:139], v[138:139], v[200:201] op_sel_hi:[1,0]
v_pk_mul_f32 v[140:141], v[140:141], v[200:201] op_sel_hi:[1,0]
v_pk_mul_f32 v[142:143], v[142:143], v[200:201] op_sel_hi:[1,0]
v_cvt_pk_bf16_f32 v224, v136, v137
v_cvt_pk_bf16_f32 v225, v138, v139
v_cvt_pk_bf16_f32 v226, v140, v141
v_cvt_pk_bf16_f32 v227, v142, v143
v_cndmask_b32_dpp v252, v220, v224, vcc row_ror:8 row_mask:0xf bank_mask:0xf
v_cndmask_b32_dpp v253, v221, v225, vcc row_ror:8 row_mask:0xf bank_mask:0xf
v_cndmask_b32_dpp v254, v222, v226, vcc row_ror:8 row_mask:0xf bank_mask:0xf
v_cndmask_b32_dpp v255, v223, v227, vcc row_ror:8 row_mask:0xf bank_mask:0xf
s_not_b64 vcc, vcc
v_cndmask_b32_dpp v248, v224, v220, vcc row_ror:8 row_mask:0xf bank_mask:0xf
v_cndmask_b32_dpp v249, v225, v221, vcc row_ror:8 row_mask:0xf bank_mask:0xf
v_cndmask_b32_dpp v250, v226, v222, vcc row_ror:8 row_mask:0xf bank_mask:0xf
v_cndmask_b32_dpp v251, v227, v223, vcc row_ror:8 row_mask:0xf bank_mask:0xf
s_not_b64 vcc, vcc
v_mfma_f32_16x16x32_bf16 v[184:187], a[224:227], v[80:83], -4.0
v_add_f32 v14, v14, v180
v_mfma_f32_16x16x32_bf16 v[184:187], a[228:231], v[84:87], v[184:187]
v_exp_f32 v181, v181
v_mfma_f32_16x16x32_bf16 v[184:187], a[232:235], v[88:91], v[184:187]
v_cvt_pk_bf16_f32 v194, v180, v181
v_add_f32 v14, v14, v181
v_mfma_f32_16x16x32_bf16 v[184:187], a[236:239], v[92:95], v[184:187]
v_exp_f32 v182, v182
v_mfma_f32_16x16x32_bf16 v[188:191], a[240:243], v[80:83], -4.0
v_add_f32 v14, v14, v182
v_mfma_f32_16x16x32_bf16 v[188:191], a[244:247], v[84:87], v[188:191]
buffer_store_dwordx4 v[244:247], v233, s[16:19], s3 offen offset:2048 sc1
v_exp_f32 v183, v183
v_mfma_f32_16x16x32_bf16 v[188:191], a[248:251], v[88:91], v[188:191]
v_cvt_pk_bf16_f32 v195, v182, v183
v_add_f32 v14, v14, v183
v_mfma_f32_16x16x32_bf16 v[188:191], a[252:255], v[92:95], v[188:191]
v_exp_f32 v184, v184
v_mfma_f32_16x16x32_bf16 v[144:147], a[128:131], v[192:195], v[144:147]
v_add_f32 v14, v14, v184
v_mfma_f32_16x16x32_bf16 v[148:151], a[132:135], v[192:195], v[148:151]
v_exp_f32 v185, v185
v_mfma_f32_16x16x32_bf16 v[152:155], a[136:139], v[192:195], v[152:155]
v_cvt_pk_bf16_f32 v196, v184, v185
v_add_f32 v14, v14, v185
v_mfma_f32_16x16x32_bf16 v[156:159], a[140:143], v[192:195], v[156:159]
v_exp_f32 v186, v186
v_mfma_f32_16x16x32_bf16 v[160:163], a[144:147], v[192:195], v[160:163]
v_add_f32 v14, v14, v186
v_mfma_f32_16x16x32_bf16 v[164:167], a[148:151], v[192:195], v[164:167]
v_exp_f32 v187, v187
v_mfma_f32_16x16x32_bf16 v[168:171], a[152:155], v[192:195], v[168:171]
v_cvt_pk_bf16_f32 v197, v186, v187
v_add_f32 v14, v14, v187
v_mfma_f32_16x16x32_bf16 v[172:175], a[156:159], v[192:195], v[172:175]
v_exp_f32 v188, v188
v_exp_f32 v189, v189
v_exp_f32 v190, v190
v_exp_f32 v191, v191
buffer_store_dwordx4 v[248:251], v233, s[16:19], s3 offen offset:128 sc1
v_add_f32 v14, v14, v188
v_cvt_pk_bf16_f32 v198, v188, v189
v_add_f32 v14, v14, v189
v_add_f32 v14, v14, v190
v_cvt_pk_bf16_f32 v199, v190, v191
v_add_f32 v14, v14, v191
s_nop 0
v_mfma_f32_16x16x32_bf16 v[144:147], a[160:163], v[196:199], v[144:147]
v_mfma_f32_16x16x32_bf16 v[148:151], a[164:167], v[196:199], v[148:151]
v_mfma_f32_16x16x32_bf16 v[152:155], a[168:171], v[196:199], v[152:155]
v_mfma_f32_16x16x32_bf16 v[156:159], a[172:175], v[196:199], v[156:159]
v_mfma_f32_16x16x32_bf16 v[160:163], a[176:179], v[196:199], v[160:163]
v_mfma_f32_16x16x32_bf16 v[164:167], a[180:183], v[196:199], v[164:167]
v_mfma_f32_16x16x32_bf16 v[168:171], a[184:187], v[196:199], v[168:171]
v_mfma_f32_16x16x32_bf16 v[172:175], a[188:191], v[196:199], v[172:175]
v_mfma_f32_16x16x4_f32 v[200:203], v7, v14, 0
buffer_store_dwordx4 v[252:255], v233, s[16:19], s3 offen offset:2176 sc1
s_add_u32 s3, s27, 16384
s_nop 7
v_rcp_f32 v200, v200
v_subrev_u32 v202, s47, v201
v_max_u32 v9, v9, v202
v_pk_mul_f32 v[144:145], v[144:145], v[200:201] op_sel_hi:[1,0]
v_pk_mul_f32 v[146:147], v[146:147], v[200:201] op_sel_hi:[1,0]
v_pk_mul_f32 v[148:149], v[148:149], v[200:201] op_sel_hi:[1,0]
v_pk_mul_f32 v[150:151], v[150:151], v[200:201] op_sel_hi:[1,0]
v_cvt_pk_bf16_f32 v220, v144, v145
v_cvt_pk_bf16_f32 v221, v146, v147
v_cvt_pk_bf16_f32 v222, v148, v149
v_cvt_pk_bf16_f32 v223, v150, v151
v_pk_mul_f32 v[152:153], v[152:153], v[200:201] op_sel_hi:[1,0]
v_pk_mul_f32 v[154:155], v[154:155], v[200:201] op_sel_hi:[1,0]
v_pk_mul_f32 v[156:157], v[156:157], v[200:201] op_sel_hi:[1,0]
v_pk_mul_f32 v[158:159], v[158:159], v[200:201] op_sel_hi:[1,0]
v_cvt_pk_bf16_f32 v224, v152, v153
v_cvt_pk_bf16_f32 v225, v154, v155
v_cvt_pk_bf16_f32 v226, v156, v157
v_cvt_pk_bf16_f32 v227, v158, v159
v_cndmask_b32_dpp v244, v220, v224, vcc row_ror:8 row_mask:0xf bank_mask:0xf
v_cndmask_b32_dpp v245, v221, v225, vcc row_ror:8 row_mask:0xf bank_mask:0xf
v_cndmask_b32_dpp v246, v222, v226, vcc row_ror:8 row_mask:0xf bank_mask:0xf
v_cndmask_b32_dpp v247, v223, v227, vcc row_ror:8 row_mask:0xf bank_mask:0xf
s_not_b64 vcc, vcc
v_cndmask_b32_dpp v240, v224, v220, vcc row_ror:8 row_mask:0xf bank_mask:0xf
v_cndmask_b32_dpp v241, v225, v221, vcc row_ror:8 row_mask:0xf bank_mask:0xf
v_cndmask_b32_dpp v242, v226, v222, vcc row_ror:8 row_mask:0xf bank_mask:0xf
L_pad14:
s_cbranch_execz L_padret
v_cndmask_b32_dpp v243, v227, v223, vcc row_ror:8 row_mask:0xf bank_mask:0xf
s_not_b64 vcc, vcc
v_pk_mul_f32 v[160:161], v[160:161], v[200:201] op_sel_hi:[1,0]
v_pk_mul_f32 v[162:163], v[162:163], v[200:201] op_sel_hi:[1,0]
buffer_store_dwordx4 v[240:243], v233, s[16:19], s3 offen offset:0 sc1
v_pk_mul_f32 v[164:165], v[164:165], v[200:201] op_sel_hi:[1,0]
v_pk_mul_f32 v[166:167], v[166:167], v[200:201] op_sel_hi:[1,0]
v_cvt_pk_bf16_f32 v220, v160, v161
v_cvt_pk_bf16_f32 v221, v162, v163
v_cvt_pk_bf16_f32 v222, v164, v165
v_cvt_pk_bf16_f32 v223, v166, v167
v_pk_mul_f32 v[168:169], v[168:169], v[200:201] op_sel_hi:[1,0]
v_pk_mul_f32 v[170:171], v[170:171], v[200:201] op_sel_hi:[1,0]
buffer_store_dwordx4 v[244:247], v233, s[16:19], s3 offen offset:2048 sc1
v_pk_mul_f32 v[172:173], v[172:173], v[200:201] op_sel_hi:[1,0]
v_pk_mul_f32 v[174:175], v[174:175], v[200:201] op_sel_hi:[1,0]
v_cvt_pk_bf16_f32 v224, v168, v169
v_cvt_pk_bf16_f32 v225, v170, v171
v_cvt_pk_bf16_f32 v226, v172, v173
v_cvt_pk_bf16_f32 v227, v174, v175
v_cndmask_b32_dpp v252, v220, v224, vcc row_ror:8 row_mask:0xf bank_mask:0xf
v_cndmask_b32_dpp v253, v221, v225, vcc row_ror:8 row_mask:0xf bank_mask:0xf
v_cndmask_b32_dpp v254, v222, v226, vcc row_ror:8 row_mask:0xf bank_mask:0xf
v_cndmask_b32_dpp v255, v223, v227, vcc row_ror:8 row_mask:0xf bank_mask:0xf
s_not_b64 vcc, vcc
v_cndmask_b32_dpp v248, v224, v220, vcc row_ror:8 row_mask:0xf bank_mask:0xf
v_cndmask_b32_dpp v249, v225, v221, vcc row_ror:8 row_mask:0xf bank_mask:0xf
v_cndmask_b32_dpp v250, v226, v222, vcc row_ror:8 row_mask:0xf bank_mask:0xf
v_cndmask_b32_dpp v251, v227, v223, vcc row_ror:8 row_mask:0xf bank_mask:0xf
s_not_b64 vcc, vcc
s_nop 0
buffer_store_dwordx4 v[248:251], v233, s[16:19], s3 offen offset:128 sc1
buffer_store_dwordx4 v[252:255], v233, s[16:19], s3 offen offset:2176 sc1
v_cmp_le_u32 vcc, 0x28000000, v9
s_nop 4
s_cbranch_vccnz L_fallback
s_endpgm
L_side:
s_waitcnt vmcnt(40)
s_mov_b32 m0, 65792
s_add_u32 s24, s21, 4096
buffer_load_dwordx4 v3, s[8:11], s21 offen offset:0 nt lds
buffer_load_dwordx4 v3, s[8:11], s21 offen offset:1024 nt lds
buffer_load_dwordx4 v4, s[8:11], s21 offen offset:2048 nt lds
buffer_load_dwordx4 v4, s[8:11], s21 offen offset:3072 nt lds
s_mov_b32 m0, 69888
s_nop 0
buffer_load_dwordx4 v3, s[8:11], s24 offen offset:0 nt lds
buffer_load_dwordx4 v3, s[8:11], s24 offen offset:1024 nt lds
buffer_load_dwordx4 v4, s[8:11], s24 offen offset:2048 nt lds
buffer_load_dwordx4 v4, s[8:11], s24 offen offset:3072 nt lds
s_mov_b32 m0, 90368
s_nop 0
buffer_load_dwordx4 v3, s[12:15], s21 offen offset:0 nt lds
s_mov_b32 m0, 90376
s_nop 0
buffer_load_dwordx4 v3, s[12:15], s21 offen offset:1024 nt lds
s_mov_b32 m0, 90384
s_nop 0
buffer_load_dwordx4 v3, s[12:15], s21 offen offset:2048 nt lds
s_mov_b32 m0, 90392
s_nop 0
buffer_load_dwordx4 v3, s[12:15], s21 offen offset:3072 nt lds
s_mov_b32 m0, 94496
s_nop 0
buffer_load_dwordx4 v3, s[12:15], s24 offen offset:0 nt lds
s_mov_b32 m0, 94504
s_nop 0
buffer_load_dwordx4 v3, s[12:15], s24 offen offset:1024 nt lds
s_mov_b32 m0, 94512
s_nop 0
buffer_load_dwordx4 v3, s[12:15], s24 offen offset:2048 nt lds
s_mov_b32 m0, 94520
s_nop 0
buffer_load_dwordx4 v3, s[12:15], s24 offen offset:3072 nt lds
s_add_u32 s21, s21, 8192
s_branch L_sideback
L_fin:
v_cmp_le_u32 vcc, 0x28000000, v9
s_nop 4
s_cbranch_vccz L_end
L_fallback:
v_and_b32 v200, 15, v0
v_lshrrev_b32 v201, 4, v0
v_lshlrev_b32 v12, 10, v201
v_lshrrev_b32 v202, 2, v200
v_lshl_add_u32 v12, v202, 4, v12
v_and_b32 v202, 3, v200
v_lshl_add_u32 v12, v202, 1, v12
s_sub_u32 s27, s27, 188416
s_mov_b32 s21, s100
s_mov_b32 s29, 0
s_waitcnt vmcnt(0) lgkmcnt(0)
L_fb_ph:
s_mov_b32 s28, 0
L_fb_tile:
s_lshl_b32 s26, s28, 12
s_add_u32 s3, s27, s26
buffer_load_dwordx4 v[16:19], v5, s[4:7], s3 offen offset:0
buffer_load_dwordx4 v[20:23], v5, s[4:7], s3 offen offset:64
buffer_load_dwordx4 v[24:27], v5, s[4:7], s3 offen offset:128
buffer_load_dwordx4 v[28:31], v5, s[4:7], s3 offen offset:192
v_mov_b32 v10, 0xff800000
s_mov_b32 s25, 0
L_fb_max:
s_add_u32 s26, s21, s25
buffer_load_dwordx4 v[32:35], v5, s[8:11], s26 offen offset:0
buffer_load_dwordx4 v[36:39], v5, s[8:11], s26 offen offset:64
buffer_load_dwordx4 v[40:43], v5, s[8:11], s26 offen offset:128
buffer_load_dwordx4 v[44:47], v5, s[8:11], s26 offen offset:192
s_waitcnt vmcnt(0)
v_mfma_f32_16x16x32_bf16 v[176:179], v[32:35], v[16:19], 0
v_mfma_f32_16x16x32_bf16 v[176:179], v[36:39], v[20:23], v[176:179]
v_mfma_f32_16x16x32_bf16 v[176:179], v[40:43], v[24:27], v[176:179]
v_mfma_f32_16x16x32_bf16 v[176:179], v[44:47], v[28:31], v[176:179]
s_nop 7
v_max3_f32 v10, v176, v177, v10
v_max3_f32 v10, v178, v179, v10
s_add_u32 s25, s25, 4096
s_cmp_lt_u32 s25, 131072
s_cbranch_scc1 L_fb_max
v_mov_b32 v200, v10
s_nop 1
v_permlane32_swap_b32 v200, v10
s_nop 1
v_max_f32 v10, v10, v200
v_mov_b32 v200, v10
s_nop 1
v_permlane16_swap_b32 v200, v10
s_nop 1
v_max_f32 v10, v10, v200
v_mul_f32 v10, s38, v10
v_mov_b32 v11, 0
v_mov_b32 v144, 0
v_mov_b32 v145, 0
v_mov_b32 v146, 0
v_mov_b32 v147, 0
v_mov_b32 v148, 0
v_mov_b32 v149, 0
v_mov_b32 v150, 0
v_mov_b32 v151, 0
v_mov_b32 v152, 0
v_mov_b32 v153, 0
v_mov_b32 v154, 0
v_mov_b32 v155, 0
v_mov_b32 v156, 0
v_mov_b32 v157, 0
v_mov_b32 v158, 0
v_mov_b32 v159, 0
v_mov_b32 v160, 0
v_mov_b32 v161, 0
v_mov_b32 v162, 0
v_mov_b32 v163, 0
v_mov_b32 v164, 0
v_mov_b32 v165, 0
v_mov_b32 v166, 0
v_mov_b32 v167, 0
v_mov_b32 v168, 0
v_mov_b32 v169, 0
v_mov_b32 v170, 0
v_mov_b32 v171, 0
v_mov_b32 v172, 0
v_mov_b32 v173, 0
v_mov_b32 v174, 0
v_mov_b32 v175, 0
s_mov_b32 s25, 0
L_fb_step:
s_add_u32 s26, s21, s25
buffer_load_dwordx4 v[32:35], v5, s[8:11], s26 offen offset:0
buffer_load_dwordx4 v[36:39], v5, s[8:11], s26 offen offset:64
buffer_load_dwordx4 v[40:43], v5, s[8:11], s26 offen offset:128
buffer_load_dwordx4 v[44:47], v5, s[8:11], s26 offen offset:192
s_waitcnt vmcnt(0)
v_mfma_f32_16x16x32_bf16 v[176:179], v[32:35], v[16:19], 0
v_mfma_f32_16x16x32_bf16 v[176:179], v[36:39], v[20:23], v[176:179]
v_mfma_f32_16x16x32_bf16 v[176:179], v[40:43], v[24:27], v[176:179]
v_mfma_f32_16x16x32_bf16 v[176:179], v[44:47], v[28:31], v[176:179]
s_nop 7
s_add_u32 s22, s26, 0
s_add_u32 s26, s26, 4096
buffer_load_dwordx4 v[32:35], v5, s[8:11], s26 offen offset:0
buffer_load_dwordx4 v[36:39], v5, s[8:11], s26 offen offset:64
buffer_load_dwordx4 v[40:43], v5, s[8:11], s26 offen offset:128
buffer_load_dwordx4 v[44:47], v5, s[8:11], s26 offen offset:192
s_waitcnt vmcnt(0)
v_mfma_f32_16x16x32_bf16 v[180:183], v[32:35], v[16:19], 0
v_mfma_f32_16x16x32_bf16 v[180:183], v[36:39], v[20:23], v[180:183]
v_mfma_f32_16x16x32_bf16 v[180:183], v[40:43], v[24:27], v[180:183]
v_mfma_f32_16x16x32_bf16 v[180:183], v[44:47], v[28:31], v[180:183]
s_nop 7
buffer_load_ushort v48, v12, s[12:15], s22 offen offset:0
buffer_load_ushort v49, v12, s[12:15], s22 offen offset:256
buffer_load_ushort v50, v12, s[12:15], s22 offen offset:512
buffer_load_ushort v51, v12, s[12:15], s22 offen offset:768
buffer_load_ushort v52, v12, s[12:15], s26 offen offset:0
buffer_load_ushort v53, v12, s[12:15], s26 offen offset:256
buffer_load_ushort v54, v12, s[12:15], s26 offen offset:512
buffer_load_ushort v55, v12, s[12:15], s26 offen offset:768
buffer_load_ushort v56, v12, s[12:15], s22 offen offset:8
buffer_load_ushort v57, v12, s[12:15], s22 offen offset:264
buffer_load_ushort v58, v12, s[12:15], s22 offen offset:520
buffer_load_ushort v59, v12, s[12:15], s22 offen offset:776
buffer_load_ushort v60, v12, s[12:15], s26 offen offset:8
buffer_load_ushort v61, v12, s[12:15], s26 offen offset:264
buffer_load_ushort v62, v12, s[12:15], s26 offen offset:520
buffer_load_ushort v63, v12, s[12:15], s26 offen offset:776
buffer_load_ushort v64, v12, s[12:15], s22 offen offset:64
buffer_load_ushort v65, v12, s[12:15], s22 offen offset:320
buffer_load_ushort v66, v12, s[12:15], s22 offen offset:576
buffer_load_ushort v67, v12, s[12:15], s22 offen offset:832
buffer_load_ushort v68, v12, s[12:15], s26 offen offset:64
buffer_load_ushort v69, v12, s[12:15], s26 offen offset:320
buffer_load_ushort v70, v12, s[12:15], s26 offen offset:576
buffer_load_ushort v71, v12, s[12:15], s26 offen offset:832
buffer_load_ushort v72, v12, s[12:15], s22 offen offset:72
buffer_load_ushort v73, v12, s[12:15], s22 offen offset:328
buffer_load_ushort v74, v12, s[12:15], s22 offen offset:584
buffer_load_ushort v75, v12, s[12:15], s22 offen offset:840
buffer_load_ushort v76, v12, s[12:15], s26 offen offset:72
buffer_load_ushort v77, v12, s[12:15], s26 offen offset:328
buffer_load_ushort v78, v12, s[12:15], s26 offen offset:584
buffer_load_ushort v79, v12, s[12:15], s26 offen offset:840
s_waitcnt vmcnt(0)
buffer_load_ushort v80, v12, s[12:15], s22 offen offset:128
buffer_load_ushort v81, v12, s[12:15], s22 offen offset:384
buffer_load_ushort v82, v12, s[12:15], s22 offen offset:640
buffer_load_ushort v83, v12, s[12:15], s22 offen offset:896
buffer_load_ushort v84, v12, s[12:15], s26 offen offset:128
buffer_load_ushort v85, v12, s[12:15], s26 offen offset:384
buffer_load_ushort v86, v12, s[12:15], s26 offen offset:640
buffer_load_ushort v87, v12, s[12:15], s26 offen offset:896
buffer_load_ushort v88, v12, s[12:15], s22 offen offset:136
buffer_load_ushort v89, v12, s[12:15], s22 offen offset:392
buffer_load_ushort v90, v12, s[12:15], s22 offen offset:648
buffer_load_ushort v91, v12, s[12:15], s22 offen offset:904
buffer_load_ushort v92, v12, s[12:15], s26 offen offset:136
buffer_load_ushort v93, v12, s[12:15], s26 offen offset:392
buffer_load_ushort v94, v12, s[12:15], s26 offen offset:648
buffer_load_ushort v95, v12, s[12:15], s26 offen offset:904
buffer_load_ushort v96, v12, s[12:15], s22 offen offset:192
buffer_load_ushort v97, v12, s[12:15], s22 offen offset:448
buffer_load_ushort v98, v12, s[12:15], s22 offen offset:704
buffer_load_ushort v99, v12, s[12:15], s22 offen offset:960
buffer_load_ushort v100, v12, s[12:15], s26 offen offset:192
buffer_load_ushort v101, v12, s[12:15], s26 offen offset:448
buffer_load_ushort v102, v12, s[12:15], s26 offen offset:704
buffer_load_ushort v103, v12, s[12:15], s26 offen offset:960
buffer_load_ushort v104, v12, s[12:15], s22 offen offset:200
buffer_load_ushort v105, v12, s[12:15], s22 offen offset:456
buffer_load_ushort v106, v12, s[12:15], s22 offen offset:712
buffer_load_ushort v107, v12, s[12:15], s22 offen offset:968
buffer_load_ushort v108, v12, s[12:15], s26 offen offset:200
buffer_load_ushort v109, v12, s[12:15], s26 offen offset:456
buffer_load_ushort v110, v12, s[12:15], s26 offen offset:712
buffer_load_ushort v111, v12, s[12:15], s26 offen offset:968
v_fma_f32 v176, v176, s38, -v10
v_fma_f32 v177, v177, s38, -v10
v_fma_f32 v178, v178, s38, -v10
v_fma_f32 v179, v179, s38, -v10
v_fma_f32 v180, v180, s38, -v10
v_fma_f32 v181, v181, s38, -v10
v_fma_f32 v182, v182, s38, -v10
v_fma_f32 v183, v183, s38, -v10
v_exp_f32 v176, v176
v_exp_f32 v177, v177
v_exp_f32 v178, v178
v_exp_f32 v179, v179
v_exp_f32 v180, v180
v_exp_f32 v181, v181
v_exp_f32 v182, v182
v_exp_f32 v183, v183
s_nop 0
v_add_f32 v11, v11, v176
v_add_f32 v11, v11, v177
v_add_f32 v11, v11, v178
v_add_f32 v11, v11, v179
v_add_f32 v11, v11, v180
v_add_f32 v11, v11, v181
v_add_f32 v11, v11, v182
v_add_f32 v11, v11, v183
v_cvt_pk_bf16_f32 v192, v176, v177
v_cvt_pk_bf16_f32 v193, v178, v179
v_cvt_pk_bf16_f32 v194, v180, v181
v_cvt_pk_bf16_f32 v195, v182, v183
s_waitcnt vmcnt(0)
v_lshl_or_b32 v112, v49, 16, v48
v_lshl_or_b32 v113, v51, 16, v50
v_lshl_or_b32 v114, v53, 16, v52
v_lshl_or_b32 v115, v55, 16, v54
v_lshl_or_b32 v116, v57, 16, v56
v_lshl_or_b32 v117, v59, 16, v58
v_lshl_or_b32 v118, v61, 16, v60
v_lshl_or_b32 v119, v63, 16, v62
v_lshl_or_b32 v120, v65, 16, v64
v_lshl_or_b32 v121, v67, 16, v66
v_lshl_or_b32 v122, v69, 16, v68
v_lshl_or_b32 v123, v71, 16, v70
v_lshl_or_b32 v124, v73, 16, v72
v_lshl_or_b32 v125, v75, 16, v74
v_lshl_or_b32 v126, v77, 16, v76
v_lshl_or_b32 v127, v79, 16, v78
v_lshl_or_b32 v128, v81, 16, v80
v_lshl_or_b32 v129, v83, 16, v82
v_lshl_or_b32 v130, v85, 16, v84
v_lshl_or_b32 v131, v87, 16, v86
v_lshl_or_b32 v132, v89, 16, v88
v_lshl_or_b32 v133, v91, 16, v90
v_lshl_or_b32 v134, v93, 16, v92
v_lshl_or_b32 v135, v95, 16, v94
v_lshl_or_b32 v136, v97, 16, v96
v_lshl_or_b32 v137, v99, 16, v98
v_lshl_or_b32 v138, v101, 16, v100
v_lshl_or_b32 v139, v103, 16, v102
v_lshl_or_b32 v140, v105, 16, v104
v_lshl_or_b32 v141, v107, 16, v106
v_lshl_or_b32 v142, v109, 16, v108
v_lshl_or_b32 v143, v111, 16, v110
s_nop 1
v_mfma_f32_16x16x32_bf16 v[144:147], v[112:115], v[192:195], v[144:147]
v_mfma_f32_16x16x32_bf16 v[148:151], v[116:119], v[192:195], v[148:151]
v_mfma_f32_16x16x32_bf16 v[152:155], v[120:123], v[192:195], v[152:155]
v_mfma_f32_16x16x32_bf16 v[156:159], v[124:127], v[192:195], v[156:159]
v_mfma_f32_16x16x32_bf16 v[160:163], v[128:131], v[192:195], v[160:163]
v_mfma_f32_16x16x32_bf16 v[164:167], v[132:135], v[192:195], v[164:167]
v_mfma_f32_16x16x32_bf16 v[168:171], v[136:139], v[192:195], v[168:171]
v_mfma_f32_16x16x32_bf16 v[172:175], v[140:143], v[192:195], v[172:175]
s_add_u32 s25, s25, 8192
s_cmp_lt_u32 s25, 131072
s_cbranch_scc1 L_fb_step
v_mfma_f32_16x16x4_f32 v[200:203], v7, v11, 0
s_nop 15
v_rcp_f32 v200, v200
s_nop 0
v_mul_f32 v144, v144, v200
v_mul_f32 v145, v145, v200
v_mul_f32 v146, v146, v200
v_mul_f32 v147, v147, v200
v_mul_f32 v148, v148, v200
v_mul_f32 v149, v149, v200
v_mul_f32 v150, v150, v200
v_mul_f32 v151, v151, v200
v_mul_f32 v152, v152, v200
v_mul_f32 v153, v153, v200
v_mul_f32 v154, v154, v200
v_mul_f32 v155, v155, v200
v_mul_f32 v156, v156, v200
v_mul_f32 v157, v157, v200
v_mul_f32 v158, v158, v200
v_mul_f32 v159, v159, v200
v_mul_f32 v160, v160, v200
v_mul_f32 v161, v161, v200
v_mul_f32 v162, v162, v200
v_mul_f32 v163, v163, v200
v_mul_f32 v164, v164, v200
v_mul_f32 v165, v165, v200
v_mul_f32 v166, v166, v200
v_mul_f32 v167, v167, v200
v_mul_f32 v168, v168, v200
v_mul_f32 v169, v169, v200
v_mul_f32 v170, v170, v200
v_mul_f32 v171, v171, v200
v_mul_f32 v172, v172, v200
v_mul_f32 v173, v173, v200
v_mul_f32 v174, v174, v200
v_mul_f32 v175, v175, v200
v_cvt_pk_bf16_f32 v112, v144, v145
v_cvt_pk_bf16_f32 v113, v146, v147
v_cvt_pk_bf16_f32 v114, v148, v149
v_cvt_pk_bf16_f32 v115, v150, v151
buffer_store_dwordx4 v[112:115], v5, s[16:19], s3 offen offset:0
v_cvt_pk_bf16_f32 v116, v152, v153
v_cvt_pk_bf16_f32 v117, v154, v155
v_cvt_pk_bf16_f32 v118, v156, v157
v_cvt_pk_bf16_f32 v119, v158, v159
buffer_store_dwordx4 v[116:119], v5, s[16:19], s3 offen offset:64
v_cvt_pk_bf16_f32 v120, v160, v161
v_cvt_pk_bf16_f32 v121, v162, v163
v_cvt_pk_bf16_f32 v122, v164, v165
v_cvt_pk_bf16_f32 v123, v166, v167
buffer_store_dwordx4 v[120:123], v5, s[16:19], s3 offen offset:128
v_cvt_pk_bf16_f32 v124, v168, v169
v_cvt_pk_bf16_f32 v125, v170, v171
v_cvt_pk_bf16_f32 v126, v172, v173
v_cvt_pk_bf16_f32 v127, v174, v175
buffer_store_dwordx4 v[124:127], v5, s[16:19], s3 offen offset:192
s_waitcnt vmcnt(0)
s_add_u32 s28, s28, 1
s_cmp_lt_u32 s28, s101
s_cbranch_scc1 L_fb_tile
s_add_u32 s27, s27, 188416
s_add_u32 s21, s21, 131072
s_add_u32 s29, s29, 1
s_cmp_lt_u32 s29, 2
s_cbranch_scc1 L_fb_ph
L_end:
s_endpgm
.section .rodata,"a"
.p2align 6
.amdhsa_kernel standalone__gqa_softmax__near_ridge_kernel
  .amdhsa_next_free_vgpr 512
  .amdhsa_next_free_sgpr 102
  .amdhsa_accum_offset 256
  .amdhsa_group_segment_fixed_size 0
  .amdhsa_kernarg_size 48
  .amdhsa_user_sgpr_count 2
  .amdhsa_user_sgpr_kernarg_segment_ptr 1
  .amdhsa_system_sgpr_workgroup_id_x 1
.end_amdhsa_kernel
```
